```python
import torch

def _softmax(x, axis=-1):
    return torch.softmax(x, dim=axis)
def _gelu(x):
    return torch.nn.functional.gelu(x, approximate="tanh")
def _silu(x):
    return torch.nn.functional.silu(x)
def _sigmoid(x):
    return torch.sigmoid(x)
def _layernorm(x, axis=-1, eps=1e-5):
    m = x.mean(dim=axis, keepdim=True)
    v = x.var(dim=axis, keepdim=True, unbiased=False)
    return (x - m) / torch.sqrt(v + eps)
def _scatter_add(tgt, idx, src, axis=0):
    return tgt.clone().index_add_(axis, idx, src)
def _segment_sum(src, seg, n):
    out = torch.zeros((n,) + src.shape[1:], dtype=src.dtype)
    return out.index_add_(0, seg, src)
def _pad(x, pw):
    flat = tuple(v for pair in reversed(pw) for v in pair)
    return torch.nn.functional.pad(x, flat)

kernel_name = 'standalone__mha_block_cached__near_ridge'

def setup_inputs():

    _w = (lambda a: (lambda t: t.to(torch.bfloat16) if t.is_floating_point() else t)(torch.as_tensor(a)))
    B, Sq, D = 32, 64, 576
    H, Sk, Dh = 32, 512, 128
    return {
        "x": _w((lambda *s: torch.randn(*s, dtype=torch.bfloat16) * 0.8)(B, Sq, D)),
        "k_cache": _w((lambda *s: torch.randn(*s, dtype=torch.bfloat16) * 0.8)(B, H, Sk, Dh)),
        "v_cache": _w((lambda *s: torch.randn(*s, dtype=torch.bfloat16) * 0.05)(B, H, Sk, Dh)),
        "wq": _w((lambda *s: torch.randn(*s, dtype=torch.bfloat16) * 0.8)(D, H * Dh) * (D ** -0.5)),
        "wo": _w((lambda *s: torch.randn(*s, dtype=torch.bfloat16) * 0.05)(H * Dh, D) * ((H * Dh) ** -0.5)),
    }

def reference(x, k_cache, v_cache, wq, wo):
    B, Sq, D = x.shape
    H, Dh = 32, 128
    q = (lambda x, *d: x.permute(*d))((x @ wq).reshape(B, Sq, H, Dh), 0, 2, 1, 3)
    scores = torch.einsum("bhqd,bhkd->bhqk", q, k_cache) * (Dh ** -0.5)
    p = _softmax(scores, axis=-1)
    o = torch.einsum("bhqk,bhkd->bhqd", p, v_cache)
    return (lambda x, *d: x.permute(*d))(o, 0, 2, 1, 3).reshape(B, Sq, H * Dh) @ wo
```

```asm
; @launch grid=(256,1,1) block=(512,1,1) lds=163840
.amdgcn_target "amdgcn-amd-amdhsa--gfx950"
.text
.globl standalone__mha_block_cached__near_ridge_kernel
.p2align 8
.type standalone__mha_block_cached__near_ridge_kernel,@function
standalone__mha_block_cached__near_ridge_kernel:
s_cmp_ge_u32 s2, 256
s_cbranch_scc1 A_end
s_load_dwordx4 s[4:7], s[0:1], 0
s_load_dwordx4 s[8:11], s[0:1], 16
s_load_dwordx2 s[14:15], s[0:1], 32
s_load_dwordx2 s[12:13], s[0:1], 56
s_load_dwordx4 s[72:75], s[0:1], 40
v_cmp_gt_u32 vcc, 14, v0
s_nop 3
s_and_saveexec_b64 s[78:79], vcc
s_cbranch_execz CPF_done
s_getpc_b64 s[76:77]
PCREF:
s_sub_u32 s76, s76, PCREF-standalone__mha_block_cached__near_ridge_kernel
s_subb_u32 s77, s77, 0
s_lshr_b32 s38, s2, 3
s_mul_i32 s38, s38, 14
v_add_u32 v7, s38, v0
v_lshlrev_b32 v7, 7, v7
v_min_u32 v7, A_end-standalone__mha_block_cached__near_ridge_kernel, v7
global_load_dword v127, v7, s[76:77]
CPF_done:
s_mov_b64 exec, s[78:79]
v_lshrrev_b32 v1, 6, v0
v_and_b32 v2, 63, v0
v_readfirstlane_b32 s3, v1
s_and_b32 s37, s2, 3
s_lshl_b32 s37, s37, 1
s_bfe_u32 s38, s2, 0x10003
s_add_u32 s37, s37, s38
s_bfe_u32 s36, s2, 0x10002
s_lshl_b32 s36, s36, 4
s_lshr_b32 s38, s2, 4
s_add_u32 s36, s36, s38
s_waitcnt lgkmcnt(0)
s_mov_b32 s16, s4
s_and_b32 s17, s5, 0xffff
s_mov_b32 s18, 2359296
s_mov_b32 s19, 0x20000
s_mov_b32 s20, s6
s_and_b32 s21, s7, 0xffff
s_mov_b32 s22, 134217728
s_mov_b32 s23, 0x20000
s_mov_b32 s24, s8
s_and_b32 s25, s9, 0xffff
s_mov_b32 s26, 134217728
s_mov_b32 s27, 0x20000
s_mov_b32 s28, s10
s_and_b32 s29, s11, 0xffff
s_mov_b32 s30, 4718592
s_mov_b32 s31, 0x20000
s_mov_b32 s32, s12
s_and_b32 s33, s13, 0xffff
s_mov_b32 s34, 18874368
s_mov_b32 s35, 0x20000
s_mov_b32 s64, s14
s_and_b32 s65, s15, 0xffff
s_mov_b32 s66, 4718592
s_mov_b32 s67, 0x20000
s_lshl_b32 s38, s36, 3
s_add_u32 s38, s38, s37
s_mul_i32 s62, s38, 73728
s_mov_b32 s69, s3
s_and_b32 s42, s3, 1
s_bfe_u32 s43, s3, 0x10001
v_lshrrev_b32 v3, 5, v2
v_bfe_u32 v4, v2, 4, 1
v_bfe_u32 v5, v2, 2, 2
v_and_b32 v6, 3, v2
s_cmp_ge_u32 s3, 4
s_cbranch_scc0 A_start
s_sub_u32 s3, s3, 4
s_lshl_b32 s50, s37, 10
v_lshrrev_b32 v10, 4, v2
v_and_b32 v11, 15, v2
s_lshl_b32 s38, s3, 4
v_add_u32 v12, s38, v10
v_lshlrev_b32 v13, 2, v10
v_xor_b32 v13, v13, v11
v_lshlrev_b32 v13, 4, v13
v_lshlrev_b32 v14, 13, v12
v_add_u32 v137, v14, v13
v_add_u32 v138, 31744, v137
v_add_u32 v139, 63488, v137
v_add_u32 v140, 95232, v137
s_lshl_b32 s48, s3, 12
s_add_u32 s48, s48, 32768
v_lshrrev_b32 v7, 3, v2
s_lshl_b32 s38, s3, 4
v_add_u32 v7, s38, v7
v_bfe_u32 v8, v7, 1, 3
v_and_b32 v10, 7, v2
v_xor_b32 v8, v8, v10
v_lshlrev_b32 v8, 4, v8
v_mul_u32_u24 v7, 1152, v7
v_add_u32 v158, v7, v8
v_add_u32 v159, 9216, v7
v_xor_b32 v8, 64, v8
v_add_u32 v159, v159, v8
s_mul_i32 s59, s36, 73728
s_lshl_b32 s41, s3, 11
s_and_b32 s51, s36, 15
s_mul_i32 s51, s51, 36
s_mul_i32 s52, s3, 9
s_add_u32 s51, s51, s52
v_lshrrev_b32 v10, 2, v2
v_min_u32 v10, 8, v10
v_add_u32 v10, s51, v10
v_lshlrev_b32 v10, 13, v10
v_and_b32 v11, 3, v2
v_lshlrev_b32 v11, 7, v11
v_add_u32 v149, v10, v11
buffer_load_dword v148, v149, s[28:31], s50 offen
v_add_u32 v131, 512, v149
s_add_u32 m0, s48, 0
s_add_u32 s53, s50, 0
buffer_load_dwordx4 v137, s[28:31], s53 offen offset:0 lds
buffer_load_dwordx4 v138, s[28:31], s53 offen offset:1024 lds
buffer_load_dwordx4 v139, s[28:31], s53 offen offset:2048 lds
buffer_load_dwordx4 v140, s[28:31], s53 offen offset:3072 lds
s_add_u32 m0, s41, 0
s_add_u32 s53, s59, 0
buffer_load_dwordx4 v158, s[16:19], s53 offen lds
s_add_u32 m0, s41, 1024
s_add_u32 s53, s59, 0
buffer_load_dwordx4 v159, s[16:19], s53 offen lds
s_add_u32 m0, s41, 8192
s_add_u32 s53, s59, 128
buffer_load_dwordx4 v158, s[16:19], s53 offen lds
s_add_u32 m0, s41, 9216
s_add_u32 s53, s59, 128
buffer_load_dwordx4 v159, s[16:19], s53 offen lds
s_add_u32 m0, s41, 16384
s_add_u32 s53, s59, 256
buffer_load_dwordx4 v158, s[16:19], s53 offen lds
s_add_u32 m0, s41, 17408
s_add_u32 s53, s59, 256
buffer_load_dwordx4 v159, s[16:19], s53 offen lds
s_add_u32 m0, s41, 24576
s_add_u32 s53, s59, 384
buffer_load_dwordx4 v158, s[16:19], s53 offen lds
s_add_u32 m0, s41, 25600
s_add_u32 s53, s59, 384
buffer_load_dwordx4 v159, s[16:19], s53 offen lds
s_add_u32 m0, s41, 114688
s_add_u32 s53, s59, 512
buffer_load_dwordx4 v158, s[16:19], s53 offen lds
s_add_u32 m0, s41, 115712
s_add_u32 s53, s59, 512
buffer_load_dwordx4 v159, s[16:19], s53 offen lds
s_add_u32 m0, s41, 122880
s_add_u32 s53, s59, 640
buffer_load_dwordx4 v158, s[16:19], s53 offen lds
s_add_u32 m0, s41, 123904
s_add_u32 s53, s59, 640
buffer_load_dwordx4 v159, s[16:19], s53 offen lds
s_add_u32 m0, s41, 131072
s_add_u32 s53, s59, 768
buffer_load_dwordx4 v158, s[16:19], s53 offen lds
s_add_u32 m0, s41, 132096
s_add_u32 s53, s59, 768
buffer_load_dwordx4 v159, s[16:19], s53 offen lds
s_add_u32 m0, s41, 139264
s_add_u32 s53, s59, 896
buffer_load_dwordx4 v158, s[16:19], s53 offen lds
s_add_u32 m0, s41, 140288
s_add_u32 s53, s59, 896
buffer_load_dwordx4 v159, s[16:19], s53 offen lds
s_add_u32 m0, s41, 147456
s_add_u32 s53, s59, 1024
buffer_load_dwordx4 v158, s[16:19], s53 offen lds
s_add_u32 m0, s41, 148480
s_add_u32 s53, s59, 1024
buffer_load_dwordx4 v159, s[16:19], s53 offen lds
s_add_u32 m0, s48, 32768
s_add_u32 s53, s50, 524288
buffer_load_dwordx4 v137, s[28:31], s53 offen offset:0 lds
buffer_load_dwordx4 v138, s[28:31], s53 offen offset:1024 lds
buffer_load_dwordx4 v139, s[28:31], s53 offen offset:2048 lds
buffer_load_dwordx4 v140, s[28:31], s53 offen offset:3072 lds
s_branch P_start
A_start:
v_lshrrev_b32 v10, 4, v2
v_and_b32 v11, 15, v2
s_lshl_b32 s38, s3, 4
v_add_u32 v12, s38, v10
v_lshlrev_b32 v13, 2, v10
v_xor_b32 v13, v13, v11
v_lshlrev_b32 v13, 4, v13
v_lshlrev_b32 v14, 13, v12
v_add_u32 v154, v14, v13
s_lshl_b32 s50, s37, 10
s_lshl_b32 s48, s3, 12
s_add_u32 s48, s48, 32768
s_add_u32 m0, s48, 16384
s_add_u32 s58, s50, 256
buffer_load_dwordx4 v154, s[28:31], s58 offen offset:0 lds
s_add_u32 s58, s50, 32000
buffer_load_dwordx4 v154, s[28:31], s58 offen offset:1024 lds
s_add_u32 s58, s50, 63744
buffer_load_dwordx4 v154, s[28:31], s58 offen offset:2048 lds
s_add_u32 s58, s50, 95488
buffer_load_dwordx4 v154, s[28:31], s58 offen offset:3072 lds
s_cmp_eq_u32 s3, 1
s_cbranch_scc0 TLB0_done
s_mov_b64 exec, 1
s_lshl_b32 s38, s36, 5
s_lshl_b32 s39, s37, 2
s_add_u32 s38, s38, s39
s_lshl_b32 s38, s38, 17
v_mov_b32 v7, s38
global_load_dword v126, v7, s[6:7] nt
global_load_dword v125, v7, s[8:9] nt
s_mul_i32 s38, s37, 589824
v_mov_b32 v8, s38
global_load_dword v124, v8, s[14:15]
s_mov_b64 exec, -1
TLB0_done:
v_and_b32 v7, 31, v2
s_lshl_b32 s38, s43, 5
v_add_u32 v8, s38, v7
v_lshlrev_b32 v8, 8, v8
v_and_b32 v7, 15, v7
v_xor_b32 v7, v7, v3
v_lshlrev_b32 v7, 4, v7
v_add_u32 v152, v8, v7
v_lshlrev_b32 v7, 2, v3
v_add_u32 v7, v7, v5
v_add_u32 v7, s38, v7
v_lshlrev_b32 v7, 8, v7
v_lshlrev_b32 v8, 1, v4
v_lshrrev_b32 v9, 1, v6
v_add_u32 v8, v8, v9
v_lshlrev_b32 v9, 2, v5
v_xor_b32 v8, v8, v9
v_lshlrev_b32 v8, 4, v8
v_and_b32 v9, 1, v6
v_lshlrev_b32 v9, 3, v9
v_add_u32 v7, v7, v8
v_add_u32 v153, v7, v9
s_lshl_b32 s51, s42, 13
s_lshl_b32 s52, s43, 12
s_add_u32 s52, s52, s51
s_xor_b32 s53, s52, 4096
s_lshl_b32 s54, s3, 8
s_xor_b32 s55, s54, 512
s_mov_b32 s44, 0x3e0293ee
s_mov_b32 s45, s44
s_mov_b32 s47, 1
s_mov_b32 s68, 0
v_lshlrev_b32 v7, 3, v3
v_add_u32 v7, v7, v5
v_lshlrev_b32 v7, 8, v7
v_lshlrev_b32 v8, 1, v4
v_and_b32 v10, 1, v6
v_add_u32 v8, v8, v10
v_lshlrev_b32 v10, 2, v5
v_xor_b32 v8, v8, v10
v_lshlrev_b32 v8, 4, v8
v_lshrrev_b32 v10, 1, v6
v_lshlrev_b32 v10, 3, v10
v_add_u32 v7, v7, v8
v_add_u32 v7, v7, v10
s_lshl_b32 s38, s43, 7
v_xor_b32 v158, s38, v7
v_and_b32 v10, 31, v2
s_lshl_b32 s38, s42, 5
v_add_u32 v10, s38, v10
v_bfe_u32 v11, v10, 1, 3
v_xor_b32 v12, v3, v11
v_lshlrev_b32 v10, 7, v10
v_lshlrev_b32 v12, 4, v12
v_add_u32 v156, v10, v12
v_add_u32 v159, 114688, v156
s_mov_b32 s68, 0
s_barrier
s_add_u32 m0, s48, 49152
s_add_u32 s58, s50, 524544
buffer_load_dwordx4 v154, s[28:31], s58 offen offset:0 lds
s_add_u32 s58, s50, 556288
buffer_load_dwordx4 v154, s[28:31], s58 offen offset:1024 lds
s_add_u32 s58, s50, 588032
buffer_load_dwordx4 v154, s[28:31], s58 offen offset:2048 lds
s_add_u32 s58, s50, 619776
buffer_load_dwordx4 v154, s[28:31], s58 offen offset:3072 lds
s_waitcnt vmcnt(4)
s_barrier
v_add_u32 v144, 49152, v158
v_xor_b32 v145, 64, v144
ds_read_b128 v[0:3], v156 offset:0
v_xor_b32 v157, 32, v156
ds_read_b128 v[4:7], v157 offset:0
v_xor_b32 v157, 64, v156
ds_read_b128 v[8:11], v157 offset:0
v_xor_b32 v157, 96, v156
ds_read_b128 v[12:15], v157 offset:0
ds_read_b64_tr_b16 v[128:129], v144 offset:0
ds_read_b64_tr_b16 v[130:131], v144 offset:1024
ds_read_b64_tr_b16 v[132:133], v145 offset:0
ds_read_b64_tr_b16 v[134:135], v145 offset:1024
ds_read_b64_tr_b16 v[136:137], v144 offset:4096
ds_read_b64_tr_b16 v[138:139], v144 offset:5120
ds_read_b64_tr_b16 v[140:141], v145 offset:4096
ds_read_b64_tr_b16 v[142:143], v145 offset:5120
s_barrier
ds_read_b64_tr_b16 a[64:65], v144 offset:8192
ds_read_b64_tr_b16 a[66:67], v144 offset:9216
s_waitcnt lgkmcnt(8)
v_mfma_f32_32x32x16_bf16 a[32:47], v[128:131], v[0:3], 0
ds_read_b64_tr_b16 a[68:69], v145 offset:8192
ds_read_b64_tr_b16 a[70:71], v145 offset:9216
ds_read_b64_tr_b16 a[72:73], v144 offset:12288
ds_read_b64_tr_b16 a[74:75], v144 offset:13312
ds_read_b64_tr_b16 a[76:77], v145 offset:12288
ds_read_b64_tr_b16 a[78:79], v145 offset:13312
s_waitcnt lgkmcnt(12)
v_mfma_f32_32x32x16_bf16 a[48:63], v[132:135], v[0:3], 0
s_waitcnt lgkmcnt(10)
v_mfma_f32_32x32x16_bf16 a[32:47], v[136:139], v[4:7], a[32:47]
s_waitcnt lgkmcnt(8)
v_mfma_f32_32x32x16_bf16 a[48:63], v[140:143], v[4:7], a[48:63]
s_waitcnt lgkmcnt(0)
s_add_u32 m0, s48, 0
s_add_u32 s58, s50, 1048832
buffer_load_dwordx4 v154, s[28:31], s58 offen offset:0 lds
s_add_u32 s58, s50, 1080576
buffer_load_dwordx4 v154, s[28:31], s58 offen offset:1024 lds
s_add_u32 s58, s50, 1112320
buffer_load_dwordx4 v154, s[28:31], s58 offen offset:2048 lds
s_add_u32 s58, s50, 1144064
buffer_load_dwordx4 v154, s[28:31], s58 offen offset:3072 lds
s_waitcnt vmcnt(4)
s_barrier
v_add_u32 v144, 81920, v158
v_xor_b32 v145, 64, v144
ds_read_b128 v[16:19], v156 offset:8192
v_xor_b32 v157, 32, v156
ds_read_b128 v[20:23], v157 offset:8192
v_xor_b32 v157, 64, v156
ds_read_b128 v[24:27], v157 offset:8192
v_xor_b32 v157, 96, v156
ds_read_b128 v[28:31], v157 offset:8192
ds_read_b64_tr_b16 v[128:129], v144 offset:0
ds_read_b64_tr_b16 v[130:131], v144 offset:1024
ds_read_b64_tr_b16 v[132:133], v145 offset:0
ds_read_b64_tr_b16 v[134:135], v145 offset:1024
ds_read_b64_tr_b16 v[136:137], v144 offset:4096
ds_read_b64_tr_b16 v[138:139], v144 offset:5120
ds_read_b64_tr_b16 v[140:141], v145 offset:4096
ds_read_b64_tr_b16 v[142:143], v145 offset:5120
v_mfma_f32_32x32x16_bf16 a[32:47], a[64:67], v[8:11], a[32:47]
s_waitcnt lgkmcnt(0)
s_barrier
ds_read_b64_tr_b16 a[64:65], v144 offset:8192
ds_read_b64_tr_b16 a[66:67], v144 offset:9216
v_mfma_f32_32x32x16_bf16 a[48:63], a[68:71], v[8:11], a[48:63]
ds_read_b64_tr_b16 a[68:69], v145 offset:8192
ds_read_b64_tr_b16 a[70:71], v145 offset:9216
v_mfma_f32_32x32x16_bf16 a[32:47], a[72:75], v[12:15], a[32:47]
ds_read_b64_tr_b16 a[72:73], v144 offset:12288
ds_read_b64_tr_b16 a[74:75], v144 offset:13312
v_mfma_f32_32x32x16_bf16 a[48:63], a[76:79], v[12:15], a[48:63]
ds_read_b64_tr_b16 a[76:77], v145 offset:12288
ds_read_b64_tr_b16 a[78:79], v145 offset:13312
v_mfma_f32_32x32x16_bf16 a[32:47], v[128:131], v[16:19], a[32:47]
s_waitcnt lgkmcnt(0)
s_add_u32 m0, s48, 32768
s_add_u32 s58, s50, 1573120
buffer_load_dwordx4 v154, s[28:31], s58 offen offset:0 lds
s_add_u32 s58, s50, 1604864
buffer_load_dwordx4 v154, s[28:31], s58 offen offset:1024 lds
s_add_u32 s58, s50, 1636608
buffer_load_dwordx4 v154, s[28:31], s58 offen offset:2048 lds
s_add_u32 s58, s50, 1668352
buffer_load_dwordx4 v154, s[28:31], s58 offen offset:3072 lds
s_waitcnt vmcnt(4)
s_barrier
v_add_u32 v144, 32768, v158
v_xor_b32 v145, 64, v144
ds_read_b128 v[32:35], v156 offset:16384
v_xor_b32 v157, 32, v156
ds_read_b128 v[36:39], v157 offset:16384
v_xor_b32 v157, 64, v156
ds_read_b128 v[40:43], v157 offset:16384
v_xor_b32 v157, 96, v156
ds_read_b128 v[44:47], v157 offset:16384
ds_read_b64_tr_b16 v[128:129], v144 offset:0
ds_read_b64_tr_b16 v[130:131], v144 offset:1024
v_mfma_f32_32x32x16_bf16 a[48:63], v[132:135], v[16:19], a[48:63]
ds_read_b64_tr_b16 v[132:133], v145 offset:0
ds_read_b64_tr_b16 v[134:135], v145 offset:1024
v_mfma_f32_32x32x16_bf16 a[32:47], v[136:139], v[20:23], a[32:47]
ds_read_b64_tr_b16 v[136:137], v144 offset:4096
ds_read_b64_tr_b16 v[138:139], v144 offset:5120
v_mfma_f32_32x32x16_bf16 a[48:63], v[140:143], v[20:23], a[48:63]
ds_read_b64_tr_b16 v[140:141], v145 offset:4096
ds_read_b64_tr_b16 v[142:143], v145 offset:5120
v_mfma_f32_32x32x16_bf16 a[32:47], a[64:67], v[24:27], a[32:47]
s_waitcnt lgkmcnt(0)
s_barrier
ds_read_b64_tr_b16 a[64:65], v144 offset:8192
ds_read_b64_tr_b16 a[66:67], v144 offset:9216
v_mfma_f32_32x32x16_bf16 a[48:63], a[68:71], v[24:27], a[48:63]
ds_read_b64_tr_b16 a[68:69], v145 offset:8192
ds_read_b64_tr_b16 a[70:71], v145 offset:9216
v_mfma_f32_32x32x16_bf16 a[32:47], a[72:75], v[28:31], a[32:47]
ds_read_b64_tr_b16 a[72:73], v144 offset:12288
ds_read_b64_tr_b16 a[74:75], v144 offset:13312
v_mfma_f32_32x32x16_bf16 a[48:63], a[76:79], v[28:31], a[48:63]
ds_read_b64_tr_b16 a[76:77], v145 offset:12288
ds_read_b64_tr_b16 a[78:79], v145 offset:13312
v_mfma_f32_32x32x16_bf16 a[32:47], v[128:131], v[32:35], a[32:47]
s_waitcnt lgkmcnt(0)
s_add_u32 m0, s48, 65536
s_add_u32 s58, s50, 2097408
buffer_load_dwordx4 v154, s[28:31], s58 offen offset:0 lds
s_add_u32 s58, s50, 2129152
buffer_load_dwordx4 v154, s[28:31], s58 offen offset:1024 lds
s_add_u32 s58, s50, 2160896
buffer_load_dwordx4 v154, s[28:31], s58 offen offset:2048 lds
s_add_u32 s58, s50, 2192640
buffer_load_dwordx4 v154, s[28:31], s58 offen offset:3072 lds
s_waitcnt vmcnt(4)
s_barrier
v_add_u32 v144, 65536, v158
v_xor_b32 v145, 64, v144
ds_read_b128 v[48:51], v156 offset:24576
v_xor_b32 v157, 32, v156
ds_read_b128 v[52:55], v157 offset:24576
v_xor_b32 v157, 64, v156
ds_read_b128 v[56:59], v157 offset:24576
v_xor_b32 v157, 96, v156
ds_read_b128 v[60:63], v157 offset:24576
ds_read_b64_tr_b16 v[128:129], v144 offset:0
ds_read_b64_tr_b16 v[130:131], v144 offset:1024
v_mfma_f32_32x32x16_bf16 a[48:63], v[132:135], v[32:35], a[48:63]
ds_read_b64_tr_b16 v[132:133], v145 offset:0
ds_read_b64_tr_b16 v[134:135], v145 offset:1024
v_mfma_f32_32x32x16_bf16 a[32:47], v[136:139], v[36:39], a[32:47]
ds_read_b64_tr_b16 v[136:137], v144 offset:4096
ds_read_b64_tr_b16 v[138:139], v144 offset:5120
v_mfma_f32_32x32x16_bf16 a[48:63], v[140:143], v[36:39], a[48:63]
ds_read_b64_tr_b16 v[140:141], v145 offset:4096
ds_read_b64_tr_b16 v[142:143], v145 offset:5120
v_mfma_f32_32x32x16_bf16 a[32:47], a[64:67], v[40:43], a[32:47]
s_waitcnt lgkmcnt(0)
s_barrier
ds_read_b64_tr_b16 a[64:65], v144 offset:8192
ds_read_b64_tr_b16 a[66:67], v144 offset:9216
v_mfma_f32_32x32x16_bf16 a[48:63], a[68:71], v[40:43], a[48:63]
ds_read_b64_tr_b16 a[68:69], v145 offset:8192
ds_read_b64_tr_b16 a[70:71], v145 offset:9216
v_mfma_f32_32x32x16_bf16 a[32:47], a[72:75], v[44:47], a[32:47]
ds_read_b64_tr_b16 a[72:73], v144 offset:12288
ds_read_b64_tr_b16 a[74:75], v144 offset:13312
v_mfma_f32_32x32x16_bf16 a[48:63], a[76:79], v[44:47], a[48:63]
ds_read_b64_tr_b16 a[76:77], v145 offset:12288
ds_read_b64_tr_b16 a[78:79], v145 offset:13312
v_mfma_f32_32x32x16_bf16 a[32:47], v[128:131], v[48:51], a[32:47]
s_waitcnt lgkmcnt(0)
s_add_u32 m0, s48, 16384
s_add_u32 s58, s50, 2621696
buffer_load_dwordx4 v154, s[28:31], s58 offen offset:0 lds
s_add_u32 s58, s50, 2653440
buffer_load_dwordx4 v154, s[28:31], s58 offen offset:1024 lds
s_add_u32 s58, s50, 2685184
buffer_load_dwordx4 v154, s[28:31], s58 offen offset:2048 lds
s_add_u32 s58, s50, 2716928
buffer_load_dwordx4 v154, s[28:31], s58 offen offset:3072 lds
s_waitcnt vmcnt(4)
s_barrier
v_add_u32 v144, 98304, v158
v_xor_b32 v145, 64, v144
ds_read_b128 v[64:67], v159 offset:0
v_xor_b32 v157, 32, v159
ds_read_b128 v[68:71], v157 offset:0
v_xor_b32 v157, 64, v159
ds_read_b128 v[72:75], v157 offset:0
v_xor_b32 v157, 96, v159
ds_read_b128 v[76:79], v157 offset:0
ds_read_b64_tr_b16 v[128:129], v144 offset:0
ds_read_b64_tr_b16 v[130:131], v144 offset:1024
v_mfma_f32_32x32x16_bf16 a[48:63], v[132:135], v[48:51], a[48:63]
ds_read_b64_tr_b16 v[132:133], v145 offset:0
ds_read_b64_tr_b16 v[134:135], v145 offset:1024
v_mfma_f32_32x32x16_bf16 a[32:47], v[136:139], v[52:55], a[32:47]
ds_read_b64_tr_b16 v[136:137], v144 offset:4096
ds_read_b64_tr_b16 v[138:139], v144 offset:5120
v_mfma_f32_32x32x16_bf16 a[48:63], v[140:143], v[52:55], a[48:63]
ds_read_b64_tr_b16 v[140:141], v145 offset:4096
ds_read_b64_tr_b16 v[142:143], v145 offset:5120
v_mfma_f32_32x32x16_bf16 a[32:47], a[64:67], v[56:59], a[32:47]
s_waitcnt lgkmcnt(0)
s_barrier
ds_read_b64_tr_b16 a[64:65], v144 offset:8192
ds_read_b64_tr_b16 a[66:67], v144 offset:9216
v_mfma_f32_32x32x16_bf16 a[48:63], a[68:71], v[56:59], a[48:63]
ds_read_b64_tr_b16 a[68:69], v145 offset:8192
ds_read_b64_tr_b16 a[70:71], v145 offset:9216
v_mfma_f32_32x32x16_bf16 a[32:47], a[72:75], v[60:63], a[32:47]
ds_read_b64_tr_b16 a[72:73], v144 offset:12288
ds_read_b64_tr_b16 a[74:75], v144 offset:13312
v_mfma_f32_32x32x16_bf16 a[48:63], a[76:79], v[60:63], a[48:63]
ds_read_b64_tr_b16 a[76:77], v145 offset:12288
ds_read_b64_tr_b16 a[78:79], v145 offset:13312
v_mfma_f32_32x32x16_bf16 a[32:47], v[128:131], v[64:67], a[32:47]
s_waitcnt lgkmcnt(0)
s_add_u32 m0, s48, 49152
s_add_u32 s58, s50, 3145984
buffer_load_dwordx4 v154, s[28:31], s58 offen offset:0 lds
s_add_u32 s58, s50, 3177728
buffer_load_dwordx4 v154, s[28:31], s58 offen offset:1024 lds
s_add_u32 s58, s50, 3209472
buffer_load_dwordx4 v154, s[28:31], s58 offen offset:2048 lds
s_add_u32 s58, s50, 3241216
buffer_load_dwordx4 v154, s[28:31], s58 offen offset:3072 lds
s_waitcnt vmcnt(4)
s_barrier
v_add_u32 v144, 49152, v158
v_xor_b32 v145, 64, v144
ds_read_b128 v[80:83], v159 offset:8192
v_xor_b32 v157, 32, v159
ds_read_b128 v[84:87], v157 offset:8192
v_xor_b32 v157, 64, v159
ds_read_b128 v[88:91], v157 offset:8192
v_xor_b32 v157, 96, v159
ds_read_b128 v[92:95], v157 offset:8192
ds_read_b64_tr_b16 v[128:129], v144 offset:0
ds_read_b64_tr_b16 v[130:131], v144 offset:1024
v_mfma_f32_32x32x16_bf16 a[48:63], v[132:135], v[64:67], a[48:63]
ds_read_b64_tr_b16 v[132:133], v145 offset:0
ds_read_b64_tr_b16 v[134:135], v145 offset:1024
v_mfma_f32_32x32x16_bf16 a[32:47], v[136:139], v[68:71], a[32:47]
ds_read_b64_tr_b16 v[136:137], v144 offset:4096
ds_read_b64_tr_b16 v[138:139], v144 offset:5120
v_mfma_f32_32x32x16_bf16 a[48:63], v[140:143], v[68:71], a[48:63]
ds_read_b64_tr_b16 v[140:141], v145 offset:4096
ds_read_b64_tr_b16 v[142:143], v145 offset:5120
v_mfma_f32_32x32x16_bf16 a[32:47], a[64:67], v[72:75], a[32:47]
s_waitcnt lgkmcnt(0)
s_barrier
ds_read_b64_tr_b16 a[64:65], v144 offset:8192
ds_read_b64_tr_b16 a[66:67], v144 offset:9216
v_mfma_f32_32x32x16_bf16 a[48:63], a[68:71], v[72:75], a[48:63]
ds_read_b64_tr_b16 a[68:69], v145 offset:8192
ds_read_b64_tr_b16 a[70:71], v145 offset:9216
v_mfma_f32_32x32x16_bf16 a[32:47], a[72:75], v[76:79], a[32:47]
ds_read_b64_tr_b16 a[72:73], v144 offset:12288
ds_read_b64_tr_b16 a[74:75], v144 offset:13312
v_mfma_f32_32x32x16_bf16 a[48:63], a[76:79], v[76:79], a[48:63]
ds_read_b64_tr_b16 a[76:77], v145 offset:12288
ds_read_b64_tr_b16 a[78:79], v145 offset:13312
v_mfma_f32_32x32x16_bf16 a[32:47], v[128:131], v[80:83], a[32:47]
s_waitcnt lgkmcnt(0)
s_add_u32 m0, s48, 0
s_add_u32 s58, s50, 3670272
buffer_load_dwordx4 v154, s[28:31], s58 offen offset:0 lds
s_add_u32 s58, s50, 3702016
buffer_load_dwordx4 v154, s[28:31], s58 offen offset:1024 lds
s_add_u32 s58, s50, 3733760
buffer_load_dwordx4 v154, s[28:31], s58 offen offset:2048 lds
s_add_u32 s58, s50, 3765504
buffer_load_dwordx4 v154, s[28:31], s58 offen offset:3072 lds
s_waitcnt vmcnt(4)
s_barrier
v_add_u32 v144, 81920, v158
v_xor_b32 v145, 64, v144
ds_read_b128 v[96:99], v159 offset:16384
v_xor_b32 v157, 32, v159
ds_read_b128 v[100:103], v157 offset:16384
v_xor_b32 v157, 64, v159
ds_read_b128 v[104:107], v157 offset:16384
v_xor_b32 v157, 96, v159
ds_read_b128 v[108:111], v157 offset:16384
ds_read_b64_tr_b16 v[128:129], v144 offset:0
ds_read_b64_tr_b16 v[130:131], v144 offset:1024
v_mfma_f32_32x32x16_bf16 a[48:63], v[132:135], v[80:83], a[48:63]
ds_read_b64_tr_b16 v[132:133], v145 offset:0
ds_read_b64_tr_b16 v[134:135], v145 offset:1024
v_mfma_f32_32x32x16_bf16 a[32:47], v[136:139], v[84:87], a[32:47]
ds_read_b64_tr_b16 v[136:137], v144 offset:4096
ds_read_b64_tr_b16 v[138:139], v144 offset:5120
v_mfma_f32_32x32x16_bf16 a[48:63], v[140:143], v[84:87], a[48:63]
ds_read_b64_tr_b16 v[140:141], v145 offset:4096
ds_read_b64_tr_b16 v[142:143], v145 offset:5120
v_mfma_f32_32x32x16_bf16 a[32:47], a[64:67], v[88:91], a[32:47]
s_waitcnt lgkmcnt(0)
s_barrier
ds_read_b64_tr_b16 a[64:65], v144 offset:8192
ds_read_b64_tr_b16 a[66:67], v144 offset:9216
v_mfma_f32_32x32x16_bf16 a[48:63], a[68:71], v[88:91], a[48:63]
ds_read_b64_tr_b16 a[68:69], v145 offset:8192
ds_read_b64_tr_b16 a[70:71], v145 offset:9216
v_mfma_f32_32x32x16_bf16 a[32:47], a[72:75], v[92:95], a[32:47]
ds_read_b64_tr_b16 a[72:73], v144 offset:12288
ds_read_b64_tr_b16 a[74:75], v144 offset:13312
v_mfma_f32_32x32x16_bf16 a[48:63], a[76:79], v[92:95], a[48:63]
ds_read_b64_tr_b16 a[76:77], v145 offset:12288
ds_read_b64_tr_b16 a[78:79], v145 offset:13312
v_mfma_f32_32x32x16_bf16 a[32:47], v[128:131], v[96:99], a[32:47]
s_waitcnt lgkmcnt(0)
s_add_u32 m0, s48, 32768
s_add_u32 s58, s50, 4194560
buffer_load_dwordx4 v154, s[28:31], s58 offen offset:0 lds
s_add_u32 s58, s50, 4226304
buffer_load_dwordx4 v154, s[28:31], s58 offen offset:1024 lds
s_add_u32 s58, s50, 4258048
buffer_load_dwordx4 v154, s[28:31], s58 offen offset:2048 lds
s_add_u32 s58, s50, 4289792
buffer_load_dwordx4 v154, s[28:31], s58 offen offset:3072 lds
s_waitcnt vmcnt(4)
s_barrier
v_add_u32 v144, 32768, v158
v_xor_b32 v145, 64, v144
ds_read_b128 v[112:115], v159 offset:24576
v_xor_b32 v157, 32, v159
ds_read_b128 v[116:119], v157 offset:24576
v_xor_b32 v157, 64, v159
ds_read_b128 v[120:123], v157 offset:24576
v_xor_b32 v157, 96, v159
ds_read_b128 v[124:127], v157 offset:24576
ds_read_b64_tr_b16 v[128:129], v144 offset:0
ds_read_b64_tr_b16 v[130:131], v144 offset:1024
v_mfma_f32_32x32x16_bf16 a[48:63], v[132:135], v[96:99], a[48:63]
ds_read_b64_tr_b16 v[132:133], v145 offset:0
ds_read_b64_tr_b16 v[134:135], v145 offset:1024
v_mfma_f32_32x32x16_bf16 a[32:47], v[136:139], v[100:103], a[32:47]
ds_read_b64_tr_b16 v[136:137], v144 offset:4096
ds_read_b64_tr_b16 v[138:139], v144 offset:5120
v_mfma_f32_32x32x16_bf16 a[48:63], v[140:143], v[100:103], a[48:63]
ds_read_b64_tr_b16 v[140:141], v145 offset:4096
ds_read_b64_tr_b16 v[142:143], v145 offset:5120
v_mfma_f32_32x32x16_bf16 a[32:47], a[64:67], v[104:107], a[32:47]
s_waitcnt lgkmcnt(0)
s_barrier
ds_read_b64_tr_b16 a[64:65], v144 offset:8192
ds_read_b64_tr_b16 a[66:67], v144 offset:9216
v_mfma_f32_32x32x16_bf16 a[48:63], a[68:71], v[104:107], a[48:63]
ds_read_b64_tr_b16 a[68:69], v145 offset:8192
ds_read_b64_tr_b16 a[70:71], v145 offset:9216
v_mfma_f32_32x32x16_bf16 a[32:47], a[72:75], v[108:111], a[32:47]
ds_read_b64_tr_b16 a[72:73], v144 offset:12288
ds_read_b64_tr_b16 a[74:75], v144 offset:13312
v_mfma_f32_32x32x16_bf16 a[48:63], a[76:79], v[108:111], a[48:63]
ds_read_b64_tr_b16 a[76:77], v145 offset:12288
ds_read_b64_tr_b16 a[78:79], v145 offset:13312
v_mfma_f32_32x32x16_bf16 a[32:47], v[128:131], v[112:115], a[32:47]
s_waitcnt lgkmcnt(0)
s_waitcnt vmcnt(0)
s_barrier
v_add_u32 v144, 65536, v158
v_xor_b32 v145, 64, v144
ds_read_b128 a[0:3], v159 offset:32768
v_xor_b32 v157, 32, v159
ds_read_b128 a[4:7], v157 offset:32768
v_xor_b32 v157, 64, v159
ds_read_b128 a[8:11], v157 offset:32768
v_xor_b32 v157, 96, v159
ds_read_b128 a[12:15], v157 offset:32768
ds_read_b64_tr_b16 v[128:129], v144 offset:0
ds_read_b64_tr_b16 v[130:131], v144 offset:1024
v_mfma_f32_32x32x16_bf16 a[48:63], v[132:135], v[112:115], a[48:63]
ds_read_b64_tr_b16 v[132:133], v145 offset:0
ds_read_b64_tr_b16 v[134:135], v145 offset:1024
v_mfma_f32_32x32x16_bf16 a[32:47], v[136:139], v[116:119], a[32:47]
ds_read_b64_tr_b16 v[136:137], v144 offset:4096
ds_read_b64_tr_b16 v[138:139], v144 offset:5120
v_mfma_f32_32x32x16_bf16 a[48:63], v[140:143], v[116:119], a[48:63]
ds_read_b64_tr_b16 v[140:141], v145 offset:4096
ds_read_b64_tr_b16 v[142:143], v145 offset:5120
v_mfma_f32_32x32x16_bf16 a[32:47], a[64:67], v[120:123], a[32:47]
s_waitcnt lgkmcnt(0)
s_barrier
ds_read_b64_tr_b16 a[64:65], v144 offset:8192
ds_read_b64_tr_b16 a[66:67], v144 offset:9216
v_mfma_f32_32x32x16_bf16 a[48:63], a[68:71], v[120:123], a[48:63]
ds_read_b64_tr_b16 a[68:69], v145 offset:8192
ds_read_b64_tr_b16 a[70:71], v145 offset:9216
v_mfma_f32_32x32x16_bf16 a[32:47], a[72:75], v[124:127], a[32:47]
ds_read_b64_tr_b16 a[72:73], v144 offset:12288
ds_read_b64_tr_b16 a[74:75], v144 offset:13312
v_mfma_f32_32x32x16_bf16 a[48:63], a[76:79], v[124:127], a[48:63]
ds_read_b64_tr_b16 a[76:77], v145 offset:12288
ds_read_b64_tr_b16 a[78:79], v145 offset:13312
v_mfma_f32_32x32x16_bf16 a[32:47], v[128:131], a[0:3], a[32:47]
v_mfma_f32_32x32x16_bf16 a[48:63], v[132:135], a[0:3], a[48:63]
v_mfma_f32_32x32x16_bf16 a[32:47], v[136:139], a[4:7], a[32:47]
v_mfma_f32_32x32x16_bf16 a[48:63], v[140:143], a[4:7], a[48:63]
s_waitcnt lgkmcnt(6)
v_mfma_f32_32x32x16_bf16 a[32:47], a[64:67], a[8:11], a[32:47]
s_waitcnt lgkmcnt(4)
v_mfma_f32_32x32x16_bf16 a[48:63], a[68:71], a[8:11], a[48:63]
s_waitcnt lgkmcnt(2)
v_mfma_f32_32x32x16_bf16 a[32:47], a[72:75], a[12:15], a[32:47]
s_waitcnt lgkmcnt(0)
v_mfma_f32_32x32x16_bf16 a[48:63], a[76:79], a[12:15], a[48:63]
s_nop 11
s_add_u32 s56, s52, 16384
v_mbcnt_lo_u32_b32 v155, -1, 0
v_mbcnt_hi_u32_b32 v155, -1, v155
v_lshlrev_b32 v155, 4, v155
v_add_u32 v155, s56, v155
v_accvgpr_read_b32 v128, a32
v_accvgpr_read_b32 v129, a33
v_accvgpr_read_b32 v130, a34
v_accvgpr_read_b32 v131, a35
v_accvgpr_read_b32 v132, a36
v_accvgpr_read_b32 v133, a37
v_accvgpr_read_b32 v134, a38
v_accvgpr_read_b32 v135, a39
v_accvgpr_read_b32 v136, a40
v_accvgpr_read_b32 v137, a41
v_accvgpr_read_b32 v138, a42
v_accvgpr_read_b32 v139, a43
v_accvgpr_read_b32 v140, a44
v_accvgpr_read_b32 v141, a45
v_accvgpr_read_b32 v142, a46
v_accvgpr_read_b32 v143, a47
v_cvt_pk_bf16_f32 v128, v128, v129
v_cvt_pk_bf16_f32 v129, v130, v131
v_cvt_pk_bf16_f32 v130, v132, v133
v_cvt_pk_bf16_f32 v131, v134, v135
v_cvt_pk_bf16_f32 v132, v136, v137
v_cvt_pk_bf16_f32 v133, v138, v139
v_cvt_pk_bf16_f32 v134, v140, v141
v_cvt_pk_bf16_f32 v135, v142, v143
ds_write_b128 v155, v[128:131] offset:0
ds_write_b128 v155, v[132:135] offset:1024
s_nop 1
v_accvgpr_read_b32 v128, a48
v_accvgpr_read_b32 v129, a49
v_accvgpr_read_b32 v130, a50
v_accvgpr_read_b32 v131, a51
v_accvgpr_read_b32 v132, a52
v_accvgpr_read_b32 v133, a53
v_accvgpr_read_b32 v134, a54
v_accvgpr_read_b32 v135, a55
v_accvgpr_read_b32 v136, a56
v_accvgpr_read_b32 v137, a57
v_accvgpr_read_b32 v138, a58
v_accvgpr_read_b32 v139, a59
v_accvgpr_read_b32 v140, a60
v_accvgpr_read_b32 v141, a61
v_accvgpr_read_b32 v142, a62
v_accvgpr_read_b32 v143, a63
v_cvt_pk_bf16_f32 v128, v128, v129
v_cvt_pk_bf16_f32 v129, v130, v131
v_cvt_pk_bf16_f32 v130, v132, v133
v_cvt_pk_bf16_f32 v131, v134, v135
v_cvt_pk_bf16_f32 v132, v136, v137
v_cvt_pk_bf16_f32 v133, v138, v139
v_cvt_pk_bf16_f32 v134, v140, v141
v_cvt_pk_bf16_f32 v135, v142, v143
ds_write_b128 v155, v[128:131] offset:2048
ds_write_b128 v155, v[132:135] offset:3072
s_waitcnt lgkmcnt(0)
s_mov_b32 s49, 19
s_setprio 1
s_cmp_eq_u32 s69, 2
s_cbranch_scc0 INIT_done
s_mov_b64 exec, 1
s_lshl_b32 s38, s36, 7
s_lshl_b32 s39, s37, 2
s_add_u32 s38, s38, s39
s_add_u32 s38, s38, 20971520
v_mov_b32 v155, s38
v_mov_b32 v0, 0
global_store_dword v155, v0, s[12:13] sc1
s_mov_b64 exec, -1
INIT_done:
s_barrier
v_mbcnt_lo_u32_b32 v155, -1, 0
v_mbcnt_hi_u32_b32 v155, -1, v155
v_lshlrev_b32 v155, 4, v155
v_add_u32 v155, s51, v155
ds_read_b128 a[0:3], v155 offset:0
ds_read_b128 a[4:7], v155 offset:1024
ds_read_b128 a[8:11], v155 offset:2048
ds_read_b128 a[12:15], v155 offset:3072
ds_read_b128 a[16:19], v155 offset:4096
ds_read_b128 a[20:23], v155 offset:5120
ds_read_b128 a[24:27], v155 offset:6144
ds_read_b128 a[28:31], v155 offset:7168
s_waitcnt lgkmcnt(0)
s_add_u32 s46, s49, 0
s_and_b32 s46, s46, 7
s_lshl_b32 s46, s46, 14
s_add_u32 s46, s46, 32768
v_add_u32 v144, s46, v152
v_xor_b32 v145, 32, v144
v_xor_b32 v146, 64, v144
v_xor_b32 v147, 96, v144
v_xor_b32 v148, 128, v144
v_xor_b32 v149, 160, v144
v_xor_b32 v150, 192, v144
v_xor_b32 v151, 224, v144
ds_read_b128 v[128:131], v144
ds_read_b128 v[132:135], v145
ds_read_b128 v[136:139], v146
ds_read_b128 v[140:143], v147
ds_read_b128 a[32:35], v148
ds_read_b128 a[36:39], v149
ds_read_b128 a[40:43], v150
ds_read_b128 a[44:47], v151
s_waitcnt lgkmcnt(7)
v_mfma_f32_32x32x16_bf16 v[0:15], v[128:131], a[0:3], 0
s_barrier
s_barrier
s_barrier
s_add_u32 s46, s49, 1
s_and_b32 s46, s46, 7
s_lshl_b32 s46, s46, 14
s_add_u32 s46, s46, 32768
v_add_u32 v144, s46, v152
v_xor_b32 v145, 32, v144
v_xor_b32 v146, 64, v144
v_xor_b32 v147, 96, v144
v_xor_b32 v148, 128, v144
v_xor_b32 v149, 160, v144
v_xor_b32 v150, 192, v144
v_xor_b32 v151, 224, v144
ds_read_b128 v[128:131], v144
s_waitcnt lgkmcnt(7)
v_mfma_f32_32x32x16_bf16 v[0:15], v[132:135], a[4:7], v[0:15]
ds_read_b128 v[132:135], v145
s_waitcnt lgkmcnt(7)
v_mfma_f32_32x32x16_bf16 v[0:15], v[136:139], a[8:11], v[0:15]
ds_read_b128 v[136:139], v146
s_waitcnt lgkmcnt(7)
v_mfma_f32_32x32x16_bf16 v[0:15], v[140:143], a[12:15], v[0:15]
ds_read_b128 v[140:143], v147
s_waitcnt lgkmcnt(7)
v_mfma_f32_32x32x16_bf16 v[0:15], a[32:35], a[16:19], v[0:15]
ds_read_b128 a[32:35], v148
s_waitcnt lgkmcnt(7)
v_mfma_f32_32x32x16_bf16 v[0:15], a[36:39], a[20:23], v[0:15]
ds_read_b128 a[36:39], v149
s_waitcnt lgkmcnt(7)
v_mfma_f32_32x32x16_bf16 v[0:15], a[40:43], a[24:27], v[0:15]
ds_read_b128 a[40:43], v150
s_waitcnt lgkmcnt(7)
v_mfma_f32_32x32x16_bf16 v[0:15], a[44:47], a[28:31], v[0:15]
ds_read_b128 a[44:47], v151
s_waitcnt lgkmcnt(7)
v_mfma_f32_32x32x16_bf16 v[16:31], v[128:131], a[0:3], 0
s_barrier
s_add_u32 s46, s49, 4
s_and_b32 s46, s46, 7
s_lshl_b32 s46, s46, 14
s_add_u32 s46, s46, 32768
v_add_u32 v144, s46, v152
v_xor_b32 v145, 32, v144
v_xor_b32 v146, 64, v144
v_xor_b32 v147, 96, v144
v_xor_b32 v148, 128, v144
v_xor_b32 v149, 160, v144
v_xor_b32 v150, 192, v144
v_xor_b32 v151, 224, v144
ds_read_b128 v[128:131], v144
s_waitcnt lgkmcnt(7)
v_mfma_f32_32x32x16_bf16 v[16:31], v[132:135], a[4:7], v[16:31]
ds_read_b128 v[132:135], v145
s_waitcnt lgkmcnt(7)
v_mfma_f32_32x32x16_bf16 v[16:31], v[136:139], a[8:11], v[16:31]
ds_read_b128 v[136:139], v146
s_waitcnt lgkmcnt(7)
v_mfma_f32_32x32x16_bf16 v[16:31], v[140:143], a[12:15], v[16:31]
ds_read_b128 v[140:143], v147
s_waitcnt lgkmcnt(7)
v_mfma_f32_32x32x16_bf16 v[16:31], a[32:35], a[16:19], v[16:31]
v_max3_f32 v156, v0, v1, v2
ds_read_b128 a[32:35], v148
s_waitcnt lgkmcnt(7)
v_mfma_f32_32x32x16_bf16 v[16:31], a[36:39], a[20:23], v[16:31]
v_max3_f32 v157, v3, v4, v5
v_max3_f32 v156, v156, v6, v7
ds_read_b128 a[36:39], v149
s_waitcnt lgkmcnt(7)
v_mfma_f32_32x32x16_bf16 v[16:31], a[40:43], a[24:27], v[16:31]
v_max3_f32 v157, v157, v8, v9
v_max3_f32 v156, v156, v10, v11
ds_read_b128 a[40:43], v150
s_waitcnt lgkmcnt(7)
v_mfma_f32_32x32x16_bf16 v[16:31], a[44:47], a[28:31], v[16:31]
v_max3_f32 v157, v157, v12, v13
v_max3_f32 v156, v156, v14, v15
ds_read_b128 a[44:47], v151
s_waitcnt lgkmcnt(7)
v_mfma_f32_32x32x16_bf16 v[32:47], v[128:131], a[0:3], 0
s_barrier
s_barrier
s_barrier
s_waitcnt lgkmcnt(0)
s_barrier
s_add_u32 s46, s49, 5
s_and_b32 s46, s46, 7
s_lshl_b32 s46, s46, 14
s_add_u32 s46, s46, 32768
v_add_u32 v144, s46, v152
v_xor_b32 v145, 32, v144
v_xor_b32 v146, 64, v144
v_xor_b32 v147, 96, v144
v_xor_b32 v148, 128, v144
v_xor_b32 v149, 160, v144
v_xor_b32 v150, 192, v144
v_xor_b32 v151, 224, v144
ds_read_b128 v[128:131], v144
v_mfma_f32_32x32x16_bf16 v[32:47], v[132:135], a[4:7], v[32:47]
ds_read_b128 v[132:135], v145
v_mfma_f32_32x32x16_bf16 v[32:47], v[136:139], a[8:11], v[32:47]
ds_read_b128 v[136:139], v146
v_mfma_f32_32x32x16_bf16 v[32:47], v[140:143], a[12:15], v[32:47]
ds_read_b128 v[140:143], v147
v_mfma_f32_32x32x16_bf16 v[32:47], a[32:35], a[16:19], v[32:47]
v_max3_f32 v156, v156, v16, v17
v_max3_f32 v157, v157, v18, v19
ds_read_b128 a[32:35], v148
v_mfma_f32_32x32x16_bf16 v[32:47], a[36:39], a[20:23], v[32:47]
v_max3_f32 v156, v156, v20, v21
v_max3_f32 v157, v157, v22, v23
ds_read_b128 a[36:39], v149
v_mfma_f32_32x32x16_bf16 v[32:47], a[40:43], a[24:27], v[32:47]
v_max3_f32 v156, v156, v24, v25
v_max3_f32 v157, v157, v26, v27
ds_read_b128 a[40:43], v150
v_mfma_f32_32x32x16_bf16 v[32:47], a[44:47], a[28:31], v[32:47]
v_max3_f32 v156, v156, v28, v29
v_max3_f32 v157, v157, v30, v31
ds_read_b128 a[44:47], v151
s_waitcnt lgkmcnt(7)
v_mfma_f32_32x32x16_bf16 v[48:63], v[128:131], a[0:3], 0
s_waitcnt lgkmcnt(0)
s_barrier
s_add_u32 s46, s49, 9
s_and_b32 s46, s46, 7
s_lshl_b32 s46, s46, 14
s_add_u32 s46, s46, 32768
v_add_u32 v144, s46, v152
v_xor_b32 v145, 32, v144
v_xor_b32 v146, 64, v144
v_xor_b32 v147, 96, v144
v_xor_b32 v148, 128, v144
v_xor_b32 v149, 160, v144
v_xor_b32 v150, 192, v144
v_xor_b32 v151, 224, v144
ds_read_b128 v[128:131], v144
v_mfma_f32_32x32x16_bf16 v[48:63], v[132:135], a[4:7], v[48:63]
ds_read_b128 v[132:135], v145
v_mfma_f32_32x32x16_bf16 v[48:63], v[136:139], a[8:11], v[48:63]
ds_read_b128 v[136:139], v146
v_mfma_f32_32x32x16_bf16 v[48:63], v[140:143], a[12:15], v[48:63]
ds_read_b128 v[140:143], v147
v_mfma_f32_32x32x16_bf16 v[48:63], a[32:35], a[16:19], v[48:63]
v_max3_f32 v156, v156, v32, v33
v_max3_f32 v157, v157, v34, v35
ds_read_b128 a[32:35], v148
v_mfma_f32_32x32x16_bf16 v[48:63], a[36:39], a[20:23], v[48:63]
v_max3_f32 v156, v156, v36, v37
v_max3_f32 v157, v157, v38, v39
ds_read_b128 a[36:39], v149
v_mfma_f32_32x32x16_bf16 v[48:63], a[40:43], a[24:27], v[48:63]
v_max3_f32 v156, v156, v40, v41
v_max3_f32 v157, v157, v42, v43
ds_read_b128 a[40:43], v150
v_mfma_f32_32x32x16_bf16 v[48:63], a[44:47], a[28:31], v[48:63]
v_max3_f32 v156, v156, v44, v45
v_max3_f32 v157, v157, v46, v47
ds_read_b128 a[44:47], v151
s_waitcnt lgkmcnt(7)
v_mfma_f32_32x32x16_bf16 v[64:79], v[128:131], a[0:3], 0
s_barrier
s_barrier
s_barrier
s_add_u32 s46, s49, 10
s_and_b32 s46, s46, 7
s_lshl_b32 s46, s46, 14
s_add_u32 s46, s46, 32768
v_add_u32 v144, s46, v152
v_xor_b32 v145, 32, v144
v_xor_b32 v146, 64, v144
v_xor_b32 v147, 96, v144
v_xor_b32 v148, 128, v144
v_xor_b32 v149, 160, v144
v_xor_b32 v150, 192, v144
v_xor_b32 v151, 224, v144
ds_read_b128 v[128:131], v144
s_waitcnt lgkmcnt(7)
v_mfma_f32_32x32x16_bf16 v[64:79], v[132:135], a[4:7], v[64:79]
ds_read_b128 v[132:135], v145
s_waitcnt lgkmcnt(7)
v_mfma_f32_32x32x16_bf16 v[64:79], v[136:139], a[8:11], v[64:79]
ds_read_b128 v[136:139], v146
s_waitcnt lgkmcnt(7)
v_mfma_f32_32x32x16_bf16 v[64:79], v[140:143], a[12:15], v[64:79]
ds_read_b128 v[140:143], v147
s_waitcnt lgkmcnt(7)
v_mfma_f32_32x32x16_bf16 v[64:79], a[32:35], a[16:19], v[64:79]
v_max3_f32 v156, v156, v48, v49
v_max3_f32 v157, v157, v50, v51
ds_read_b128 a[32:35], v148
s_waitcnt lgkmcnt(7)
v_mfma_f32_32x32x16_bf16 v[64:79], a[36:39], a[20:23], v[64:79]
v_max3_f32 v156, v156, v52, v53
v_max3_f32 v157, v157, v54, v55
ds_read_b128 a[36:39], v149
s_waitcnt lgkmcnt(7)
v_mfma_f32_32x32x16_bf16 v[64:79], a[40:43], a[24:27], v[64:79]
v_max3_f32 v156, v156, v56, v57
v_max3_f32 v157, v157, v58, v59
ds_read_b128 a[40:43], v150
s_waitcnt lgkmcnt(7)
v_mfma_f32_32x32x16_bf16 v[64:79], a[44:47], a[28:31], v[64:79]
v_max3_f32 v156, v156, v60, v61
v_max3_f32 v157, v157, v62, v63
ds_read_b128 a[44:47], v151
s_waitcnt lgkmcnt(7)
v_mfma_f32_32x32x16_bf16 v[80:95], v[128:131], a[0:3], 0
s_barrier
s_add_u32 s46, s49, 13
s_and_b32 s46, s46, 7
s_lshl_b32 s46, s46, 14
s_add_u32 s46, s46, 32768
v_add_u32 v144, s46, v152
v_xor_b32 v145, 32, v144
v_xor_b32 v146, 64, v144
v_xor_b32 v147, 96, v144
v_xor_b32 v148, 128, v144
v_xor_b32 v149, 160, v144
v_xor_b32 v150, 192, v144
v_xor_b32 v151, 224, v144
ds_read_b128 v[128:131], v144
s_waitcnt lgkmcnt(7)
v_mfma_f32_32x32x16_bf16 v[80:95], v[132:135], a[4:7], v[80:95]
ds_read_b128 v[132:135], v145
s_waitcnt lgkmcnt(7)
v_mfma_f32_32x32x16_bf16 v[80:95], v[136:139], a[8:11], v[80:95]
ds_read_b128 v[136:139], v146
s_waitcnt lgkmcnt(7)
v_mfma_f32_32x32x16_bf16 v[80:95], v[140:143], a[12:15], v[80:95]
ds_read_b128 v[140:143], v147
s_waitcnt lgkmcnt(7)
v_mfma_f32_32x32x16_bf16 v[80:95], a[32:35], a[16:19], v[80:95]
v_max3_f32 v156, v156, v64, v65
v_max3_f32 v157, v157, v66, v67
ds_read_b128 a[32:35], v148
s_waitcnt lgkmcnt(7)
v_mfma_f32_32x32x16_bf16 v[80:95], a[36:39], a[20:23], v[80:95]
v_max3_f32 v156, v156, v68, v69
v_max3_f32 v157, v157, v70, v71
ds_read_b128 a[36:39], v149
s_waitcnt lgkmcnt(7)
v_mfma_f32_32x32x16_bf16 v[80:95], a[40:43], a[24:27], v[80:95]
v_max3_f32 v156, v156, v72, v73
v_max3_f32 v157, v157, v74, v75
ds_read_b128 a[40:43], v150
s_waitcnt lgkmcnt(7)
v_mfma_f32_32x32x16_bf16 v[80:95], a[44:47], a[28:31], v[80:95]
v_max3_f32 v156, v156, v76, v77
v_max3_f32 v157, v157, v78, v79
ds_read_b128 a[44:47], v151
s_waitcnt lgkmcnt(7)
v_mfma_f32_32x32x16_bf16 v[96:111], v[128:131], a[0:3], 0
s_barrier
s_barrier
s_barrier
s_add_u32 s46, s49, 14
s_and_b32 s46, s46, 7
s_lshl_b32 s46, s46, 14
s_add_u32 s46, s46, 32768
v_add_u32 v144, s46, v152
v_xor_b32 v145, 32, v144
v_xor_b32 v146, 64, v144
v_xor_b32 v147, 96, v144
v_xor_b32 v148, 128, v144
v_xor_b32 v149, 160, v144
v_xor_b32 v150, 192, v144
v_xor_b32 v151, 224, v144
ds_read_b128 v[128:131], v144
s_waitcnt lgkmcnt(7)
v_mfma_f32_32x32x16_bf16 v[96:111], v[132:135], a[4:7], v[96:111]
ds_read_b128 v[132:135], v145
s_waitcnt lgkmcnt(7)
v_mfma_f32_32x32x16_bf16 v[96:111], v[136:139], a[8:11], v[96:111]
ds_read_b128 v[136:139], v146
s_waitcnt lgkmcnt(7)
v_mfma_f32_32x32x16_bf16 v[96:111], v[140:143], a[12:15], v[96:111]
ds_read_b128 v[140:143], v147
s_waitcnt lgkmcnt(7)
v_mfma_f32_32x32x16_bf16 v[96:111], a[32:35], a[16:19], v[96:111]
v_max3_f32 v156, v156, v80, v81
v_max3_f32 v157, v157, v82, v83
ds_read_b128 a[32:35], v148
s_waitcnt lgkmcnt(7)
v_mfma_f32_32x32x16_bf16 v[96:111], a[36:39], a[20:23], v[96:111]
v_max3_f32 v156, v156, v84, v85
v_max3_f32 v157, v157, v86, v87
ds_read_b128 a[36:39], v149
s_waitcnt lgkmcnt(7)
v_mfma_f32_32x32x16_bf16 v[96:111], a[40:43], a[24:27], v[96:111]
v_max3_f32 v156, v156, v88, v89
v_max3_f32 v157, v157, v90, v91
ds_read_b128 a[40:43], v150
s_waitcnt lgkmcnt(7)
v_mfma_f32_32x32x16_bf16 v[96:111], a[44:47], a[28:31], v[96:111]
v_max3_f32 v156, v156, v92, v93
v_max3_f32 v157, v157, v94, v95
ds_read_b128 a[44:47], v151
s_waitcnt lgkmcnt(7)
v_mfma_f32_32x32x16_bf16 v[112:127], v[128:131], a[0:3], 0
s_waitcnt lgkmcnt(6)
v_mfma_f32_32x32x16_bf16 v[112:127], v[132:135], a[4:7], v[112:127]
s_waitcnt lgkmcnt(5)
v_mfma_f32_32x32x16_bf16 v[112:127], v[136:139], a[8:11], v[112:127]
s_waitcnt lgkmcnt(4)
v_mfma_f32_32x32x16_bf16 v[112:127], v[140:143], a[12:15], v[112:127]
s_waitcnt lgkmcnt(3)
v_mfma_f32_32x32x16_bf16 v[112:127], a[32:35], a[16:19], v[112:127]
v_max3_f32 v156, v156, v96, v97
v_max3_f32 v157, v157, v98, v99
s_waitcnt lgkmcnt(2)
v_mfma_f32_32x32x16_bf16 v[112:127], a[36:39], a[20:23], v[112:127]
v_max3_f32 v156, v156, v100, v101
v_max3_f32 v157, v157, v102, v103
s_waitcnt lgkmcnt(1)
v_mfma_f32_32x32x16_bf16 v[112:127], a[40:43], a[24:27], v[112:127]
v_max3_f32 v156, v156, v104, v105
v_max3_f32 v157, v157, v106, v107
s_waitcnt lgkmcnt(0)
v_mfma_f32_32x32x16_bf16 v[112:127], a[44:47], a[28:31], v[112:127]
v_max3_f32 v156, v156, v108, v109
v_max3_f32 v157, v157, v110, v111
s_nop 9
v_max3_f32 v156, v156, v112, v113
v_max3_f32 v157, v157, v114, v115
v_max3_f32 v156, v156, v116, v117
v_max3_f32 v157, v157, v118, v119
v_max3_f32 v156, v156, v120, v121
v_max3_f32 v157, v157, v122, v123
v_max3_f32 v156, v156, v124, v125
v_max3_f32 v157, v157, v126, v127
v_max_f32 v156, v156, v157
v_mov_b32 v157, v156
s_nop 1
v_permlane32_swap_b32 v156, v157
s_nop 0
v_max_f32 v156, v156, v157
v_mbcnt_lo_u32_b32 v155, -1, 0
v_mbcnt_hi_u32_b32 v155, -1, v155
v_lshlrev_b32 v155, 2, v155
v_add_u32 v155, s54, v155
ds_write_b32 v155, v156 offset:0
s_waitcnt lgkmcnt(0)
s_barrier
v_mbcnt_lo_u32_b32 v155, -1, 0
v_mbcnt_hi_u32_b32 v155, -1, v155
v_lshlrev_b32 v155, 2, v155
v_add_u32 v155, s55, v155
ds_read_b32 v157, v155 offset:0
v_mov_b32 v158, 0
v_mov_b32 v159, 0
s_waitcnt lgkmcnt(0)
v_max_f32 v156, v156, v157
v_mul_f32 v156, s44, v156
v_mov_b32 v157, v156
v_pk_fma_f32 v[0:1], v[0:1], s[44:45], v[156:157] neg_lo:[0,0,1] neg_hi:[0,0,1]
v_pk_fma_f32 v[2:3], v[2:3], s[44:45], v[156:157] neg_lo:[0,0,1] neg_hi:[0,0,1]
v_pk_fma_f32 v[4:5], v[4:5], s[44:45], v[156:157] neg_lo:[0,0,1] neg_hi:[0,0,1]
v_pk_fma_f32 v[6:7], v[6:7], s[44:45], v[156:157] neg_lo:[0,0,1] neg_hi:[0,0,1]
v_exp_f32 v0, v0
v_exp_f32 v1, v1
v_exp_f32 v2, v2
v_exp_f32 v3, v3
v_exp_f32 v4, v4
v_exp_f32 v5, v5
v_exp_f32 v6, v6
v_exp_f32 v7, v7
v_pk_add_f32 v[158:159], v[158:159], v[0:1]
v_pk_add_f32 v[158:159], v[158:159], v[2:3]
v_pk_add_f32 v[158:159], v[158:159], v[4:5]
v_pk_add_f32 v[158:159], v[158:159], v[6:7]
v_cvt_pk_bf16_f32 v0, v0, v1
v_cvt_pk_bf16_f32 v1, v2, v3
v_cvt_pk_bf16_f32 v2, v4, v5
v_cvt_pk_bf16_f32 v3, v6, v7
v_pk_fma_f32 v[8:9], v[8:9], s[44:45], v[156:157] neg_lo:[0,0,1] neg_hi:[0,0,1]
v_pk_fma_f32 v[10:11], v[10:11], s[44:45], v[156:157] neg_lo:[0,0,1] neg_hi:[0,0,1]
v_pk_fma_f32 v[12:13], v[12:13], s[44:45], v[156:157] neg_lo:[0,0,1] neg_hi:[0,0,1]
v_pk_fma_f32 v[14:15], v[14:15], s[44:45], v[156:157] neg_lo:[0,0,1] neg_hi:[0,0,1]
v_exp_f32 v8, v8
v_exp_f32 v9, v9
v_exp_f32 v10, v10
v_exp_f32 v11, v11
v_exp_f32 v12, v12
v_exp_f32 v13, v13
v_exp_f32 v14, v14
v_exp_f32 v15, v15
v_pk_add_f32 v[158:159], v[158:159], v[8:9]
v_pk_add_f32 v[158:159], v[158:159], v[10:11]
v_pk_add_f32 v[158:159], v[158:159], v[12:13]
v_pk_add_f32 v[158:159], v[158:159], v[14:15]
v_cvt_pk_bf16_f32 v4, v8, v9
v_cvt_pk_bf16_f32 v5, v10, v11
v_cvt_pk_bf16_f32 v6, v12, v13
v_cvt_pk_bf16_f32 v7, v14, v15
v_pk_fma_f32 v[16:17], v[16:17], s[44:45], v[156:157] neg_lo:[0,0,1] neg_hi:[0,0,1]
v_pk_fma_f32 v[18:19], v[18:19], s[44:45], v[156:157] neg_lo:[0,0,1] neg_hi:[0,0,1]
v_pk_fma_f32 v[20:21], v[20:21], s[44:45], v[156:157] neg_lo:[0,0,1] neg_hi:[0,0,1]
v_pk_fma_f32 v[22:23], v[22:23], s[44:45], v[156:157] neg_lo:[0,0,1] neg_hi:[0,0,1]
v_exp_f32 v16, v16
v_exp_f32 v17, v17
v_exp_f32 v18, v18
v_exp_f32 v19, v19
v_exp_f32 v20, v20
v_exp_f32 v21, v21
v_exp_f32 v22, v22
v_exp_f32 v23, v23
v_pk_add_f32 v[158:159], v[158:159], v[16:17]
v_pk_add_f32 v[158:159], v[158:159], v[18:19]
v_pk_add_f32 v[158:159], v[158:159], v[20:21]
v_pk_add_f32 v[158:159], v[158:159], v[22:23]
v_cvt_pk_bf16_f32 v16, v16, v17
v_cvt_pk_bf16_f32 v17, v18, v19
v_cvt_pk_bf16_f32 v18, v20, v21
v_cvt_pk_bf16_f32 v19, v22, v23
v_pk_fma_f32 v[24:25], v[24:25], s[44:45], v[156:157] neg_lo:[0,0,1] neg_hi:[0,0,1]
v_pk_fma_f32 v[26:27], v[26:27], s[44:45], v[156:157] neg_lo:[0,0,1] neg_hi:[0,0,1]
v_pk_fma_f32 v[28:29], v[28:29], s[44:45], v[156:157] neg_lo:[0,0,1] neg_hi:[0,0,1]
v_pk_fma_f32 v[30:31], v[30:31], s[44:45], v[156:157] neg_lo:[0,0,1] neg_hi:[0,0,1]
v_exp_f32 v24, v24
v_exp_f32 v25, v25
v_exp_f32 v26, v26
v_exp_f32 v27, v27
v_exp_f32 v28, v28
v_exp_f32 v29, v29
v_exp_f32 v30, v30
v_exp_f32 v31, v31
v_pk_add_f32 v[158:159], v[158:159], v[24:25]
v_pk_add_f32 v[158:159], v[158:159], v[26:27]
v_pk_add_f32 v[158:159], v[158:159], v[28:29]
v_pk_add_f32 v[158:159], v[158:159], v[30:31]
v_cvt_pk_bf16_f32 v20, v24, v25
v_cvt_pk_bf16_f32 v21, v26, v27
v_cvt_pk_bf16_f32 v22, v28, v29
v_cvt_pk_bf16_f32 v23, v30, v31
s_nop 1
s_barrier
s_add_u32 s46, s49, 17
s_and_b32 s46, s46, 7
s_lshl_b32 s46, s46, 14
s_add_u32 s46, s46, 32768
v_add_u32 v144, s46, v153
v_xor_b32 v145, 64, v144
v_xor_b32 v146, 128, v144
v_xor_b32 v147, 192, v144
ds_read_b64_tr_b16 v[128:129], v144 offset:0
ds_read_b64_tr_b16 v[130:131], v144 offset:2048
ds_read_b64_tr_b16 v[132:133], v145 offset:0
ds_read_b64_tr_b16 v[134:135], v145 offset:2048
ds_read_b64_tr_b16 v[136:137], v146 offset:0
ds_read_b64_tr_b16 v[138:139], v146 offset:2048
ds_read_b64_tr_b16 v[140:141], v147 offset:0
ds_read_b64_tr_b16 v[142:143], v147 offset:2048
ds_read_b64_tr_b16 a[0:1], v144 offset:4096
ds_read_b64_tr_b16 a[2:3], v144 offset:6144
ds_read_b64_tr_b16 a[4:5], v145 offset:4096
ds_read_b64_tr_b16 a[6:7], v145 offset:6144
ds_read_b64_tr_b16 a[8:9], v146 offset:4096
ds_read_b64_tr_b16 a[10:11], v146 offset:6144
s_waitcnt lgkmcnt(12)
v_mfma_f32_32x32x16_bf16 a[32:47], v[128:131], v[0:3], 0
v_pk_fma_f32 v[32:33], v[32:33], s[44:45], v[156:157] neg_lo:[0,0,1] neg_hi:[0,0,1]
v_pk_fma_f32 v[34:35], v[34:35], s[44:45], v[156:157] neg_lo:[0,0,1] neg_hi:[0,0,1]
v_pk_fma_f32 v[36:37], v[36:37], s[44:45], v[156:157] neg_lo:[0,0,1] neg_hi:[0,0,1]
v_pk_fma_f32 v[38:39], v[38:39], s[44:45], v[156:157] neg_lo:[0,0,1] neg_hi:[0,0,1]
v_exp_f32 v32, v32
ds_read_b64_tr_b16 a[12:13], v147 offset:4096
ds_read_b64_tr_b16 a[14:15], v147 offset:6144
s_waitcnt lgkmcnt(12)
v_mfma_f32_32x32x16_bf16 a[48:63], v[132:135], v[0:3], 0
v_exp_f32 v33, v33
v_exp_f32 v34, v34
v_exp_f32 v35, v35
v_exp_f32 v36, v36
v_exp_f32 v37, v37
s_barrier
s_barrier
s_add_u32 s46, s49, 18
s_and_b32 s46, s46, 7
s_lshl_b32 s46, s46, 14
s_add_u32 s46, s46, 32768
v_add_u32 v144, s46, v153
v_xor_b32 v145, 64, v144
v_xor_b32 v146, 128, v144
v_xor_b32 v147, 192, v144
ds_read_b64_tr_b16 v[128:129], v144 offset:0
ds_read_b64_tr_b16 v[130:131], v144 offset:2048
s_waitcnt lgkmcnt(12)
v_mfma_f32_32x32x16_bf16 a[64:79], v[136:139], v[0:3], 0
v_exp_f32 v38, v38
v_exp_f32 v39, v39
v_pk_add_f32 v[158:159], v[158:159], v[32:33]
v_pk_add_f32 v[158:159], v[158:159], v[34:35]
v_pk_add_f32 v[158:159], v[158:159], v[36:37]
ds_read_b64_tr_b16 v[132:133], v145 offset:0
ds_read_b64_tr_b16 v[134:135], v145 offset:2048
s_waitcnt lgkmcnt(12)
v_mfma_f32_32x32x16_bf16 a[80:95], v[140:143], v[0:3], 0
v_pk_add_f32 v[158:159], v[158:159], v[38:39]
v_cvt_pk_bf16_f32 v32, v32, v33
v_cvt_pk_bf16_f32 v33, v34, v35
v_cvt_pk_bf16_f32 v34, v36, v37
v_cvt_pk_bf16_f32 v35, v38, v39
ds_read_b64_tr_b16 v[136:137], v146 offset:0
ds_read_b64_tr_b16 v[138:139], v146 offset:2048
s_waitcnt lgkmcnt(12)
v_mfma_f32_32x32x16_bf16 a[32:47], a[0:3], v[4:7], a[32:47]
v_pk_fma_f32 v[40:41], v[40:41], s[44:45], v[156:157] neg_lo:[0,0,1] neg_hi:[0,0,1]
v_pk_fma_f32 v[42:43], v[42:43], s[44:45], v[156:157] neg_lo:[0,0,1] neg_hi:[0,0,1]
v_pk_fma_f32 v[44:45], v[44:45], s[44:45], v[156:157] neg_lo:[0,0,1] neg_hi:[0,0,1]
v_pk_fma_f32 v[46:47], v[46:47], s[44:45], v[156:157] neg_lo:[0,0,1] neg_hi:[0,0,1]
v_exp_f32 v40, v40
ds_read_b64_tr_b16 v[140:141], v147 offset:0
ds_read_b64_tr_b16 v[142:143], v147 offset:2048
s_waitcnt lgkmcnt(12)
v_mfma_f32_32x32x16_bf16 a[48:63], a[4:7], v[4:7], a[48:63]
v_exp_f32 v41, v41
v_exp_f32 v42, v42
v_exp_f32 v43, v43
v_exp_f32 v44, v44
v_exp_f32 v45, v45
ds_read_b64_tr_b16 a[0:1], v144 offset:4096
ds_read_b64_tr_b16 a[2:3], v144 offset:6144
s_waitcnt lgkmcnt(12)
v_mfma_f32_32x32x16_bf16 a[64:79], a[8:11], v[4:7], a[64:79]
v_exp_f32 v46, v46
v_exp_f32 v47, v47
v_pk_add_f32 v[158:159], v[158:159], v[40:41]
v_pk_add_f32 v[158:159], v[158:159], v[42:43]
v_pk_add_f32 v[158:159], v[158:159], v[44:45]
ds_read_b64_tr_b16 a[4:5], v145 offset:4096
ds_read_b64_tr_b16 a[6:7], v145 offset:6144
s_waitcnt lgkmcnt(12)
v_mfma_f32_32x32x16_bf16 a[80:95], a[12:15], v[4:7], a[80:95]
v_pk_add_f32 v[158:159], v[158:159], v[46:47]
v_cvt_pk_bf16_f32 v36, v40, v41
v_cvt_pk_bf16_f32 v37, v42, v43
v_cvt_pk_bf16_f32 v38, v44, v45
v_cvt_pk_bf16_f32 v39, v46, v47
ds_read_b64_tr_b16 a[8:9], v146 offset:4096
ds_read_b64_tr_b16 a[10:11], v146 offset:6144
s_waitcnt lgkmcnt(12)
v_mfma_f32_32x32x16_bf16 a[32:47], v[128:131], v[16:19], a[32:47]
v_pk_fma_f32 v[48:49], v[48:49], s[44:45], v[156:157] neg_lo:[0,0,1] neg_hi:[0,0,1]
v_pk_fma_f32 v[50:51], v[50:51], s[44:45], v[156:157] neg_lo:[0,0,1] neg_hi:[0,0,1]
v_pk_fma_f32 v[52:53], v[52:53], s[44:45], v[156:157] neg_lo:[0,0,1] neg_hi:[0,0,1]
v_pk_fma_f32 v[54:55], v[54:55], s[44:45], v[156:157] neg_lo:[0,0,1] neg_hi:[0,0,1]
v_exp_f32 v48, v48
ds_read_b64_tr_b16 a[12:13], v147 offset:4096
ds_read_b64_tr_b16 a[14:15], v147 offset:6144
s_waitcnt lgkmcnt(12)
v_mfma_f32_32x32x16_bf16 a[48:63], v[132:135], v[16:19], a[48:63]
v_exp_f32 v49, v49
v_exp_f32 v50, v50
v_exp_f32 v51, v51
v_exp_f32 v52, v52
v_exp_f32 v53, v53
s_barrier
s_add_u32 s46, s49, 21
s_and_b32 s46, s46, 7
s_lshl_b32 s46, s46, 14
s_add_u32 s46, s46, 32768
v_add_u32 v144, s46, v153
v_xor_b32 v145, 64, v144
v_xor_b32 v146, 128, v144
v_xor_b32 v147, 192, v144
ds_read_b64_tr_b16 v[128:129], v144 offset:0
ds_read_b64_tr_b16 v[130:131], v144 offset:2048
s_waitcnt lgkmcnt(12)
v_mfma_f32_32x32x16_bf16 a[64:79], v[136:139], v[16:19], a[64:79]
v_exp_f32 v54, v54
v_exp_f32 v55, v55
v_pk_add_f32 v[158:159], v[158:159], v[48:49]
v_pk_add_f32 v[158:159], v[158:159], v[50:51]
v_pk_add_f32 v[158:159], v[158:159], v[52:53]
ds_read_b64_tr_b16 v[132:133], v145 offset:0
ds_read_b64_tr_b16 v[134:135], v145 offset:2048
s_waitcnt lgkmcnt(12)
v_mfma_f32_32x32x16_bf16 a[80:95], v[140:143], v[16:19], a[80:95]
v_pk_add_f32 v[158:159], v[158:159], v[54:55]
v_cvt_pk_bf16_f32 v48, v48, v49
v_cvt_pk_bf16_f32 v49, v50, v51
v_cvt_pk_bf16_f32 v50, v52, v53
v_cvt_pk_bf16_f32 v51, v54, v55
ds_read_b64_tr_b16 v[136:137], v146 offset:0
ds_read_b64_tr_b16 v[138:139], v146 offset:2048
s_waitcnt lgkmcnt(12)
v_mfma_f32_32x32x16_bf16 a[32:47], a[0:3], v[20:23], a[32:47]
v_pk_fma_f32 v[56:57], v[56:57], s[44:45], v[156:157] neg_lo:[0,0,1] neg_hi:[0,0,1]
v_pk_fma_f32 v[58:59], v[58:59], s[44:45], v[156:157] neg_lo:[0,0,1] neg_hi:[0,0,1]
v_pk_fma_f32 v[60:61], v[60:61], s[44:45], v[156:157] neg_lo:[0,0,1] neg_hi:[0,0,1]
v_pk_fma_f32 v[62:63], v[62:63], s[44:45], v[156:157] neg_lo:[0,0,1] neg_hi:[0,0,1]
v_exp_f32 v56, v56
ds_read_b64_tr_b16 v[140:141], v147 offset:0
ds_read_b64_tr_b16 v[142:143], v147 offset:2048
s_waitcnt lgkmcnt(12)
v_mfma_f32_32x32x16_bf16 a[48:63], a[4:7], v[20:23], a[48:63]
v_exp_f32 v57, v57
v_exp_f32 v58, v58
v_exp_f32 v59, v59
v_exp_f32 v60, v60
v_exp_f32 v61, v61
ds_read_b64_tr_b16 a[0:1], v144 offset:4096
ds_read_b64_tr_b16 a[2:3], v144 offset:6144
s_waitcnt lgkmcnt(12)
v_mfma_f32_32x32x16_bf16 a[64:79], a[8:11], v[20:23], a[64:79]
v_exp_f32 v62, v62
v_exp_f32 v63, v63
v_pk_add_f32 v[158:159], v[158:159], v[56:57]
v_pk_add_f32 v[158:159], v[158:159], v[58:59]
v_pk_add_f32 v[158:159], v[158:159], v[60:61]
ds_read_b64_tr_b16 a[4:5], v145 offset:4096
ds_read_b64_tr_b16 a[6:7], v145 offset:6144
s_waitcnt lgkmcnt(12)
v_mfma_f32_32x32x16_bf16 a[80:95], a[12:15], v[20:23], a[80:95]
v_pk_add_f32 v[158:159], v[158:159], v[62:63]
v_cvt_pk_bf16_f32 v52, v56, v57
v_cvt_pk_bf16_f32 v53, v58, v59
v_cvt_pk_bf16_f32 v54, v60, v61
v_cvt_pk_bf16_f32 v55, v62, v63
ds_read_b64_tr_b16 a[8:9], v146 offset:4096
ds_read_b64_tr_b16 a[10:11], v146 offset:6144
s_waitcnt lgkmcnt(12)
v_mfma_f32_32x32x16_bf16 a[32:47], v[128:131], v[32:35], a[32:47]
v_pk_fma_f32 v[64:65], v[64:65], s[44:45], v[156:157] neg_lo:[0,0,1] neg_hi:[0,0,1]
v_pk_fma_f32 v[66:67], v[66:67], s[44:45], v[156:157] neg_lo:[0,0,1] neg_hi:[0,0,1]
v_pk_fma_f32 v[68:69], v[68:69], s[44:45], v[156:157] neg_lo:[0,0,1] neg_hi:[0,0,1]
v_pk_fma_f32 v[70:71], v[70:71], s[44:45], v[156:157] neg_lo:[0,0,1] neg_hi:[0,0,1]
v_exp_f32 v64, v64
ds_read_b64_tr_b16 a[12:13], v147 offset:4096
ds_read_b64_tr_b16 a[14:15], v147 offset:6144
s_waitcnt lgkmcnt(12)
v_mfma_f32_32x32x16_bf16 a[48:63], v[132:135], v[32:35], a[48:63]
v_exp_f32 v65, v65
v_exp_f32 v66, v66
v_exp_f32 v67, v67
v_exp_f32 v68, v68
v_exp_f32 v69, v69
s_barrier
s_barrier
s_barrier
s_waitcnt lgkmcnt(0)
s_barrier
s_add_u32 s46, s49, 22
s_and_b32 s46, s46, 7
s_lshl_b32 s46, s46, 14
s_add_u32 s46, s46, 32768
v_add_u32 v144, s46, v153
v_xor_b32 v145, 64, v144
v_xor_b32 v146, 128, v144
v_xor_b32 v147, 192, v144
ds_read_b64_tr_b16 v[128:129], v144 offset:0
ds_read_b64_tr_b16 v[130:131], v144 offset:2048
ds_read_b64_tr_b16 v[132:133], v145 offset:0
ds_read_b64_tr_b16 v[134:135], v145 offset:2048
v_mfma_f32_32x32x16_bf16 a[64:79], v[136:139], v[32:35], a[64:79]
v_exp_f32 v70, v70
v_exp_f32 v71, v71
v_pk_add_f32 v[158:159], v[158:159], v[64:65]
v_pk_add_f32 v[158:159], v[158:159], v[66:67]
v_pk_add_f32 v[158:159], v[158:159], v[68:69]
ds_read_b64_tr_b16 v[136:137], v146 offset:0
ds_read_b64_tr_b16 v[138:139], v146 offset:2048
v_mfma_f32_32x32x16_bf16 a[80:95], v[140:143], v[32:35], a[80:95]
v_pk_add_f32 v[158:159], v[158:159], v[70:71]
v_cvt_pk_bf16_f32 v64, v64, v65
v_cvt_pk_bf16_f32 v65, v66, v67
v_cvt_pk_bf16_f32 v66, v68, v69
v_cvt_pk_bf16_f32 v67, v70, v71
ds_read_b64_tr_b16 v[140:141], v147 offset:0
ds_read_b64_tr_b16 v[142:143], v147 offset:2048
v_mfma_f32_32x32x16_bf16 a[32:47], a[0:3], v[36:39], a[32:47]
v_pk_fma_f32 v[72:73], v[72:73], s[44:45], v[156:157] neg_lo:[0,0,1] neg_hi:[0,0,1]
v_pk_fma_f32 v[74:75], v[74:75], s[44:45], v[156:157] neg_lo:[0,0,1] neg_hi:[0,0,1]
v_pk_fma_f32 v[76:77], v[76:77], s[44:45], v[156:157] neg_lo:[0,0,1] neg_hi:[0,0,1]
v_pk_fma_f32 v[78:79], v[78:79], s[44:45], v[156:157] neg_lo:[0,0,1] neg_hi:[0,0,1]
v_exp_f32 v72, v72
ds_read_b64_tr_b16 a[0:1], v144 offset:4096
ds_read_b64_tr_b16 a[2:3], v144 offset:6144
v_mfma_f32_32x32x16_bf16 a[48:63], a[4:7], v[36:39], a[48:63]
v_exp_f32 v73, v73
v_exp_f32 v74, v74
v_exp_f32 v75, v75
v_exp_f32 v76, v76
v_exp_f32 v77, v77
ds_read_b64_tr_b16 a[4:5], v145 offset:4096
ds_read_b64_tr_b16 a[6:7], v145 offset:6144
v_mfma_f32_32x32x16_bf16 a[64:79], a[8:11], v[36:39], a[64:79]
v_exp_f32 v78, v78
v_exp_f32 v79, v79
v_pk_add_f32 v[158:159], v[158:159], v[72:73]
v_pk_add_f32 v[158:159], v[158:159], v[74:75]
v_pk_add_f32 v[158:159], v[158:159], v[76:77]
ds_read_b64_tr_b16 a[8:9], v146 offset:4096
ds_read_b64_tr_b16 a[10:11], v146 offset:6144
v_mfma_f32_32x32x16_bf16 a[80:95], a[12:15], v[36:39], a[80:95]
v_pk_add_f32 v[158:159], v[158:159], v[78:79]
v_cvt_pk_bf16_f32 v68, v72, v73
v_cvt_pk_bf16_f32 v69, v74, v75
v_cvt_pk_bf16_f32 v70, v76, v77
v_cvt_pk_bf16_f32 v71, v78, v79
s_waitcnt lgkmcnt(12)
v_mfma_f32_32x32x16_bf16 a[32:47], v[128:131], v[48:51], a[32:47]
v_pk_fma_f32 v[80:81], v[80:81], s[44:45], v[156:157] neg_lo:[0,0,1] neg_hi:[0,0,1]
v_pk_fma_f32 v[82:83], v[82:83], s[44:45], v[156:157] neg_lo:[0,0,1] neg_hi:[0,0,1]
v_pk_fma_f32 v[84:85], v[84:85], s[44:45], v[156:157] neg_lo:[0,0,1] neg_hi:[0,0,1]
v_pk_fma_f32 v[86:87], v[86:87], s[44:45], v[156:157] neg_lo:[0,0,1] neg_hi:[0,0,1]
v_exp_f32 v80, v80
ds_read_b64_tr_b16 a[12:13], v147 offset:4096
ds_read_b64_tr_b16 a[14:15], v147 offset:6144
s_waitcnt lgkmcnt(12)
v_mfma_f32_32x32x16_bf16 a[48:63], v[132:135], v[48:51], a[48:63]
v_exp_f32 v81, v81
v_exp_f32 v82, v82
v_exp_f32 v83, v83
v_exp_f32 v84, v84
v_exp_f32 v85, v85
s_waitcnt lgkmcnt(0)
s_barrier
s_add_u32 s46, s49, 26
s_and_b32 s46, s46, 7
s_lshl_b32 s46, s46, 14
s_add_u32 s46, s46, 32768
v_add_u32 v144, s46, v153
v_xor_b32 v145, 64, v144
v_xor_b32 v146, 128, v144
v_xor_b32 v147, 192, v144
ds_read_b64_tr_b16 v[128:129], v144 offset:0
ds_read_b64_tr_b16 v[130:131], v144 offset:2048
ds_read_b64_tr_b16 v[132:133], v145 offset:0
ds_read_b64_tr_b16 v[134:135], v145 offset:2048
v_mfma_f32_32x32x16_bf16 a[64:79], v[136:139], v[48:51], a[64:79]
v_exp_f32 v86, v86
v_exp_f32 v87, v87
v_pk_add_f32 v[158:159], v[158:159], v[80:81]
v_pk_add_f32 v[158:159], v[158:159], v[82:83]
v_pk_add_f32 v[158:159], v[158:159], v[84:85]
ds_read_b64_tr_b16 v[136:137], v146 offset:0
ds_read_b64_tr_b16 v[138:139], v146 offset:2048
v_mfma_f32_32x32x16_bf16 a[80:95], v[140:143], v[48:51], a[80:95]
v_pk_add_f32 v[158:159], v[158:159], v[86:87]
v_cvt_pk_bf16_f32 v80, v80, v81
v_cvt_pk_bf16_f32 v81, v82, v83
v_cvt_pk_bf16_f32 v82, v84, v85
v_cvt_pk_bf16_f32 v83, v86, v87
ds_read_b64_tr_b16 v[140:141], v147 offset:0
ds_read_b64_tr_b16 v[142:143], v147 offset:2048
v_mfma_f32_32x32x16_bf16 a[32:47], a[0:3], v[52:55], a[32:47]
v_pk_fma_f32 v[88:89], v[88:89], s[44:45], v[156:157] neg_lo:[0,0,1] neg_hi:[0,0,1]
v_pk_fma_f32 v[90:91], v[90:91], s[44:45], v[156:157] neg_lo:[0,0,1] neg_hi:[0,0,1]
v_pk_fma_f32 v[92:93], v[92:93], s[44:45], v[156:157] neg_lo:[0,0,1] neg_hi:[0,0,1]
v_pk_fma_f32 v[94:95], v[94:95], s[44:45], v[156:157] neg_lo:[0,0,1] neg_hi:[0,0,1]
v_exp_f32 v88, v88
ds_read_b64_tr_b16 a[0:1], v144 offset:4096
ds_read_b64_tr_b16 a[2:3], v144 offset:6144
v_mfma_f32_32x32x16_bf16 a[48:63], a[4:7], v[52:55], a[48:63]
v_exp_f32 v89, v89
v_exp_f32 v90, v90
v_exp_f32 v91, v91
v_exp_f32 v92, v92
v_exp_f32 v93, v93
ds_read_b64_tr_b16 a[4:5], v145 offset:4096
ds_read_b64_tr_b16 a[6:7], v145 offset:6144
v_mfma_f32_32x32x16_bf16 a[64:79], a[8:11], v[52:55], a[64:79]
v_exp_f32 v94, v94
v_exp_f32 v95, v95
v_pk_add_f32 v[158:159], v[158:159], v[88:89]
v_pk_add_f32 v[158:159], v[158:159], v[90:91]
v_pk_add_f32 v[158:159], v[158:159], v[92:93]
ds_read_b64_tr_b16 a[8:9], v146 offset:4096
ds_read_b64_tr_b16 a[10:11], v146 offset:6144
v_mfma_f32_32x32x16_bf16 a[80:95], a[12:15], v[52:55], a[80:95]
v_pk_add_f32 v[158:159], v[158:159], v[94:95]
v_cvt_pk_bf16_f32 v84, v88, v89
v_cvt_pk_bf16_f32 v85, v90, v91
v_cvt_pk_bf16_f32 v86, v92, v93
v_cvt_pk_bf16_f32 v87, v94, v95
s_waitcnt lgkmcnt(12)
v_mfma_f32_32x32x16_bf16 a[32:47], v[128:131], v[64:67], a[32:47]
v_pk_fma_f32 v[96:97], v[96:97], s[44:45], v[156:157] neg_lo:[0,0,1] neg_hi:[0,0,1]
v_pk_fma_f32 v[98:99], v[98:99], s[44:45], v[156:157] neg_lo:[0,0,1] neg_hi:[0,0,1]
v_pk_fma_f32 v[100:101], v[100:101], s[44:45], v[156:157] neg_lo:[0,0,1] neg_hi:[0,0,1]
v_pk_fma_f32 v[102:103], v[102:103], s[44:45], v[156:157] neg_lo:[0,0,1] neg_hi:[0,0,1]
v_exp_f32 v96, v96
ds_read_b64_tr_b16 a[12:13], v147 offset:4096
ds_read_b64_tr_b16 a[14:15], v147 offset:6144
s_waitcnt lgkmcnt(12)
v_mfma_f32_32x32x16_bf16 a[48:63], v[132:135], v[64:67], a[48:63]
v_exp_f32 v97, v97
v_exp_f32 v98, v98
v_exp_f32 v99, v99
v_exp_f32 v100, v100
v_exp_f32 v101, v101
s_barrier
s_barrier
s_barrier
s_add_u32 s46, s49, 27
s_and_b32 s46, s46, 7
s_lshl_b32 s46, s46, 14
s_add_u32 s46, s46, 32768
v_add_u32 v144, s46, v153
v_xor_b32 v145, 64, v144
v_xor_b32 v146, 128, v144
v_xor_b32 v147, 192, v144
ds_read_b64_tr_b16 v[128:129], v144 offset:0
ds_read_b64_tr_b16 v[130:131], v144 offset:2048
s_waitcnt lgkmcnt(12)
v_mfma_f32_32x32x16_bf16 a[64:79], v[136:139], v[64:67], a[64:79]
v_exp_f32 v102, v102
v_exp_f32 v103, v103
v_pk_add_f32 v[158:159], v[158:159], v[96:97]
v_pk_add_f32 v[158:159], v[158:159], v[98:99]
v_pk_add_f32 v[158:159], v[158:159], v[100:101]
ds_read_b64_tr_b16 v[132:133], v145 offset:0
ds_read_b64_tr_b16 v[134:135], v145 offset:2048
s_waitcnt lgkmcnt(12)
v_mfma_f32_32x32x16_bf16 a[80:95], v[140:143], v[64:67], a[80:95]
v_pk_add_f32 v[158:159], v[158:159], v[102:103]
v_cvt_pk_bf16_f32 v96, v96, v97
v_cvt_pk_bf16_f32 v97, v98, v99
v_cvt_pk_bf16_f32 v98, v100, v101
v_cvt_pk_bf16_f32 v99, v102, v103
ds_read_b64_tr_b16 v[136:137], v146 offset:0
ds_read_b64_tr_b16 v[138:139], v146 offset:2048
s_waitcnt lgkmcnt(12)
v_mfma_f32_32x32x16_bf16 a[32:47], a[0:3], v[68:71], a[32:47]
v_pk_fma_f32 v[104:105], v[104:105], s[44:45], v[156:157] neg_lo:[0,0,1] neg_hi:[0,0,1]
v_pk_fma_f32 v[106:107], v[106:107], s[44:45], v[156:157] neg_lo:[0,0,1] neg_hi:[0,0,1]
v_pk_fma_f32 v[108:109], v[108:109], s[44:45], v[156:157] neg_lo:[0,0,1] neg_hi:[0,0,1]
v_pk_fma_f32 v[110:111], v[110:111], s[44:45], v[156:157] neg_lo:[0,0,1] neg_hi:[0,0,1]
v_exp_f32 v104, v104
ds_read_b64_tr_b16 v[140:141], v147 offset:0
ds_read_b64_tr_b16 v[142:143], v147 offset:2048
s_waitcnt lgkmcnt(12)
v_mfma_f32_32x32x16_bf16 a[48:63], a[4:7], v[68:71], a[48:63]
v_exp_f32 v105, v105
v_exp_f32 v106, v106
v_exp_f32 v107, v107
v_exp_f32 v108, v108
v_exp_f32 v109, v109
ds_read_b64_tr_b16 a[0:1], v144 offset:4096
ds_read_b64_tr_b16 a[2:3], v144 offset:6144
s_waitcnt lgkmcnt(12)
v_mfma_f32_32x32x16_bf16 a[64:79], a[8:11], v[68:71], a[64:79]
v_exp_f32 v110, v110
v_exp_f32 v111, v111
v_pk_add_f32 v[158:159], v[158:159], v[104:105]
v_pk_add_f32 v[158:159], v[158:159], v[106:107]
v_pk_add_f32 v[158:159], v[158:159], v[108:109]
ds_read_b64_tr_b16 a[4:5], v145 offset:4096
ds_read_b64_tr_b16 a[6:7], v145 offset:6144
s_waitcnt lgkmcnt(12)
v_mfma_f32_32x32x16_bf16 a[80:95], a[12:15], v[68:71], a[80:95]
v_pk_add_f32 v[158:159], v[158:159], v[110:111]
v_cvt_pk_bf16_f32 v100, v104, v105
v_cvt_pk_bf16_f32 v101, v106, v107
v_cvt_pk_bf16_f32 v102, v108, v109
v_cvt_pk_bf16_f32 v103, v110, v111
ds_read_b64_tr_b16 a[8:9], v146 offset:4096
ds_read_b64_tr_b16 a[10:11], v146 offset:6144
s_waitcnt lgkmcnt(12)
v_mfma_f32_32x32x16_bf16 a[32:47], v[128:131], v[80:83], a[32:47]
v_pk_fma_f32 v[112:113], v[112:113], s[44:45], v[156:157] neg_lo:[0,0,1] neg_hi:[0,0,1]
v_pk_fma_f32 v[114:115], v[114:115], s[44:45], v[156:157] neg_lo:[0,0,1] neg_hi:[0,0,1]
v_pk_fma_f32 v[116:117], v[116:117], s[44:45], v[156:157] neg_lo:[0,0,1] neg_hi:[0,0,1]
v_pk_fma_f32 v[118:119], v[118:119], s[44:45], v[156:157] neg_lo:[0,0,1] neg_hi:[0,0,1]
v_exp_f32 v112, v112
ds_read_b64_tr_b16 a[12:13], v147 offset:4096
ds_read_b64_tr_b16 a[14:15], v147 offset:6144
s_waitcnt lgkmcnt(12)
v_mfma_f32_32x32x16_bf16 a[48:63], v[132:135], v[80:83], a[48:63]
v_exp_f32 v113, v113
v_exp_f32 v114, v114
v_exp_f32 v115, v115
v_exp_f32 v116, v116
v_exp_f32 v117, v117
s_barrier
s_add_u32 s46, s49, 30
s_and_b32 s46, s46, 7
s_lshl_b32 s46, s46, 14
s_add_u32 s46, s46, 32768
v_add_u32 v144, s46, v153
v_xor_b32 v145, 64, v144
v_xor_b32 v146, 128, v144
v_xor_b32 v147, 192, v144
ds_read_b64_tr_b16 v[128:129], v144 offset:0
ds_read_b64_tr_b16 v[130:131], v144 offset:2048
s_waitcnt lgkmcnt(12)
v_mfma_f32_32x32x16_bf16 a[64:79], v[136:139], v[80:83], a[64:79]
v_exp_f32 v118, v118
v_exp_f32 v119, v119
v_pk_add_f32 v[158:159], v[158:159], v[112:113]
v_pk_add_f32 v[158:159], v[158:159], v[114:115]
v_pk_add_f32 v[158:159], v[158:159], v[116:117]
ds_read_b64_tr_b16 v[132:133], v145 offset:0
ds_read_b64_tr_b16 v[134:135], v145 offset:2048
s_waitcnt lgkmcnt(12)
v_mfma_f32_32x32x16_bf16 a[80:95], v[140:143], v[80:83], a[80:95]
v_pk_add_f32 v[158:159], v[158:159], v[118:119]
v_cvt_pk_bf16_f32 v112, v112, v113
v_cvt_pk_bf16_f32 v113, v114, v115
v_cvt_pk_bf16_f32 v114, v116, v117
v_cvt_pk_bf16_f32 v115, v118, v119
ds_read_b64_tr_b16 v[136:137], v146 offset:0
ds_read_b64_tr_b16 v[138:139], v146 offset:2048
s_waitcnt lgkmcnt(12)
v_mfma_f32_32x32x16_bf16 a[32:47], a[0:3], v[84:87], a[32:47]
v_pk_fma_f32 v[120:121], v[120:121], s[44:45], v[156:157] neg_lo:[0,0,1] neg_hi:[0,0,1]
v_pk_fma_f32 v[122:123], v[122:123], s[44:45], v[156:157] neg_lo:[0,0,1] neg_hi:[0,0,1]
v_pk_fma_f32 v[124:125], v[124:125], s[44:45], v[156:157] neg_lo:[0,0,1] neg_hi:[0,0,1]
v_pk_fma_f32 v[126:127], v[126:127], s[44:45], v[156:157] neg_lo:[0,0,1] neg_hi:[0,0,1]
v_exp_f32 v120, v120
ds_read_b64_tr_b16 v[140:141], v147 offset:0
ds_read_b64_tr_b16 v[142:143], v147 offset:2048
s_waitcnt lgkmcnt(12)
v_mfma_f32_32x32x16_bf16 a[48:63], a[4:7], v[84:87], a[48:63]
v_exp_f32 v121, v121
v_exp_f32 v122, v122
v_exp_f32 v123, v123
v_exp_f32 v124, v124
v_exp_f32 v125, v125
ds_read_b64_tr_b16 a[0:1], v144 offset:4096
ds_read_b64_tr_b16 a[2:3], v144 offset:6144
s_waitcnt lgkmcnt(12)
v_mfma_f32_32x32x16_bf16 a[64:79], a[8:11], v[84:87], a[64:79]
v_exp_f32 v126, v126
v_exp_f32 v127, v127
v_pk_add_f32 v[158:159], v[158:159], v[120:121]
v_pk_add_f32 v[158:159], v[158:159], v[122:123]
v_pk_add_f32 v[158:159], v[158:159], v[124:125]
ds_read_b64_tr_b16 a[4:5], v145 offset:4096
ds_read_b64_tr_b16 a[6:7], v145 offset:6144
s_waitcnt lgkmcnt(12)
v_mfma_f32_32x32x16_bf16 a[80:95], a[12:15], v[84:87], a[80:95]
v_pk_add_f32 v[158:159], v[158:159], v[126:127]
v_cvt_pk_bf16_f32 v116, v120, v121
v_cvt_pk_bf16_f32 v117, v122, v123
v_cvt_pk_bf16_f32 v118, v124, v125
v_cvt_pk_bf16_f32 v119, v126, v127
ds_read_b64_tr_b16 a[8:9], v146 offset:4096
ds_read_b64_tr_b16 a[10:11], v146 offset:6144
s_waitcnt lgkmcnt(12)
v_mfma_f32_32x32x16_bf16 a[32:47], v[128:131], v[96:99], a[32:47]
ds_read_b64_tr_b16 a[12:13], v147 offset:4096
ds_read_b64_tr_b16 a[14:15], v147 offset:6144
s_waitcnt lgkmcnt(12)
v_mfma_f32_32x32x16_bf16 a[48:63], v[132:135], v[96:99], a[48:63]
s_barrier
s_add_u32 s46, s49, 31
s_and_b32 s46, s46, 7
s_lshl_b32 s46, s46, 14
s_add_u32 s46, s46, 32768
v_add_u32 v144, s46, v153
v_xor_b32 v145, 64, v144
v_xor_b32 v146, 128, v144
v_xor_b32 v147, 192, v144
ds_read_b64_tr_b16 v[128:129], v144 offset:0
ds_read_b64_tr_b16 v[130:131], v144 offset:2048
s_waitcnt lgkmcnt(12)
v_mfma_f32_32x32x16_bf16 a[64:79], v[136:139], v[96:99], a[64:79]
ds_read_b64_tr_b16 v[132:133], v145 offset:0
ds_read_b64_tr_b16 v[134:135], v145 offset:2048
s_waitcnt lgkmcnt(12)
v_mfma_f32_32x32x16_bf16 a[80:95], v[140:143], v[96:99], a[80:95]
ds_read_b64_tr_b16 v[136:137], v146 offset:0
ds_read_b64_tr_b16 v[138:139], v146 offset:2048
s_waitcnt lgkmcnt(12)
v_mfma_f32_32x32x16_bf16 a[32:47], a[0:3], v[100:103], a[32:47]
ds_read_b64_tr_b16 v[140:141], v147 offset:0
ds_read_b64_tr_b16 v[142:143], v147 offset:2048
s_waitcnt lgkmcnt(12)
v_mfma_f32_32x32x16_bf16 a[48:63], a[4:7], v[100:103], a[48:63]
ds_read_b64_tr_b16 a[0:1], v144 offset:4096
ds_read_b64_tr_b16 a[2:3], v144 offset:6144
s_waitcnt lgkmcnt(12)
v_mfma_f32_32x32x16_bf16 a[64:79], a[8:11], v[100:103], a[64:79]
ds_read_b64_tr_b16 a[4:5], v145 offset:4096
ds_read_b64_tr_b16 a[6:7], v145 offset:6144
s_waitcnt lgkmcnt(12)
v_mfma_f32_32x32x16_bf16 a[80:95], a[12:15], v[100:103], a[80:95]
ds_read_b64_tr_b16 a[8:9], v146 offset:4096
ds_read_b64_tr_b16 a[10:11], v146 offset:6144
s_waitcnt lgkmcnt(12)
v_mfma_f32_32x32x16_bf16 a[32:47], v[128:131], v[112:115], a[32:47]
ds_read_b64_tr_b16 a[12:13], v147 offset:4096
ds_read_b64_tr_b16 a[14:15], v147 offset:6144
s_waitcnt lgkmcnt(12)
v_mfma_f32_32x32x16_bf16 a[48:63], v[132:135], v[112:115], a[48:63]
s_waitcnt lgkmcnt(10)
v_mfma_f32_32x32x16_bf16 a[64:79], v[136:139], v[112:115], a[64:79]
s_waitcnt lgkmcnt(8)
v_mfma_f32_32x32x16_bf16 a[80:95], v[140:143], v[112:115], a[80:95]
s_waitcnt lgkmcnt(6)
v_mfma_f32_32x32x16_bf16 a[32:47], a[0:3], v[116:119], a[32:47]
s_waitcnt lgkmcnt(4)
v_mfma_f32_32x32x16_bf16 a[48:63], a[4:7], v[116:119], a[48:63]
s_waitcnt lgkmcnt(2)
v_mfma_f32_32x32x16_bf16 a[64:79], a[8:11], v[116:119], a[64:79]
s_waitcnt lgkmcnt(0)
v_mfma_f32_32x32x16_bf16 a[80:95], a[12:15], v[116:119], a[80:95]
s_barrier
s_nop 9
s_mov_b32 s57, s43
s_add_u32 s56, s49, 34
s_add_u32 s56, s56, s57
s_and_b32 s56, s56, 7
s_lshl_b32 s56, s56, 14
s_add_u32 s56, s56, 32768
s_add_u32 s56, s56, s51
v_mbcnt_lo_u32_b32 v155, -1, 0
v_mbcnt_hi_u32_b32 v155, -1, v155
v_lshlrev_b32 v155, 4, v155
v_add_u32 v155, s56, v155
s_cmp_eq_u32 s43, 1
s_cbranch_scc1 KH1_1
ds_write_b128 v155, a[64:67] offset:0
ds_write_b128 v155, a[68:71] offset:1024
ds_write_b128 v155, a[72:75] offset:2048
ds_write_b128 v155, a[76:79] offset:3072
ds_write_b128 v155, a[80:83] offset:4096
ds_write_b128 v155, a[84:87] offset:5120
ds_write_b128 v155, a[88:91] offset:6144
ds_write_b128 v155, a[92:95] offset:7168
s_branch KHD_1
KH1_1:
ds_write_b128 v155, a[32:35] offset:0
ds_write_b128 v155, a[36:39] offset:1024
ds_write_b128 v155, a[40:43] offset:2048
ds_write_b128 v155, a[44:47] offset:3072
ds_write_b128 v155, a[48:51] offset:4096
ds_write_b128 v155, a[52:55] offset:5120
ds_write_b128 v155, a[56:59] offset:6144
ds_write_b128 v155, a[60:63] offset:7168
KHD_1:
v_add_f32 v158, v158, v159
v_mov_b32 v159, v158
s_nop 1
v_permlane32_swap_b32 v158, v159
s_nop 0
v_add_f32 v158, v158, v159
v_mbcnt_lo_u32_b32 v155, -1, 0
v_mbcnt_hi_u32_b32 v155, -1, v155
v_lshlrev_b32 v155, 2, v155
v_add_u32 v155, s53, v155
ds_write_b32 v155, v158 offset:16384
s_waitcnt lgkmcnt(0)
s_barrier
s_xor_b32 s57, s43, 1
s_add_u32 s56, s49, 34
s_add_u32 s56, s56, s57
s_and_b32 s56, s56, 7
s_lshl_b32 s56, s56, 14
s_add_u32 s56, s56, 32768
s_add_u32 s56, s56, s51
v_mbcnt_lo_u32_b32 v155, -1, 0
v_mbcnt_hi_u32_b32 v155, -1, v155
v_lshlrev_b32 v155, 4, v155
v_add_u32 v155, s56, v155
ds_read_b128 v[0:3], v155 offset:0
ds_read_b128 v[4:7], v155 offset:1024
ds_read_b128 v[8:11], v155 offset:2048
ds_read_b128 v[12:15], v155 offset:3072
ds_read_b128 v[16:19], v155 offset:4096
ds_read_b128 v[20:23], v155 offset:5120
ds_read_b128 v[24:27], v155 offset:6144
ds_read_b128 v[28:31], v155 offset:7168
v_mbcnt_lo_u32_b32 v155, -1, 0
v_mbcnt_hi_u32_b32 v155, -1, v155
v_lshlrev_b32 v155, 2, v155
v_add_u32 v155, s52, v155
ds_read_b32 v159, v155 offset:16384
s_cmp_eq_u32 s43, 1
s_cbranch_scc1 KH1_2
v_accvgpr_read_b32 v32, a32
v_accvgpr_read_b32 v33, a33
v_accvgpr_read_b32 v34, a34
v_accvgpr_read_b32 v35, a35
v_accvgpr_read_b32 v36, a36
v_accvgpr_read_b32 v37, a37
v_accvgpr_read_b32 v38, a38
v_accvgpr_read_b32 v39, a39
v_accvgpr_read_b32 v40, a40
v_accvgpr_read_b32 v41, a41
v_accvgpr_read_b32 v42, a42
v_accvgpr_read_b32 v43, a43
v_accvgpr_read_b32 v44, a44
v_accvgpr_read_b32 v45, a45
v_accvgpr_read_b32 v46, a46
v_accvgpr_read_b32 v47, a47
v_accvgpr_read_b32 v48, a48
v_accvgpr_read_b32 v49, a49
v_accvgpr_read_b32 v50, a50
v_accvgpr_read_b32 v51, a51
v_accvgpr_read_b32 v52, a52
v_accvgpr_read_b32 v53, a53
v_accvgpr_read_b32 v54, a54
v_accvgpr_read_b32 v55, a55
v_accvgpr_read_b32 v56, a56
v_accvgpr_read_b32 v57, a57
v_accvgpr_read_b32 v58, a58
v_accvgpr_read_b32 v59, a59
v_accvgpr_read_b32 v60, a60
v_accvgpr_read_b32 v61, a61
v_accvgpr_read_b32 v62, a62
v_accvgpr_read_b32 v63, a63
s_branch KHD_2
KH1_2:
v_accvgpr_read_b32 v32, a64
v_accvgpr_read_b32 v33, a65
v_accvgpr_read_b32 v34, a66
v_accvgpr_read_b32 v35, a67
v_accvgpr_read_b32 v36, a68
v_accvgpr_read_b32 v37, a69
v_accvgpr_read_b32 v38, a70
v_accvgpr_read_b32 v39, a71
v_accvgpr_read_b32 v40, a72
v_accvgpr_read_b32 v41, a73
v_accvgpr_read_b32 v42, a74
v_accvgpr_read_b32 v43, a75
v_accvgpr_read_b32 v44, a76
v_accvgpr_read_b32 v45, a77
v_accvgpr_read_b32 v46, a78
v_accvgpr_read_b32 v47, a79
v_accvgpr_read_b32 v48, a80
v_accvgpr_read_b32 v49, a81
v_accvgpr_read_b32 v50, a82
v_accvgpr_read_b32 v51, a83
v_accvgpr_read_b32 v52, a84
v_accvgpr_read_b32 v53, a85
v_accvgpr_read_b32 v54, a86
v_accvgpr_read_b32 v55, a87
v_accvgpr_read_b32 v56, a88
v_accvgpr_read_b32 v57, a89
v_accvgpr_read_b32 v58, a90
v_accvgpr_read_b32 v59, a91
v_accvgpr_read_b32 v60, a92
v_accvgpr_read_b32 v61, a93
v_accvgpr_read_b32 v62, a94
v_accvgpr_read_b32 v63, a95
KHD_2:
s_waitcnt lgkmcnt(0)
v_add_f32 v158, v158, v159
v_rcp_f32 v158, v158
v_pk_add_f32 v[0:1], v[0:1], v[32:33]
v_pk_add_f32 v[2:3], v[2:3], v[34:35]
v_pk_add_f32 v[4:5], v[4:5], v[36:37]
v_pk_add_f32 v[6:7], v[6:7], v[38:39]
v_pk_add_f32 v[8:9], v[8:9], v[40:41]
v_pk_add_f32 v[10:11], v[10:11], v[42:43]
v_pk_add_f32 v[12:13], v[12:13], v[44:45]
v_pk_add_f32 v[14:15], v[14:15], v[46:47]
v_pk_add_f32 v[16:17], v[16:17], v[48:49]
v_pk_add_f32 v[18:19], v[18:19], v[50:51]
v_pk_add_f32 v[20:21], v[20:21], v[52:53]
v_pk_add_f32 v[22:23], v[22:23], v[54:55]
v_pk_add_f32 v[24:25], v[24:25], v[56:57]
v_pk_add_f32 v[26:27], v[26:27], v[58:59]
v_pk_add_f32 v[28:29], v[28:29], v[60:61]
v_pk_add_f32 v[30:31], v[30:31], v[62:63]
v_mov_b32 v159, v158
s_nop 0
v_pk_mul_f32 v[0:1], v[0:1], v[158:159]
v_pk_mul_f32 v[2:3], v[2:3], v[158:159]
v_pk_mul_f32 v[4:5], v[4:5], v[158:159]
v_pk_mul_f32 v[6:7], v[6:7], v[158:159]
v_pk_mul_f32 v[8:9], v[8:9], v[158:159]
v_pk_mul_f32 v[10:11], v[10:11], v[158:159]
v_pk_mul_f32 v[12:13], v[12:13], v[158:159]
v_pk_mul_f32 v[14:15], v[14:15], v[158:159]
v_pk_mul_f32 v[16:17], v[16:17], v[158:159]
v_pk_mul_f32 v[18:19], v[18:19], v[158:159]
v_pk_mul_f32 v[20:21], v[20:21], v[158:159]
v_pk_mul_f32 v[22:23], v[22:23], v[158:159]
v_pk_mul_f32 v[24:25], v[24:25], v[158:159]
v_pk_mul_f32 v[26:27], v[26:27], v[158:159]
v_pk_mul_f32 v[28:29], v[28:29], v[158:159]
v_pk_mul_f32 v[30:31], v[30:31], v[158:159]
v_cvt_pk_bf16_f32 v64, v0, v1
v_cvt_pk_bf16_f32 v65, v2, v3
v_cvt_pk_bf16_f32 v66, v4, v5
v_cvt_pk_bf16_f32 v67, v6, v7
v_cvt_pk_bf16_f32 v68, v8, v9
v_cvt_pk_bf16_f32 v69, v10, v11
v_cvt_pk_bf16_f32 v70, v12, v13
v_cvt_pk_bf16_f32 v71, v14, v15
v_cvt_pk_bf16_f32 v72, v16, v17
v_cvt_pk_bf16_f32 v73, v18, v19
v_cvt_pk_bf16_f32 v74, v20, v21
v_cvt_pk_bf16_f32 v75, v22, v23
v_cvt_pk_bf16_f32 v76, v24, v25
v_cvt_pk_bf16_f32 v77, v26, v27
v_cvt_pk_bf16_f32 v78, v28, v29
v_cvt_pk_bf16_f32 v79, v30, v31
v_mbcnt_lo_u32_b32 v155, -1, 0
v_mbcnt_hi_u32_b32 v155, -1, v155
v_lshlrev_b32 v155, 4, v155
v_add_u32 v155, s52, v155
ds_write_b128 v155, v[64:67] offset:16384
ds_write_b128 v155, v[68:71] offset:17408
ds_write_b128 v155, v[72:75] offset:18432
ds_write_b128 v155, v[76:79] offset:19456
s_waitcnt lgkmcnt(0)
s_barrier
s_barrier
s_add_u32 s49, s49, 36
s_cmp_eq_u32 s69, 2
s_cbranch_scc0 INIT2_done
s_waitcnt vmcnt(0)
s_mov_b64 exec, 1
s_lshl_b32 s38, s36, 3
v_mov_b32 v155, s38
v_mov_b32 v0, 1
global_atomic_add v155, v0, s[74:75] sc1
s_mov_b64 exec, -1
INIT2_done:
s_mov_b32 s47, 1
A_unit:
s_barrier
v_mbcnt_lo_u32_b32 v155, -1, 0
v_mbcnt_hi_u32_b32 v155, -1, v155
v_lshlrev_b32 v155, 4, v155
v_add_u32 v155, s51, v155
ds_read_b128 a[0:3], v155 offset:0
ds_read_b128 a[4:7], v155 offset:1024
ds_read_b128 a[8:11], v155 offset:2048
ds_read_b128 a[12:15], v155 offset:3072
ds_read_b128 a[16:19], v155 offset:4096
ds_read_b128 a[20:23], v155 offset:5120
ds_read_b128 a[24:27], v155 offset:6144
ds_read_b128 a[28:31], v155 offset:7168
s_waitcnt lgkmcnt(0)
s_add_u32 s46, s49, 0
s_and_b32 s46, s46, 7
s_lshl_b32 s46, s46, 14
s_add_u32 s46, s46, 32768
v_add_u32 v144, s46, v152
v_xor_b32 v145, 32, v144
v_xor_b32 v146, 64, v144
v_xor_b32 v147, 96, v144
v_xor_b32 v148, 128, v144
v_xor_b32 v149, 160, v144
v_xor_b32 v150, 192, v144
v_xor_b32 v151, 224, v144
ds_read_b128 v[128:131], v144
ds_read_b128 v[132:135], v145
ds_read_b128 v[136:139], v146
ds_read_b128 v[140:143], v147
ds_read_b128 a[32:35], v148
ds_read_b128 a[36:39], v149
ds_read_b128 a[40:43], v150
ds_read_b128 a[44:47], v151
s_waitcnt lgkmcnt(7)
v_mfma_f32_32x32x16_bf16 v[0:15], v[128:131], a[0:3], 0
s_barrier
s_barrier
s_add_u32 s46, s49, 1
s_and_b32 s46, s46, 7
s_lshl_b32 s46, s46, 14
s_add_u32 s46, s46, 32768
v_add_u32 v144, s46, v152
v_xor_b32 v145, 32, v144
v_xor_b32 v146, 64, v144
v_xor_b32 v147, 96, v144
v_xor_b32 v148, 128, v144
v_xor_b32 v149, 160, v144
v_xor_b32 v150, 192, v144
v_xor_b32 v151, 224, v144
ds_read_b128 v[128:131], v144
s_waitcnt lgkmcnt(7)
v_mfma_f32_32x32x16_bf16 v[0:15], v[132:135], a[4:7], v[0:15]
ds_read_b128 v[132:135], v145
s_waitcnt lgkmcnt(7)
v_mfma_f32_32x32x16_bf16 v[0:15], v[136:139], a[8:11], v[0:15]
ds_read_b128 v[136:139], v146
s_waitcnt lgkmcnt(7)
v_mfma_f32_32x32x16_bf16 v[0:15], v[140:143], a[12:15], v[0:15]
ds_read_b128 v[140:143], v147
s_waitcnt lgkmcnt(7)
v_mfma_f32_32x32x16_bf16 v[0:15], a[32:35], a[16:19], v[0:15]
ds_read_b128 a[32:35], v148
s_waitcnt lgkmcnt(7)
v_mfma_f32_32x32x16_bf16 v[0:15], a[36:39], a[20:23], v[0:15]
ds_read_b128 a[36:39], v149
s_waitcnt lgkmcnt(7)
v_mfma_f32_32x32x16_bf16 v[0:15], a[40:43], a[24:27], v[0:15]
ds_read_b128 a[40:43], v150
s_waitcnt lgkmcnt(7)
v_mfma_f32_32x32x16_bf16 v[0:15], a[44:47], a[28:31], v[0:15]
ds_read_b128 a[44:47], v151
s_waitcnt lgkmcnt(7)
v_mfma_f32_32x32x16_bf16 v[16:31], v[128:131], a[0:3], 0
s_barrier
s_add_u32 s46, s49, 3
s_and_b32 s46, s46, 7
s_lshl_b32 s46, s46, 14
s_add_u32 s46, s46, 32768
v_add_u32 v144, s46, v152
v_xor_b32 v145, 32, v144
v_xor_b32 v146, 64, v144
v_xor_b32 v147, 96, v144
v_xor_b32 v148, 128, v144
v_xor_b32 v149, 160, v144
v_xor_b32 v150, 192, v144
v_xor_b32 v151, 224, v144
ds_read_b128 v[128:131], v144
s_waitcnt lgkmcnt(7)
v_mfma_f32_32x32x16_bf16 v[16:31], v[132:135], a[4:7], v[16:31]
ds_read_b128 v[132:135], v145
s_waitcnt lgkmcnt(7)
v_mfma_f32_32x32x16_bf16 v[16:31], v[136:139], a[8:11], v[16:31]
ds_read_b128 v[136:139], v146
s_waitcnt lgkmcnt(7)
v_mfma_f32_32x32x16_bf16 v[16:31], v[140:143], a[12:15], v[16:31]
ds_read_b128 v[140:143], v147
s_waitcnt lgkmcnt(7)
v_mfma_f32_32x32x16_bf16 v[16:31], a[32:35], a[16:19], v[16:31]
v_max3_f32 v156, v0, v1, v2
ds_read_b128 a[32:35], v148
s_waitcnt lgkmcnt(7)
v_mfma_f32_32x32x16_bf16 v[16:31], a[36:39], a[20:23], v[16:31]
v_max3_f32 v157, v3, v4, v5
v_max3_f32 v156, v156, v6, v7
ds_read_b128 a[36:39], v149
s_waitcnt lgkmcnt(7)
v_mfma_f32_32x32x16_bf16 v[16:31], a[40:43], a[24:27], v[16:31]
v_max3_f32 v157, v157, v8, v9
v_max3_f32 v156, v156, v10, v11
ds_read_b128 a[40:43], v150
s_waitcnt lgkmcnt(7)
v_mfma_f32_32x32x16_bf16 v[16:31], a[44:47], a[28:31], v[16:31]
v_max3_f32 v157, v157, v12, v13
v_max3_f32 v156, v156, v14, v15
ds_read_b128 a[44:47], v151
s_waitcnt lgkmcnt(7)
v_mfma_f32_32x32x16_bf16 v[32:47], v[128:131], a[0:3], 0
s_barrier
s_barrier
s_add_u32 s46, s49, 4
s_and_b32 s46, s46, 7
s_lshl_b32 s46, s46, 14
s_add_u32 s46, s46, 32768
v_add_u32 v144, s46, v152
v_xor_b32 v145, 32, v144
v_xor_b32 v146, 64, v144
v_xor_b32 v147, 96, v144
v_xor_b32 v148, 128, v144
v_xor_b32 v149, 160, v144
v_xor_b32 v150, 192, v144
v_xor_b32 v151, 224, v144
ds_read_b128 v[128:131], v144
s_waitcnt lgkmcnt(7)
v_mfma_f32_32x32x16_bf16 v[32:47], v[132:135], a[4:7], v[32:47]
ds_read_b128 v[132:135], v145
s_waitcnt lgkmcnt(7)
v_mfma_f32_32x32x16_bf16 v[32:47], v[136:139], a[8:11], v[32:47]
ds_read_b128 v[136:139], v146
s_waitcnt lgkmcnt(7)
v_mfma_f32_32x32x16_bf16 v[32:47], v[140:143], a[12:15], v[32:47]
ds_read_b128 v[140:143], v147
s_waitcnt lgkmcnt(7)
v_mfma_f32_32x32x16_bf16 v[32:47], a[32:35], a[16:19], v[32:47]
v_max3_f32 v156, v156, v16, v17
v_max3_f32 v157, v157, v18, v19
ds_read_b128 a[32:35], v148
s_waitcnt lgkmcnt(7)
v_mfma_f32_32x32x16_bf16 v[32:47], a[36:39], a[20:23], v[32:47]
v_max3_f32 v156, v156, v20, v21
v_max3_f32 v157, v157, v22, v23
ds_read_b128 a[36:39], v149
s_waitcnt lgkmcnt(7)
v_mfma_f32_32x32x16_bf16 v[32:47], a[40:43], a[24:27], v[32:47]
v_max3_f32 v156, v156, v24, v25
v_max3_f32 v157, v157, v26, v27
ds_read_b128 a[40:43], v150
s_waitcnt lgkmcnt(7)
v_mfma_f32_32x32x16_bf16 v[32:47], a[44:47], a[28:31], v[32:47]
v_max3_f32 v156, v156, v28, v29
v_max3_f32 v157, v157, v30, v31
ds_read_b128 a[44:47], v151
s_waitcnt lgkmcnt(7)
v_mfma_f32_32x32x16_bf16 v[48:63], v[128:131], a[0:3], 0
s_barrier
s_add_u32 s46, s49, 6
s_and_b32 s46, s46, 7
s_lshl_b32 s46, s46, 14
s_add_u32 s46, s46, 32768
v_add_u32 v144, s46, v152
v_xor_b32 v145, 32, v144
v_xor_b32 v146, 64, v144
v_xor_b32 v147, 96, v144
v_xor_b32 v148, 128, v144
v_xor_b32 v149, 160, v144
v_xor_b32 v150, 192, v144
v_xor_b32 v151, 224, v144
ds_read_b128 v[128:131], v144
s_waitcnt lgkmcnt(7)
v_mfma_f32_32x32x16_bf16 v[48:63], v[132:135], a[4:7], v[48:63]
ds_read_b128 v[132:135], v145
s_waitcnt lgkmcnt(7)
v_mfma_f32_32x32x16_bf16 v[48:63], v[136:139], a[8:11], v[48:63]
ds_read_b128 v[136:139], v146
s_waitcnt lgkmcnt(7)
v_mfma_f32_32x32x16_bf16 v[48:63], v[140:143], a[12:15], v[48:63]
ds_read_b128 v[140:143], v147
s_waitcnt lgkmcnt(7)
v_mfma_f32_32x32x16_bf16 v[48:63], a[32:35], a[16:19], v[48:63]
v_max3_f32 v156, v156, v32, v33
v_max3_f32 v157, v157, v34, v35
ds_read_b128 a[32:35], v148
s_waitcnt lgkmcnt(7)
v_mfma_f32_32x32x16_bf16 v[48:63], a[36:39], a[20:23], v[48:63]
v_max3_f32 v156, v156, v36, v37
v_max3_f32 v157, v157, v38, v39
ds_read_b128 a[36:39], v149
s_waitcnt lgkmcnt(7)
v_mfma_f32_32x32x16_bf16 v[48:63], a[40:43], a[24:27], v[48:63]
v_max3_f32 v156, v156, v40, v41
v_max3_f32 v157, v157, v42, v43
ds_read_b128 a[40:43], v150
s_waitcnt lgkmcnt(7)
v_mfma_f32_32x32x16_bf16 v[48:63], a[44:47], a[28:31], v[48:63]
v_max3_f32 v156, v156, v44, v45
v_max3_f32 v157, v157, v46, v47
ds_read_b128 a[44:47], v151
s_waitcnt lgkmcnt(7)
v_mfma_f32_32x32x16_bf16 v[64:79], v[128:131], a[0:3], 0
s_barrier
s_barrier
s_add_u32 s46, s49, 7
s_and_b32 s46, s46, 7
s_lshl_b32 s46, s46, 14
s_add_u32 s46, s46, 32768
v_add_u32 v144, s46, v152
v_xor_b32 v145, 32, v144
v_xor_b32 v146, 64, v144
v_xor_b32 v147, 96, v144
v_xor_b32 v148, 128, v144
v_xor_b32 v149, 160, v144
v_xor_b32 v150, 192, v144
v_xor_b32 v151, 224, v144
ds_read_b128 v[128:131], v144
s_waitcnt lgkmcnt(7)
v_mfma_f32_32x32x16_bf16 v[64:79], v[132:135], a[4:7], v[64:79]
ds_read_b128 v[132:135], v145
s_waitcnt lgkmcnt(7)
v_mfma_f32_32x32x16_bf16 v[64:79], v[136:139], a[8:11], v[64:79]
ds_read_b128 v[136:139], v146
s_waitcnt lgkmcnt(7)
v_mfma_f32_32x32x16_bf16 v[64:79], v[140:143], a[12:15], v[64:79]
ds_read_b128 v[140:143], v147
s_waitcnt lgkmcnt(7)
v_mfma_f32_32x32x16_bf16 v[64:79], a[32:35], a[16:19], v[64:79]
v_max3_f32 v156, v156, v48, v49
v_max3_f32 v157, v157, v50, v51
ds_read_b128 a[32:35], v148
s_waitcnt lgkmcnt(7)
v_mfma_f32_32x32x16_bf16 v[64:79], a[36:39], a[20:23], v[64:79]
v_max3_f32 v156, v156, v52, v53
v_max3_f32 v157, v157, v54, v55
ds_read_b128 a[36:39], v149
s_waitcnt lgkmcnt(7)
v_mfma_f32_32x32x16_bf16 v[64:79], a[40:43], a[24:27], v[64:79]
v_max3_f32 v156, v156, v56, v57
v_max3_f32 v157, v157, v58, v59
ds_read_b128 a[40:43], v150
s_waitcnt lgkmcnt(7)
v_mfma_f32_32x32x16_bf16 v[64:79], a[44:47], a[28:31], v[64:79]
v_max3_f32 v156, v156, v60, v61
v_max3_f32 v157, v157, v62, v63
ds_read_b128 a[44:47], v151
s_waitcnt lgkmcnt(7)
v_mfma_f32_32x32x16_bf16 v[80:95], v[128:131], a[0:3], 0
s_barrier
s_add_u32 s46, s49, 9
s_and_b32 s46, s46, 7
s_lshl_b32 s46, s46, 14
s_add_u32 s46, s46, 32768
v_add_u32 v144, s46, v152
v_xor_b32 v145, 32, v144
v_xor_b32 v146, 64, v144
v_xor_b32 v147, 96, v144
v_xor_b32 v148, 128, v144
v_xor_b32 v149, 160, v144
v_xor_b32 v150, 192, v144
v_xor_b32 v151, 224, v144
ds_read_b128 v[128:131], v144
s_waitcnt lgkmcnt(7)
v_mfma_f32_32x32x16_bf16 v[80:95], v[132:135], a[4:7], v[80:95]
ds_read_b128 v[132:135], v145
s_waitcnt lgkmcnt(7)
v_mfma_f32_32x32x16_bf16 v[80:95], v[136:139], a[8:11], v[80:95]
ds_read_b128 v[136:139], v146
s_waitcnt lgkmcnt(7)
v_mfma_f32_32x32x16_bf16 v[80:95], v[140:143], a[12:15], v[80:95]
ds_read_b128 v[140:143], v147
s_waitcnt lgkmcnt(7)
v_mfma_f32_32x32x16_bf16 v[80:95], a[32:35], a[16:19], v[80:95]
v_max3_f32 v156, v156, v64, v65
v_max3_f32 v157, v157, v66, v67
ds_read_b128 a[32:35], v148
s_waitcnt lgkmcnt(7)
v_mfma_f32_32x32x16_bf16 v[80:95], a[36:39], a[20:23], v[80:95]
v_max3_f32 v156, v156, v68, v69
v_max3_f32 v157, v157, v70, v71
ds_read_b128 a[36:39], v149
s_waitcnt lgkmcnt(7)
v_mfma_f32_32x32x16_bf16 v[80:95], a[40:43], a[24:27], v[80:95]
v_max3_f32 v156, v156, v72, v73
v_max3_f32 v157, v157, v74, v75
ds_read_b128 a[40:43], v150
s_waitcnt lgkmcnt(7)
v_mfma_f32_32x32x16_bf16 v[80:95], a[44:47], a[28:31], v[80:95]
v_max3_f32 v156, v156, v76, v77
v_max3_f32 v157, v157, v78, v79
ds_read_b128 a[44:47], v151
s_waitcnt lgkmcnt(7)
v_mfma_f32_32x32x16_bf16 v[96:111], v[128:131], a[0:3], 0
s_barrier
s_barrier
s_barrier
s_add_u32 s46, s49, 10
s_and_b32 s46, s46, 7
s_lshl_b32 s46, s46, 14
s_add_u32 s46, s46, 32768
v_add_u32 v144, s46, v152
v_xor_b32 v145, 32, v144
v_xor_b32 v146, 64, v144
v_xor_b32 v147, 96, v144
v_xor_b32 v148, 128, v144
v_xor_b32 v149, 160, v144
v_xor_b32 v150, 192, v144
v_xor_b32 v151, 224, v144
ds_read_b128 v[128:131], v144
s_waitcnt lgkmcnt(7)
v_mfma_f32_32x32x16_bf16 v[96:111], v[132:135], a[4:7], v[96:111]
ds_read_b128 v[132:135], v145
s_waitcnt lgkmcnt(7)
v_mfma_f32_32x32x16_bf16 v[96:111], v[136:139], a[8:11], v[96:111]
ds_read_b128 v[136:139], v146
s_waitcnt lgkmcnt(7)
v_mfma_f32_32x32x16_bf16 v[96:111], v[140:143], a[12:15], v[96:111]
ds_read_b128 v[140:143], v147
s_waitcnt lgkmcnt(7)
v_mfma_f32_32x32x16_bf16 v[96:111], a[32:35], a[16:19], v[96:111]
v_max3_f32 v156, v156, v80, v81
v_max3_f32 v157, v157, v82, v83
ds_read_b128 a[32:35], v148
s_waitcnt lgkmcnt(7)
v_mfma_f32_32x32x16_bf16 v[96:111], a[36:39], a[20:23], v[96:111]
v_max3_f32 v156, v156, v84, v85
v_max3_f32 v157, v157, v86, v87
ds_read_b128 a[36:39], v149
s_waitcnt lgkmcnt(7)
v_mfma_f32_32x32x16_bf16 v[96:111], a[40:43], a[24:27], v[96:111]
v_max3_f32 v156, v156, v88, v89
v_max3_f32 v157, v157, v90, v91
ds_read_b128 a[40:43], v150
s_waitcnt lgkmcnt(7)
v_mfma_f32_32x32x16_bf16 v[96:111], a[44:47], a[28:31], v[96:111]
v_max3_f32 v156, v156, v92, v93
v_max3_f32 v157, v157, v94, v95
ds_read_b128 a[44:47], v151
s_waitcnt lgkmcnt(7)
v_mfma_f32_32x32x16_bf16 v[112:127], v[128:131], a[0:3], 0
s_waitcnt lgkmcnt(6)
v_mfma_f32_32x32x16_bf16 v[112:127], v[132:135], a[4:7], v[112:127]
s_waitcnt lgkmcnt(5)
v_mfma_f32_32x32x16_bf16 v[112:127], v[136:139], a[8:11], v[112:127]
s_waitcnt lgkmcnt(4)
v_mfma_f32_32x32x16_bf16 v[112:127], v[140:143], a[12:15], v[112:127]
s_waitcnt lgkmcnt(3)
v_mfma_f32_32x32x16_bf16 v[112:127], a[32:35], a[16:19], v[112:127]
v_max3_f32 v156, v156, v96, v97
v_max3_f32 v157, v157, v98, v99
s_waitcnt lgkmcnt(2)
v_mfma_f32_32x32x16_bf16 v[112:127], a[36:39], a[20:23], v[112:127]
v_max3_f32 v156, v156, v100, v101
v_max3_f32 v157, v157, v102, v103
s_waitcnt lgkmcnt(1)
v_mfma_f32_32x32x16_bf16 v[112:127], a[40:43], a[24:27], v[112:127]
v_max3_f32 v156, v156, v104, v105
v_max3_f32 v157, v157, v106, v107
s_waitcnt lgkmcnt(0)
v_mfma_f32_32x32x16_bf16 v[112:127], a[44:47], a[28:31], v[112:127]
v_max3_f32 v156, v156, v108, v109
v_max3_f32 v157, v157, v110, v111
s_nop 9
v_max3_f32 v156, v156, v112, v113
v_max3_f32 v157, v157, v114, v115
v_max3_f32 v156, v156, v116, v117
v_max3_f32 v157, v157, v118, v119
v_max3_f32 v156, v156, v120, v121
v_max3_f32 v157, v157, v122, v123
v_max3_f32 v156, v156, v124, v125
v_max3_f32 v157, v157, v126, v127
v_max_f32 v156, v156, v157
v_mov_b32 v157, v156
s_nop 1
v_permlane32_swap_b32 v156, v157
s_nop 0
v_max_f32 v156, v156, v157
v_mbcnt_lo_u32_b32 v155, -1, 0
v_mbcnt_hi_u32_b32 v155, -1, v155
v_lshlrev_b32 v155, 2, v155
v_add_u32 v155, s54, v155
ds_write_b32 v155, v156 offset:0
s_waitcnt lgkmcnt(0)
s_barrier
v_mbcnt_lo_u32_b32 v155, -1, 0
v_mbcnt_hi_u32_b32 v155, -1, v155
v_lshlrev_b32 v155, 2, v155
v_add_u32 v155, s55, v155
ds_read_b32 v157, v155 offset:0
v_mov_b32 v158, 0
v_mov_b32 v159, 0
s_waitcnt lgkmcnt(0)
v_max_f32 v156, v156, v157
v_mul_f32 v156, s44, v156
v_mov_b32 v157, v156
v_pk_fma_f32 v[0:1], v[0:1], s[44:45], v[156:157] neg_lo:[0,0,1] neg_hi:[0,0,1]
v_pk_fma_f32 v[2:3], v[2:3], s[44:45], v[156:157] neg_lo:[0,0,1] neg_hi:[0,0,1]
v_pk_fma_f32 v[4:5], v[4:5], s[44:45], v[156:157] neg_lo:[0,0,1] neg_hi:[0,0,1]
v_pk_fma_f32 v[6:7], v[6:7], s[44:45], v[156:157] neg_lo:[0,0,1] neg_hi:[0,0,1]
v_exp_f32 v0, v0
v_exp_f32 v1, v1
v_exp_f32 v2, v2
v_exp_f32 v3, v3
v_exp_f32 v4, v4
v_exp_f32 v5, v5
v_exp_f32 v6, v6
v_exp_f32 v7, v7
v_pk_add_f32 v[158:159], v[158:159], v[0:1]
v_pk_add_f32 v[158:159], v[158:159], v[2:3]
v_pk_add_f32 v[158:159], v[158:159], v[4:5]
v_pk_add_f32 v[158:159], v[158:159], v[6:7]
v_cvt_pk_bf16_f32 v0, v0, v1
v_cvt_pk_bf16_f32 v1, v2, v3
v_cvt_pk_bf16_f32 v2, v4, v5
v_cvt_pk_bf16_f32 v3, v6, v7
v_pk_fma_f32 v[8:9], v[8:9], s[44:45], v[156:157] neg_lo:[0,0,1] neg_hi:[0,0,1]
v_pk_fma_f32 v[10:11], v[10:11], s[44:45], v[156:157] neg_lo:[0,0,1] neg_hi:[0,0,1]
v_pk_fma_f32 v[12:13], v[12:13], s[44:45], v[156:157] neg_lo:[0,0,1] neg_hi:[0,0,1]
v_pk_fma_f32 v[14:15], v[14:15], s[44:45], v[156:157] neg_lo:[0,0,1] neg_hi:[0,0,1]
v_exp_f32 v8, v8
v_exp_f32 v9, v9
v_exp_f32 v10, v10
v_exp_f32 v11, v11
v_exp_f32 v12, v12
v_exp_f32 v13, v13
v_exp_f32 v14, v14
v_exp_f32 v15, v15
v_pk_add_f32 v[158:159], v[158:159], v[8:9]
v_pk_add_f32 v[158:159], v[158:159], v[10:11]
v_pk_add_f32 v[158:159], v[158:159], v[12:13]
v_pk_add_f32 v[158:159], v[158:159], v[14:15]
v_cvt_pk_bf16_f32 v4, v8, v9
v_cvt_pk_bf16_f32 v5, v10, v11
v_cvt_pk_bf16_f32 v6, v12, v13
v_cvt_pk_bf16_f32 v7, v14, v15
v_pk_fma_f32 v[16:17], v[16:17], s[44:45], v[156:157] neg_lo:[0,0,1] neg_hi:[0,0,1]
v_pk_fma_f32 v[18:19], v[18:19], s[44:45], v[156:157] neg_lo:[0,0,1] neg_hi:[0,0,1]
v_pk_fma_f32 v[20:21], v[20:21], s[44:45], v[156:157] neg_lo:[0,0,1] neg_hi:[0,0,1]
v_pk_fma_f32 v[22:23], v[22:23], s[44:45], v[156:157] neg_lo:[0,0,1] neg_hi:[0,0,1]
v_exp_f32 v16, v16
v_exp_f32 v17, v17
v_exp_f32 v18, v18
v_exp_f32 v19, v19
v_exp_f32 v20, v20
v_exp_f32 v21, v21
v_exp_f32 v22, v22
v_exp_f32 v23, v23
v_pk_add_f32 v[158:159], v[158:159], v[16:17]
v_pk_add_f32 v[158:159], v[158:159], v[18:19]
v_pk_add_f32 v[158:159], v[158:159], v[20:21]
v_pk_add_f32 v[158:159], v[158:159], v[22:23]
v_cvt_pk_bf16_f32 v16, v16, v17
v_cvt_pk_bf16_f32 v17, v18, v19
v_cvt_pk_bf16_f32 v18, v20, v21
v_cvt_pk_bf16_f32 v19, v22, v23
v_pk_fma_f32 v[24:25], v[24:25], s[44:45], v[156:157] neg_lo:[0,0,1] neg_hi:[0,0,1]
v_pk_fma_f32 v[26:27], v[26:27], s[44:45], v[156:157] neg_lo:[0,0,1] neg_hi:[0,0,1]
v_pk_fma_f32 v[28:29], v[28:29], s[44:45], v[156:157] neg_lo:[0,0,1] neg_hi:[0,0,1]
v_pk_fma_f32 v[30:31], v[30:31], s[44:45], v[156:157] neg_lo:[0,0,1] neg_hi:[0,0,1]
v_exp_f32 v24, v24
v_exp_f32 v25, v25
v_exp_f32 v26, v26
v_exp_f32 v27, v27
v_exp_f32 v28, v28
v_exp_f32 v29, v29
v_exp_f32 v30, v30
v_exp_f32 v31, v31
v_pk_add_f32 v[158:159], v[158:159], v[24:25]
v_pk_add_f32 v[158:159], v[158:159], v[26:27]
v_pk_add_f32 v[158:159], v[158:159], v[28:29]
v_pk_add_f32 v[158:159], v[158:159], v[30:31]
v_cvt_pk_bf16_f32 v20, v24, v25
v_cvt_pk_bf16_f32 v21, v26, v27
v_cvt_pk_bf16_f32 v22, v28, v29
v_cvt_pk_bf16_f32 v23, v30, v31
s_nop 1
s_barrier
s_add_u32 s46, s49, 13
s_and_b32 s46, s46, 7
s_lshl_b32 s46, s46, 14
s_add_u32 s46, s46, 32768
v_add_u32 v144, s46, v153
v_xor_b32 v145, 64, v144
v_xor_b32 v146, 128, v144
v_xor_b32 v147, 192, v144
ds_read_b64_tr_b16 v[128:129], v144 offset:0
ds_read_b64_tr_b16 v[130:131], v144 offset:2048
ds_read_b64_tr_b16 v[132:133], v145 offset:0
ds_read_b64_tr_b16 v[134:135], v145 offset:2048
ds_read_b64_tr_b16 v[136:137], v146 offset:0
ds_read_b64_tr_b16 v[138:139], v146 offset:2048
ds_read_b64_tr_b16 v[140:141], v147 offset:0
ds_read_b64_tr_b16 v[142:143], v147 offset:2048
ds_read_b64_tr_b16 a[0:1], v144 offset:4096
ds_read_b64_tr_b16 a[2:3], v144 offset:6144
ds_read_b64_tr_b16 a[4:5], v145 offset:4096
ds_read_b64_tr_b16 a[6:7], v145 offset:6144
ds_read_b64_tr_b16 a[8:9], v146 offset:4096
ds_read_b64_tr_b16 a[10:11], v146 offset:6144
s_waitcnt lgkmcnt(12)
v_mfma_f32_32x32x16_bf16 a[32:47], v[128:131], v[0:3], 0
v_pk_fma_f32 v[32:33], v[32:33], s[44:45], v[156:157] neg_lo:[0,0,1] neg_hi:[0,0,1]
v_pk_fma_f32 v[34:35], v[34:35], s[44:45], v[156:157] neg_lo:[0,0,1] neg_hi:[0,0,1]
v_pk_fma_f32 v[36:37], v[36:37], s[44:45], v[156:157] neg_lo:[0,0,1] neg_hi:[0,0,1]
v_pk_fma_f32 v[38:39], v[38:39], s[44:45], v[156:157] neg_lo:[0,0,1] neg_hi:[0,0,1]
v_exp_f32 v32, v32
ds_read_b64_tr_b16 a[12:13], v147 offset:4096
ds_read_b64_tr_b16 a[14:15], v147 offset:6144
s_waitcnt lgkmcnt(12)
v_mfma_f32_32x32x16_bf16 a[48:63], v[132:135], v[0:3], 0
v_exp_f32 v33, v33
v_exp_f32 v34, v34
v_exp_f32 v35, v35
v_exp_f32 v36, v36
v_exp_f32 v37, v37
s_barrier
s_add_u32 s46, s49, 14
s_and_b32 s46, s46, 7
s_lshl_b32 s46, s46, 14
s_add_u32 s46, s46, 32768
v_add_u32 v144, s46, v153
v_xor_b32 v145, 64, v144
v_xor_b32 v146, 128, v144
v_xor_b32 v147, 192, v144
ds_read_b64_tr_b16 v[128:129], v144 offset:0
ds_read_b64_tr_b16 v[130:131], v144 offset:2048
s_waitcnt lgkmcnt(12)
v_mfma_f32_32x32x16_bf16 a[64:79], v[136:139], v[0:3], 0
v_exp_f32 v38, v38
v_exp_f32 v39, v39
v_pk_add_f32 v[158:159], v[158:159], v[32:33]
v_pk_add_f32 v[158:159], v[158:159], v[34:35]
v_pk_add_f32 v[158:159], v[158:159], v[36:37]
ds_read_b64_tr_b16 v[132:133], v145 offset:0
ds_read_b64_tr_b16 v[134:135], v145 offset:2048
s_waitcnt lgkmcnt(12)
v_mfma_f32_32x32x16_bf16 a[80:95], v[140:143], v[0:3], 0
v_pk_add_f32 v[158:159], v[158:159], v[38:39]
v_cvt_pk_bf16_f32 v32, v32, v33
v_cvt_pk_bf16_f32 v33, v34, v35
v_cvt_pk_bf16_f32 v34, v36, v37
v_cvt_pk_bf16_f32 v35, v38, v39
ds_read_b64_tr_b16 v[136:137], v146 offset:0
ds_read_b64_tr_b16 v[138:139], v146 offset:2048
s_waitcnt lgkmcnt(12)
v_mfma_f32_32x32x16_bf16 a[32:47], a[0:3], v[4:7], a[32:47]
v_pk_fma_f32 v[40:41], v[40:41], s[44:45], v[156:157] neg_lo:[0,0,1] neg_hi:[0,0,1]
v_pk_fma_f32 v[42:43], v[42:43], s[44:45], v[156:157] neg_lo:[0,0,1] neg_hi:[0,0,1]
v_pk_fma_f32 v[44:45], v[44:45], s[44:45], v[156:157] neg_lo:[0,0,1] neg_hi:[0,0,1]
v_pk_fma_f32 v[46:47], v[46:47], s[44:45], v[156:157] neg_lo:[0,0,1] neg_hi:[0,0,1]
v_exp_f32 v40, v40
ds_read_b64_tr_b16 v[140:141], v147 offset:0
ds_read_b64_tr_b16 v[142:143], v147 offset:2048
s_waitcnt lgkmcnt(12)
v_mfma_f32_32x32x16_bf16 a[48:63], a[4:7], v[4:7], a[48:63]
v_exp_f32 v41, v41
v_exp_f32 v42, v42
v_exp_f32 v43, v43
v_exp_f32 v44, v44
v_exp_f32 v45, v45
ds_read_b64_tr_b16 a[0:1], v144 offset:4096
ds_read_b64_tr_b16 a[2:3], v144 offset:6144
s_waitcnt lgkmcnt(12)
v_mfma_f32_32x32x16_bf16 a[64:79], a[8:11], v[4:7], a[64:79]
v_exp_f32 v46, v46
v_exp_f32 v47, v47
v_pk_add_f32 v[158:159], v[158:159], v[40:41]
v_pk_add_f32 v[158:159], v[158:159], v[42:43]
v_pk_add_f32 v[158:159], v[158:159], v[44:45]
ds_read_b64_tr_b16 a[4:5], v145 offset:4096
ds_read_b64_tr_b16 a[6:7], v145 offset:6144
s_waitcnt lgkmcnt(12)
v_mfma_f32_32x32x16_bf16 a[80:95], a[12:15], v[4:7], a[80:95]
v_pk_add_f32 v[158:159], v[158:159], v[46:47]
v_cvt_pk_bf16_f32 v36, v40, v41
v_cvt_pk_bf16_f32 v37, v42, v43
v_cvt_pk_bf16_f32 v38, v44, v45
v_cvt_pk_bf16_f32 v39, v46, v47
ds_read_b64_tr_b16 a[8:9], v146 offset:4096
ds_read_b64_tr_b16 a[10:11], v146 offset:6144
s_waitcnt lgkmcnt(12)
v_mfma_f32_32x32x16_bf16 a[32:47], v[128:131], v[16:19], a[32:47]
v_pk_fma_f32 v[48:49], v[48:49], s[44:45], v[156:157] neg_lo:[0,0,1] neg_hi:[0,0,1]
v_pk_fma_f32 v[50:51], v[50:51], s[44:45], v[156:157] neg_lo:[0,0,1] neg_hi:[0,0,1]
v_pk_fma_f32 v[52:53], v[52:53], s[44:45], v[156:157] neg_lo:[0,0,1] neg_hi:[0,0,1]
v_pk_fma_f32 v[54:55], v[54:55], s[44:45], v[156:157] neg_lo:[0,0,1] neg_hi:[0,0,1]
v_exp_f32 v48, v48
ds_read_b64_tr_b16 a[12:13], v147 offset:4096
ds_read_b64_tr_b16 a[14:15], v147 offset:6144
s_waitcnt lgkmcnt(12)
v_mfma_f32_32x32x16_bf16 a[48:63], v[132:135], v[16:19], a[48:63]
v_exp_f32 v49, v49
v_exp_f32 v50, v50
v_exp_f32 v51, v51
v_exp_f32 v52, v52
v_exp_f32 v53, v53
s_barrier
s_add_u32 s46, s49, 16
s_and_b32 s46, s46, 7
s_lshl_b32 s46, s46, 14
s_add_u32 s46, s46, 32768
v_add_u32 v144, s46, v153
v_xor_b32 v145, 64, v144
v_xor_b32 v146, 128, v144
v_xor_b32 v147, 192, v144
ds_read_b64_tr_b16 v[128:129], v144 offset:0
ds_read_b64_tr_b16 v[130:131], v144 offset:2048
s_waitcnt lgkmcnt(12)
v_mfma_f32_32x32x16_bf16 a[64:79], v[136:139], v[16:19], a[64:79]
v_exp_f32 v54, v54
v_exp_f32 v55, v55
v_pk_add_f32 v[158:159], v[158:159], v[48:49]
v_pk_add_f32 v[158:159], v[158:159], v[50:51]
v_pk_add_f32 v[158:159], v[158:159], v[52:53]
ds_read_b64_tr_b16 v[132:133], v145 offset:0
ds_read_b64_tr_b16 v[134:135], v145 offset:2048
s_waitcnt lgkmcnt(12)
v_mfma_f32_32x32x16_bf16 a[80:95], v[140:143], v[16:19], a[80:95]
v_pk_add_f32 v[158:159], v[158:159], v[54:55]
v_cvt_pk_bf16_f32 v48, v48, v49
v_cvt_pk_bf16_f32 v49, v50, v51
v_cvt_pk_bf16_f32 v50, v52, v53
v_cvt_pk_bf16_f32 v51, v54, v55
ds_read_b64_tr_b16 v[136:137], v146 offset:0
ds_read_b64_tr_b16 v[138:139], v146 offset:2048
s_waitcnt lgkmcnt(12)
v_mfma_f32_32x32x16_bf16 a[32:47], a[0:3], v[20:23], a[32:47]
v_pk_fma_f32 v[56:57], v[56:57], s[44:45], v[156:157] neg_lo:[0,0,1] neg_hi:[0,0,1]
v_pk_fma_f32 v[58:59], v[58:59], s[44:45], v[156:157] neg_lo:[0,0,1] neg_hi:[0,0,1]
v_pk_fma_f32 v[60:61], v[60:61], s[44:45], v[156:157] neg_lo:[0,0,1] neg_hi:[0,0,1]
v_pk_fma_f32 v[62:63], v[62:63], s[44:45], v[156:157] neg_lo:[0,0,1] neg_hi:[0,0,1]
v_exp_f32 v56, v56
ds_read_b64_tr_b16 v[140:141], v147 offset:0
ds_read_b64_tr_b16 v[142:143], v147 offset:2048
s_waitcnt lgkmcnt(12)
v_mfma_f32_32x32x16_bf16 a[48:63], a[4:7], v[20:23], a[48:63]
v_exp_f32 v57, v57
v_exp_f32 v58, v58
v_exp_f32 v59, v59
v_exp_f32 v60, v60
v_exp_f32 v61, v61
ds_read_b64_tr_b16 a[0:1], v144 offset:4096
ds_read_b64_tr_b16 a[2:3], v144 offset:6144
s_waitcnt lgkmcnt(12)
v_mfma_f32_32x32x16_bf16 a[64:79], a[8:11], v[20:23], a[64:79]
v_exp_f32 v62, v62
v_exp_f32 v63, v63
v_pk_add_f32 v[158:159], v[158:159], v[56:57]
v_pk_add_f32 v[158:159], v[158:159], v[58:59]
v_pk_add_f32 v[158:159], v[158:159], v[60:61]
ds_read_b64_tr_b16 a[4:5], v145 offset:4096
ds_read_b64_tr_b16 a[6:7], v145 offset:6144
s_waitcnt lgkmcnt(12)
v_mfma_f32_32x32x16_bf16 a[80:95], a[12:15], v[20:23], a[80:95]
v_pk_add_f32 v[158:159], v[158:159], v[62:63]
v_cvt_pk_bf16_f32 v52, v56, v57
v_cvt_pk_bf16_f32 v53, v58, v59
v_cvt_pk_bf16_f32 v54, v60, v61
v_cvt_pk_bf16_f32 v55, v62, v63
ds_read_b64_tr_b16 a[8:9], v146 offset:4096
ds_read_b64_tr_b16 a[10:11], v146 offset:6144
s_waitcnt lgkmcnt(12)
v_mfma_f32_32x32x16_bf16 a[32:47], v[128:131], v[32:35], a[32:47]
v_pk_fma_f32 v[64:65], v[64:65], s[44:45], v[156:157] neg_lo:[0,0,1] neg_hi:[0,0,1]
v_pk_fma_f32 v[66:67], v[66:67], s[44:45], v[156:157] neg_lo:[0,0,1] neg_hi:[0,0,1]
v_pk_fma_f32 v[68:69], v[68:69], s[44:45], v[156:157] neg_lo:[0,0,1] neg_hi:[0,0,1]
v_pk_fma_f32 v[70:71], v[70:71], s[44:45], v[156:157] neg_lo:[0,0,1] neg_hi:[0,0,1]
v_exp_f32 v64, v64
ds_read_b64_tr_b16 a[12:13], v147 offset:4096
ds_read_b64_tr_b16 a[14:15], v147 offset:6144
s_waitcnt lgkmcnt(12)
v_mfma_f32_32x32x16_bf16 a[48:63], v[132:135], v[32:35], a[48:63]
v_exp_f32 v65, v65
v_exp_f32 v66, v66
v_exp_f32 v67, v67
v_exp_f32 v68, v68
v_exp_f32 v69, v69
s_barrier
s_barrier
s_add_u32 s46, s49, 17
s_and_b32 s46, s46, 7
s_lshl_b32 s46, s46, 14
s_add_u32 s46, s46, 32768
v_add_u32 v144, s46, v153
v_xor_b32 v145, 64, v144
v_xor_b32 v146, 128, v144
v_xor_b32 v147, 192, v144
ds_read_b64_tr_b16 v[128:129], v144 offset:0
ds_read_b64_tr_b16 v[130:131], v144 offset:2048
s_waitcnt lgkmcnt(12)
v_mfma_f32_32x32x16_bf16 a[64:79], v[136:139], v[32:35], a[64:79]
v_exp_f32 v70, v70
v_exp_f32 v71, v71
v_pk_add_f32 v[158:159], v[158:159], v[64:65]
v_pk_add_f32 v[158:159], v[158:159], v[66:67]
v_pk_add_f32 v[158:159], v[158:159], v[68:69]
ds_read_b64_tr_b16 v[132:133], v145 offset:0
ds_read_b64_tr_b16 v[134:135], v145 offset:2048
s_waitcnt lgkmcnt(12)
v_mfma_f32_32x32x16_bf16 a[80:95], v[140:143], v[32:35], a[80:95]
v_pk_add_f32 v[158:159], v[158:159], v[70:71]
v_cvt_pk_bf16_f32 v64, v64, v65
v_cvt_pk_bf16_f32 v65, v66, v67
v_cvt_pk_bf16_f32 v66, v68, v69
v_cvt_pk_bf16_f32 v67, v70, v71
ds_read_b64_tr_b16 v[136:137], v146 offset:0
ds_read_b64_tr_b16 v[138:139], v146 offset:2048
s_waitcnt lgkmcnt(12)
v_mfma_f32_32x32x16_bf16 a[32:47], a[0:3], v[36:39], a[32:47]
v_pk_fma_f32 v[72:73], v[72:73], s[44:45], v[156:157] neg_lo:[0,0,1] neg_hi:[0,0,1]
v_pk_fma_f32 v[74:75], v[74:75], s[44:45], v[156:157] neg_lo:[0,0,1] neg_hi:[0,0,1]
v_pk_fma_f32 v[76:77], v[76:77], s[44:45], v[156:157] neg_lo:[0,0,1] neg_hi:[0,0,1]
v_pk_fma_f32 v[78:79], v[78:79], s[44:45], v[156:157] neg_lo:[0,0,1] neg_hi:[0,0,1]
v_exp_f32 v72, v72
ds_read_b64_tr_b16 v[140:141], v147 offset:0
ds_read_b64_tr_b16 v[142:143], v147 offset:2048
s_waitcnt lgkmcnt(12)
v_mfma_f32_32x32x16_bf16 a[48:63], a[4:7], v[36:39], a[48:63]
v_exp_f32 v73, v73
v_exp_f32 v74, v74
v_exp_f32 v75, v75
v_exp_f32 v76, v76
v_exp_f32 v77, v77
ds_read_b64_tr_b16 a[0:1], v144 offset:4096
ds_read_b64_tr_b16 a[2:3], v144 offset:6144
s_waitcnt lgkmcnt(12)
v_mfma_f32_32x32x16_bf16 a[64:79], a[8:11], v[36:39], a[64:79]
v_exp_f32 v78, v78
v_exp_f32 v79, v79
v_pk_add_f32 v[158:159], v[158:159], v[72:73]
v_pk_add_f32 v[158:159], v[158:159], v[74:75]
v_pk_add_f32 v[158:159], v[158:159], v[76:77]
ds_read_b64_tr_b16 a[4:5], v145 offset:4096
ds_read_b64_tr_b16 a[6:7], v145 offset:6144
s_waitcnt lgkmcnt(12)
v_mfma_f32_32x32x16_bf16 a[80:95], a[12:15], v[36:39], a[80:95]
v_pk_add_f32 v[158:159], v[158:159], v[78:79]
v_cvt_pk_bf16_f32 v68, v72, v73
v_cvt_pk_bf16_f32 v69, v74, v75
v_cvt_pk_bf16_f32 v70, v76, v77
v_cvt_pk_bf16_f32 v71, v78, v79
ds_read_b64_tr_b16 a[8:9], v146 offset:4096
ds_read_b64_tr_b16 a[10:11], v146 offset:6144
s_waitcnt lgkmcnt(12)
v_mfma_f32_32x32x16_bf16 a[32:47], v[128:131], v[48:51], a[32:47]
v_pk_fma_f32 v[80:81], v[80:81], s[44:45], v[156:157] neg_lo:[0,0,1] neg_hi:[0,0,1]
v_pk_fma_f32 v[82:83], v[82:83], s[44:45], v[156:157] neg_lo:[0,0,1] neg_hi:[0,0,1]
v_pk_fma_f32 v[84:85], v[84:85], s[44:45], v[156:157] neg_lo:[0,0,1] neg_hi:[0,0,1]
v_pk_fma_f32 v[86:87], v[86:87], s[44:45], v[156:157] neg_lo:[0,0,1] neg_hi:[0,0,1]
v_exp_f32 v80, v80
ds_read_b64_tr_b16 a[12:13], v147 offset:4096
ds_read_b64_tr_b16 a[14:15], v147 offset:6144
s_waitcnt lgkmcnt(12)
v_mfma_f32_32x32x16_bf16 a[48:63], v[132:135], v[48:51], a[48:63]
v_exp_f32 v81, v81
v_exp_f32 v82, v82
v_exp_f32 v83, v83
v_exp_f32 v84, v84
v_exp_f32 v85, v85
s_barrier
s_add_u32 s46, s49, 19
s_and_b32 s46, s46, 7
s_lshl_b32 s46, s46, 14
s_add_u32 s46, s46, 32768
v_add_u32 v144, s46, v153
v_xor_b32 v145, 64, v144
v_xor_b32 v146, 128, v144
v_xor_b32 v147, 192, v144
ds_read_b64_tr_b16 v[128:129], v144 offset:0
ds_read_b64_tr_b16 v[130:131], v144 offset:2048
s_waitcnt lgkmcnt(12)
v_mfma_f32_32x32x16_bf16 a[64:79], v[136:139], v[48:51], a[64:79]
v_exp_f32 v86, v86
v_exp_f32 v87, v87
v_pk_add_f32 v[158:159], v[158:159], v[80:81]
v_pk_add_f32 v[158:159], v[158:159], v[82:83]
v_pk_add_f32 v[158:159], v[158:159], v[84:85]
ds_read_b64_tr_b16 v[132:133], v145 offset:0
ds_read_b64_tr_b16 v[134:135], v145 offset:2048
s_waitcnt lgkmcnt(12)
v_mfma_f32_32x32x16_bf16 a[80:95], v[140:143], v[48:51], a[80:95]
v_pk_add_f32 v[158:159], v[158:159], v[86:87]
v_cvt_pk_bf16_f32 v80, v80, v81
v_cvt_pk_bf16_f32 v81, v82, v83
v_cvt_pk_bf16_f32 v82, v84, v85
v_cvt_pk_bf16_f32 v83, v86, v87
ds_read_b64_tr_b16 v[136:137], v146 offset:0
ds_read_b64_tr_b16 v[138:139], v146 offset:2048
s_waitcnt lgkmcnt(12)
v_mfma_f32_32x32x16_bf16 a[32:47], a[0:3], v[52:55], a[32:47]
v_pk_fma_f32 v[88:89], v[88:89], s[44:45], v[156:157] neg_lo:[0,0,1] neg_hi:[0,0,1]
v_pk_fma_f32 v[90:91], v[90:91], s[44:45], v[156:157] neg_lo:[0,0,1] neg_hi:[0,0,1]
v_pk_fma_f32 v[92:93], v[92:93], s[44:45], v[156:157] neg_lo:[0,0,1] neg_hi:[0,0,1]
v_pk_fma_f32 v[94:95], v[94:95], s[44:45], v[156:157] neg_lo:[0,0,1] neg_hi:[0,0,1]
v_exp_f32 v88, v88
ds_read_b64_tr_b16 v[140:141], v147 offset:0
ds_read_b64_tr_b16 v[142:143], v147 offset:2048
s_waitcnt lgkmcnt(12)
v_mfma_f32_32x32x16_bf16 a[48:63], a[4:7], v[52:55], a[48:63]
v_exp_f32 v89, v89
v_exp_f32 v90, v90
v_exp_f32 v91, v91
v_exp_f32 v92, v92
v_exp_f32 v93, v93
ds_read_b64_tr_b16 a[0:1], v144 offset:4096
ds_read_b64_tr_b16 a[2:3], v144 offset:6144
s_waitcnt lgkmcnt(12)
v_mfma_f32_32x32x16_bf16 a[64:79], a[8:11], v[52:55], a[64:79]
v_exp_f32 v94, v94
v_exp_f32 v95, v95
v_pk_add_f32 v[158:159], v[158:159], v[88:89]
v_pk_add_f32 v[158:159], v[158:159], v[90:91]
v_pk_add_f32 v[158:159], v[158:159], v[92:93]
ds_read_b64_tr_b16 a[4:5], v145 offset:4096
ds_read_b64_tr_b16 a[6:7], v145 offset:6144
s_waitcnt lgkmcnt(12)
v_mfma_f32_32x32x16_bf16 a[80:95], a[12:15], v[52:55], a[80:95]
v_pk_add_f32 v[158:159], v[158:159], v[94:95]
v_cvt_pk_bf16_f32 v84, v88, v89
v_cvt_pk_bf16_f32 v85, v90, v91
v_cvt_pk_bf16_f32 v86, v92, v93
v_cvt_pk_bf16_f32 v87, v94, v95
ds_read_b64_tr_b16 a[8:9], v146 offset:4096
ds_read_b64_tr_b16 a[10:11], v146 offset:6144
s_waitcnt lgkmcnt(12)
v_mfma_f32_32x32x16_bf16 a[32:47], v[128:131], v[64:67], a[32:47]
v_pk_fma_f32 v[96:97], v[96:97], s[44:45], v[156:157] neg_lo:[0,0,1] neg_hi:[0,0,1]
v_pk_fma_f32 v[98:99], v[98:99], s[44:45], v[156:157] neg_lo:[0,0,1] neg_hi:[0,0,1]
v_pk_fma_f32 v[100:101], v[100:101], s[44:45], v[156:157] neg_lo:[0,0,1] neg_hi:[0,0,1]
v_pk_fma_f32 v[102:103], v[102:103], s[44:45], v[156:157] neg_lo:[0,0,1] neg_hi:[0,0,1]
v_exp_f32 v96, v96
ds_read_b64_tr_b16 a[12:13], v147 offset:4096
ds_read_b64_tr_b16 a[14:15], v147 offset:6144
s_waitcnt lgkmcnt(12)
v_mfma_f32_32x32x16_bf16 a[48:63], v[132:135], v[64:67], a[48:63]
v_exp_f32 v97, v97
v_exp_f32 v98, v98
v_exp_f32 v99, v99
v_exp_f32 v100, v100
v_exp_f32 v101, v101
s_barrier
s_barrier
s_add_u32 s46, s49, 20
s_and_b32 s46, s46, 7
s_lshl_b32 s46, s46, 14
s_add_u32 s46, s46, 32768
v_add_u32 v144, s46, v153
v_xor_b32 v145, 64, v144
v_xor_b32 v146, 128, v144
v_xor_b32 v147, 192, v144
ds_read_b64_tr_b16 v[128:129], v144 offset:0
ds_read_b64_tr_b16 v[130:131], v144 offset:2048
s_waitcnt lgkmcnt(12)
v_mfma_f32_32x32x16_bf16 a[64:79], v[136:139], v[64:67], a[64:79]
v_exp_f32 v102, v102
v_exp_f32 v103, v103
v_pk_add_f32 v[158:159], v[158:159], v[96:97]
v_pk_add_f32 v[158:159], v[158:159], v[98:99]
v_pk_add_f32 v[158:159], v[158:159], v[100:101]
ds_read_b64_tr_b16 v[132:133], v145 offset:0
ds_read_b64_tr_b16 v[134:135], v145 offset:2048
s_waitcnt lgkmcnt(12)
v_mfma_f32_32x32x16_bf16 a[80:95], v[140:143], v[64:67], a[80:95]
v_pk_add_f32 v[158:159], v[158:159], v[102:103]
v_cvt_pk_bf16_f32 v96, v96, v97
v_cvt_pk_bf16_f32 v97, v98, v99
v_cvt_pk_bf16_f32 v98, v100, v101
v_cvt_pk_bf16_f32 v99, v102, v103
ds_read_b64_tr_b16 v[136:137], v146 offset:0
ds_read_b64_tr_b16 v[138:139], v146 offset:2048
s_waitcnt lgkmcnt(12)
v_mfma_f32_32x32x16_bf16 a[32:47], a[0:3], v[68:71], a[32:47]
v_pk_fma_f32 v[104:105], v[104:105], s[44:45], v[156:157] neg_lo:[0,0,1] neg_hi:[0,0,1]
v_pk_fma_f32 v[106:107], v[106:107], s[44:45], v[156:157] neg_lo:[0,0,1] neg_hi:[0,0,1]
v_pk_fma_f32 v[108:109], v[108:109], s[44:45], v[156:157] neg_lo:[0,0,1] neg_hi:[0,0,1]
v_pk_fma_f32 v[110:111], v[110:111], s[44:45], v[156:157] neg_lo:[0,0,1] neg_hi:[0,0,1]
v_exp_f32 v104, v104
ds_read_b64_tr_b16 v[140:141], v147 offset:0
ds_read_b64_tr_b16 v[142:143], v147 offset:2048
s_waitcnt lgkmcnt(12)
v_mfma_f32_32x32x16_bf16 a[48:63], a[4:7], v[68:71], a[48:63]
v_exp_f32 v105, v105
v_exp_f32 v106, v106
v_exp_f32 v107, v107
v_exp_f32 v108, v108
v_exp_f32 v109, v109
ds_read_b64_tr_b16 a[0:1], v144 offset:4096
ds_read_b64_tr_b16 a[2:3], v144 offset:6144
s_waitcnt lgkmcnt(12)
v_mfma_f32_32x32x16_bf16 a[64:79], a[8:11], v[68:71], a[64:79]
v_exp_f32 v110, v110
v_exp_f32 v111, v111
v_pk_add_f32 v[158:159], v[158:159], v[104:105]
v_pk_add_f32 v[158:159], v[158:159], v[106:107]
v_pk_add_f32 v[158:159], v[158:159], v[108:109]
ds_read_b64_tr_b16 a[4:5], v145 offset:4096
ds_read_b64_tr_b16 a[6:7], v145 offset:6144
s_waitcnt lgkmcnt(12)
v_mfma_f32_32x32x16_bf16 a[80:95], a[12:15], v[68:71], a[80:95]
v_pk_add_f32 v[158:159], v[158:159], v[110:111]
v_cvt_pk_bf16_f32 v100, v104, v105
v_cvt_pk_bf16_f32 v101, v106, v107
v_cvt_pk_bf16_f32 v102, v108, v109
v_cvt_pk_bf16_f32 v103, v110, v111
ds_read_b64_tr_b16 a[8:9], v146 offset:4096
ds_read_b64_tr_b16 a[10:11], v146 offset:6144
s_waitcnt lgkmcnt(12)
v_mfma_f32_32x32x16_bf16 a[32:47], v[128:131], v[80:83], a[32:47]
v_pk_fma_f32 v[112:113], v[112:113], s[44:45], v[156:157] neg_lo:[0,0,1] neg_hi:[0,0,1]
v_pk_fma_f32 v[114:115], v[114:115], s[44:45], v[156:157] neg_lo:[0,0,1] neg_hi:[0,0,1]
v_pk_fma_f32 v[116:117], v[116:117], s[44:45], v[156:157] neg_lo:[0,0,1] neg_hi:[0,0,1]
v_pk_fma_f32 v[118:119], v[118:119], s[44:45], v[156:157] neg_lo:[0,0,1] neg_hi:[0,0,1]
v_exp_f32 v112, v112
ds_read_b64_tr_b16 a[12:13], v147 offset:4096
ds_read_b64_tr_b16 a[14:15], v147 offset:6144
s_waitcnt lgkmcnt(12)
v_mfma_f32_32x32x16_bf16 a[48:63], v[132:135], v[80:83], a[48:63]
v_exp_f32 v113, v113
v_exp_f32 v114, v114
v_exp_f32 v115, v115
v_exp_f32 v116, v116
v_exp_f32 v117, v117
s_barrier
s_add_u32 s46, s49, 22
s_and_b32 s46, s46, 7
s_lshl_b32 s46, s46, 14
s_add_u32 s46, s46, 32768
v_add_u32 v144, s46, v153
v_xor_b32 v145, 64, v144
v_xor_b32 v146, 128, v144
v_xor_b32 v147, 192, v144
ds_read_b64_tr_b16 v[128:129], v144 offset:0
ds_read_b64_tr_b16 v[130:131], v144 offset:2048
s_waitcnt lgkmcnt(12)
v_mfma_f32_32x32x16_bf16 a[64:79], v[136:139], v[80:83], a[64:79]
v_exp_f32 v118, v118
v_exp_f32 v119, v119
v_pk_add_f32 v[158:159], v[158:159], v[112:113]
v_pk_add_f32 v[158:159], v[158:159], v[114:115]
v_pk_add_f32 v[158:159], v[158:159], v[116:117]
ds_read_b64_tr_b16 v[132:133], v145 offset:0
ds_read_b64_tr_b16 v[134:135], v145 offset:2048
s_waitcnt lgkmcnt(12)
v_mfma_f32_32x32x16_bf16 a[80:95], v[140:143], v[80:83], a[80:95]
v_pk_add_f32 v[158:159], v[158:159], v[118:119]
v_cvt_pk_bf16_f32 v112, v112, v113
v_cvt_pk_bf16_f32 v113, v114, v115
v_cvt_pk_bf16_f32 v114, v116, v117
v_cvt_pk_bf16_f32 v115, v118, v119
ds_read_b64_tr_b16 v[136:137], v146 offset:0
ds_read_b64_tr_b16 v[138:139], v146 offset:2048
s_waitcnt lgkmcnt(12)
v_mfma_f32_32x32x16_bf16 a[32:47], a[0:3], v[84:87], a[32:47]
v_pk_fma_f32 v[120:121], v[120:121], s[44:45], v[156:157] neg_lo:[0,0,1] neg_hi:[0,0,1]
v_pk_fma_f32 v[122:123], v[122:123], s[44:45], v[156:157] neg_lo:[0,0,1] neg_hi:[0,0,1]
v_pk_fma_f32 v[124:125], v[124:125], s[44:45], v[156:157] neg_lo:[0,0,1] neg_hi:[0,0,1]
v_pk_fma_f32 v[126:127], v[126:127], s[44:45], v[156:157] neg_lo:[0,0,1] neg_hi:[0,0,1]
v_exp_f32 v120, v120
ds_read_b64_tr_b16 v[140:141], v147 offset:0
ds_read_b64_tr_b16 v[142:143], v147 offset:2048
s_waitcnt lgkmcnt(12)
v_mfma_f32_32x32x16_bf16 a[48:63], a[4:7], v[84:87], a[48:63]
v_exp_f32 v121, v121
v_exp_f32 v122, v122
v_exp_f32 v123, v123
v_exp_f32 v124, v124
v_exp_f32 v125, v125
ds_read_b64_tr_b16 a[0:1], v144 offset:4096
ds_read_b64_tr_b16 a[2:3], v144 offset:6144
s_waitcnt lgkmcnt(12)
v_mfma_f32_32x32x16_bf16 a[64:79], a[8:11], v[84:87], a[64:79]
v_exp_f32 v126, v126
v_exp_f32 v127, v127
v_pk_add_f32 v[158:159], v[158:159], v[120:121]
v_pk_add_f32 v[158:159], v[158:159], v[122:123]
v_pk_add_f32 v[158:159], v[158:159], v[124:125]
ds_read_b64_tr_b16 a[4:5], v145 offset:4096
ds_read_b64_tr_b16 a[6:7], v145 offset:6144
s_waitcnt lgkmcnt(12)
v_mfma_f32_32x32x16_bf16 a[80:95], a[12:15], v[84:87], a[80:95]
v_pk_add_f32 v[158:159], v[158:159], v[126:127]
v_cvt_pk_bf16_f32 v116, v120, v121
v_cvt_pk_bf16_f32 v117, v122, v123
v_cvt_pk_bf16_f32 v118, v124, v125
v_cvt_pk_bf16_f32 v119, v126, v127
ds_read_b64_tr_b16 a[8:9], v146 offset:4096
ds_read_b64_tr_b16 a[10:11], v146 offset:6144
s_waitcnt lgkmcnt(12)
v_mfma_f32_32x32x16_bf16 a[32:47], v[128:131], v[96:99], a[32:47]
ds_read_b64_tr_b16 a[12:13], v147 offset:4096
ds_read_b64_tr_b16 a[14:15], v147 offset:6144
s_waitcnt lgkmcnt(12)
v_mfma_f32_32x32x16_bf16 a[48:63], v[132:135], v[96:99], a[48:63]
s_barrier
s_add_u32 s46, s49, 23
s_and_b32 s46, s46, 7
s_lshl_b32 s46, s46, 14
s_add_u32 s46, s46, 32768
v_add_u32 v144, s46, v153
v_xor_b32 v145, 64, v144
v_xor_b32 v146, 128, v144
v_xor_b32 v147, 192, v144
ds_read_b64_tr_b16 v[128:129], v144 offset:0
ds_read_b64_tr_b16 v[130:131], v144 offset:2048
s_waitcnt lgkmcnt(12)
v_mfma_f32_32x32x16_bf16 a[64:79], v[136:139], v[96:99], a[64:79]
ds_read_b64_tr_b16 v[132:133], v145 offset:0
ds_read_b64_tr_b16 v[134:135], v145 offset:2048
s_waitcnt lgkmcnt(12)
v_mfma_f32_32x32x16_bf16 a[80:95], v[140:143], v[96:99], a[80:95]
ds_read_b64_tr_b16 v[136:137], v146 offset:0
ds_read_b64_tr_b16 v[138:139], v146 offset:2048
s_waitcnt lgkmcnt(12)
v_mfma_f32_32x32x16_bf16 a[32:47], a[0:3], v[100:103], a[32:47]
ds_read_b64_tr_b16 v[140:141], v147 offset:0
ds_read_b64_tr_b16 v[142:143], v147 offset:2048
s_waitcnt lgkmcnt(12)
v_mfma_f32_32x32x16_bf16 a[48:63], a[4:7], v[100:103], a[48:63]
ds_read_b64_tr_b16 a[0:1], v144 offset:4096
ds_read_b64_tr_b16 a[2:3], v144 offset:6144
s_waitcnt lgkmcnt(12)
v_mfma_f32_32x32x16_bf16 a[64:79], a[8:11], v[100:103], a[64:79]
ds_read_b64_tr_b16 a[4:5], v145 offset:4096
ds_read_b64_tr_b16 a[6:7], v145 offset:6144
s_waitcnt lgkmcnt(12)
v_mfma_f32_32x32x16_bf16 a[80:95], a[12:15], v[100:103], a[80:95]
ds_read_b64_tr_b16 a[8:9], v146 offset:4096
ds_read_b64_tr_b16 a[10:11], v146 offset:6144
s_waitcnt lgkmcnt(12)
v_mfma_f32_32x32x16_bf16 a[32:47], v[128:131], v[112:115], a[32:47]
ds_read_b64_tr_b16 a[12:13], v147 offset:4096
ds_read_b64_tr_b16 a[14:15], v147 offset:6144
s_waitcnt lgkmcnt(12)
v_mfma_f32_32x32x16_bf16 a[48:63], v[132:135], v[112:115], a[48:63]
s_waitcnt lgkmcnt(10)
v_mfma_f32_32x32x16_bf16 a[64:79], v[136:139], v[112:115], a[64:79]
s_waitcnt lgkmcnt(8)
v_mfma_f32_32x32x16_bf16 a[80:95], v[140:143], v[112:115], a[80:95]
s_waitcnt lgkmcnt(6)
v_mfma_f32_32x32x16_bf16 a[32:47], a[0:3], v[116:119], a[32:47]
s_waitcnt lgkmcnt(4)
v_mfma_f32_32x32x16_bf16 a[48:63], a[4:7], v[116:119], a[48:63]
s_waitcnt lgkmcnt(2)
v_mfma_f32_32x32x16_bf16 a[64:79], a[8:11], v[116:119], a[64:79]
s_waitcnt lgkmcnt(0)
v_mfma_f32_32x32x16_bf16 a[80:95], a[12:15], v[116:119], a[80:95]
s_nop 9
s_mov_b32 s57, s43
s_add_u32 s56, s49, 25
s_add_u32 s56, s56, s57
s_and_b32 s56, s56, 7
s_lshl_b32 s56, s56, 14
s_add_u32 s56, s56, 32768
s_add_u32 s56, s56, s51
v_mbcnt_lo_u32_b32 v155, -1, 0
v_mbcnt_hi_u32_b32 v155, -1, v155
v_lshlrev_b32 v155, 4, v155
v_add_u32 v155, s56, v155
s_cmp_eq_u32 s43, 1
s_cbranch_scc1 KH1_3
ds_write_b128 v155, a[64:67] offset:0
ds_write_b128 v155, a[68:71] offset:1024
ds_write_b128 v155, a[72:75] offset:2048
ds_write_b128 v155, a[76:79] offset:3072
ds_write_b128 v155, a[80:83] offset:4096
ds_write_b128 v155, a[84:87] offset:5120
ds_write_b128 v155, a[88:91] offset:6144
ds_write_b128 v155, a[92:95] offset:7168
s_branch KHD_3
KH1_3:
ds_write_b128 v155, a[32:35] offset:0
ds_write_b128 v155, a[36:39] offset:1024
ds_write_b128 v155, a[40:43] offset:2048
ds_write_b128 v155, a[44:47] offset:3072
ds_write_b128 v155, a[48:51] offset:4096
ds_write_b128 v155, a[52:55] offset:5120
ds_write_b128 v155, a[56:59] offset:6144
ds_write_b128 v155, a[60:63] offset:7168
KHD_3:
v_add_f32 v158, v158, v159
v_mov_b32 v159, v158
s_nop 1
v_permlane32_swap_b32 v158, v159
s_nop 0
v_add_f32 v158, v158, v159
v_mbcnt_lo_u32_b32 v155, -1, 0
v_mbcnt_hi_u32_b32 v155, -1, v155
v_lshlrev_b32 v155, 2, v155
v_add_u32 v155, s53, v155
ds_write_b32 v155, v158 offset:16384
s_waitcnt lgkmcnt(0)
s_barrier
s_xor_b32 s57, s43, 1
s_add_u32 s56, s49, 25
s_add_u32 s56, s56, s57
s_and_b32 s56, s56, 7
s_lshl_b32 s56, s56, 14
s_add_u32 s56, s56, 32768
s_add_u32 s56, s56, s51
v_mbcnt_lo_u32_b32 v155, -1, 0
v_mbcnt_hi_u32_b32 v155, -1, v155
v_lshlrev_b32 v155, 4, v155
v_add_u32 v155, s56, v155
ds_read_b128 v[0:3], v155 offset:0
ds_read_b128 v[4:7], v155 offset:1024
ds_read_b128 v[8:11], v155 offset:2048
ds_read_b128 v[12:15], v155 offset:3072
ds_read_b128 v[16:19], v155 offset:4096
ds_read_b128 v[20:23], v155 offset:5120
ds_read_b128 v[24:27], v155 offset:6144
ds_read_b128 v[28:31], v155 offset:7168
v_mbcnt_lo_u32_b32 v155, -1, 0
v_mbcnt_hi_u32_b32 v155, -1, v155
v_lshlrev_b32 v155, 2, v155
v_add_u32 v155, s52, v155
ds_read_b32 v159, v155 offset:16384
s_cmp_eq_u32 s43, 1
s_cbranch_scc1 KH1_4
v_accvgpr_read_b32 v32, a32
v_accvgpr_read_b32 v33, a33
v_accvgpr_read_b32 v34, a34
v_accvgpr_read_b32 v35, a35
v_accvgpr_read_b32 v36, a36
v_accvgpr_read_b32 v37, a37
v_accvgpr_read_b32 v38, a38
v_accvgpr_read_b32 v39, a39
v_accvgpr_read_b32 v40, a40
v_accvgpr_read_b32 v41, a41
v_accvgpr_read_b32 v42, a42
v_accvgpr_read_b32 v43, a43
v_accvgpr_read_b32 v44, a44
v_accvgpr_read_b32 v45, a45
v_accvgpr_read_b32 v46, a46
v_accvgpr_read_b32 v47, a47
v_accvgpr_read_b32 v48, a48
v_accvgpr_read_b32 v49, a49
v_accvgpr_read_b32 v50, a50
v_accvgpr_read_b32 v51, a51
v_accvgpr_read_b32 v52, a52
v_accvgpr_read_b32 v53, a53
v_accvgpr_read_b32 v54, a54
v_accvgpr_read_b32 v55, a55
v_accvgpr_read_b32 v56, a56
v_accvgpr_read_b32 v57, a57
v_accvgpr_read_b32 v58, a58
v_accvgpr_read_b32 v59, a59
v_accvgpr_read_b32 v60, a60
v_accvgpr_read_b32 v61, a61
v_accvgpr_read_b32 v62, a62
v_accvgpr_read_b32 v63, a63
s_branch KHD_4
KH1_4:
v_accvgpr_read_b32 v32, a64
v_accvgpr_read_b32 v33, a65
v_accvgpr_read_b32 v34, a66
v_accvgpr_read_b32 v35, a67
v_accvgpr_read_b32 v36, a68
v_accvgpr_read_b32 v37, a69
v_accvgpr_read_b32 v38, a70
v_accvgpr_read_b32 v39, a71
v_accvgpr_read_b32 v40, a72
v_accvgpr_read_b32 v41, a73
v_accvgpr_read_b32 v42, a74
v_accvgpr_read_b32 v43, a75
v_accvgpr_read_b32 v44, a76
v_accvgpr_read_b32 v45, a77
v_accvgpr_read_b32 v46, a78
v_accvgpr_read_b32 v47, a79
v_accvgpr_read_b32 v48, a80
v_accvgpr_read_b32 v49, a81
v_accvgpr_read_b32 v50, a82
v_accvgpr_read_b32 v51, a83
v_accvgpr_read_b32 v52, a84
v_accvgpr_read_b32 v53, a85
v_accvgpr_read_b32 v54, a86
v_accvgpr_read_b32 v55, a87
v_accvgpr_read_b32 v56, a88
v_accvgpr_read_b32 v57, a89
v_accvgpr_read_b32 v58, a90
v_accvgpr_read_b32 v59, a91
v_accvgpr_read_b32 v60, a92
v_accvgpr_read_b32 v61, a93
v_accvgpr_read_b32 v62, a94
v_accvgpr_read_b32 v63, a95
KHD_4:
s_waitcnt lgkmcnt(0)
v_add_f32 v158, v158, v159
v_rcp_f32 v158, v158
v_pk_add_f32 v[0:1], v[0:1], v[32:33]
v_pk_add_f32 v[2:3], v[2:3], v[34:35]
v_pk_add_f32 v[4:5], v[4:5], v[36:37]
v_pk_add_f32 v[6:7], v[6:7], v[38:39]
v_pk_add_f32 v[8:9], v[8:9], v[40:41]
v_pk_add_f32 v[10:11], v[10:11], v[42:43]
v_pk_add_f32 v[12:13], v[12:13], v[44:45]
v_pk_add_f32 v[14:15], v[14:15], v[46:47]
v_pk_add_f32 v[16:17], v[16:17], v[48:49]
v_pk_add_f32 v[18:19], v[18:19], v[50:51]
v_pk_add_f32 v[20:21], v[20:21], v[52:53]
v_pk_add_f32 v[22:23], v[22:23], v[54:55]
v_pk_add_f32 v[24:25], v[24:25], v[56:57]
v_pk_add_f32 v[26:27], v[26:27], v[58:59]
v_pk_add_f32 v[28:29], v[28:29], v[60:61]
v_pk_add_f32 v[30:31], v[30:31], v[62:63]
v_mov_b32 v159, v158
s_nop 0
v_pk_mul_f32 v[0:1], v[0:1], v[158:159]
v_pk_mul_f32 v[2:3], v[2:3], v[158:159]
v_pk_mul_f32 v[4:5], v[4:5], v[158:159]
v_pk_mul_f32 v[6:7], v[6:7], v[158:159]
v_pk_mul_f32 v[8:9], v[8:9], v[158:159]
v_pk_mul_f32 v[10:11], v[10:11], v[158:159]
v_pk_mul_f32 v[12:13], v[12:13], v[158:159]
v_pk_mul_f32 v[14:15], v[14:15], v[158:159]
v_pk_mul_f32 v[16:17], v[16:17], v[158:159]
v_pk_mul_f32 v[18:19], v[18:19], v[158:159]
v_pk_mul_f32 v[20:21], v[20:21], v[158:159]
v_pk_mul_f32 v[22:23], v[22:23], v[158:159]
v_pk_mul_f32 v[24:25], v[24:25], v[158:159]
v_pk_mul_f32 v[26:27], v[26:27], v[158:159]
v_pk_mul_f32 v[28:29], v[28:29], v[158:159]
v_pk_mul_f32 v[30:31], v[30:31], v[158:159]
v_cvt_pk_bf16_f32 v64, v0, v1
v_cvt_pk_bf16_f32 v65, v2, v3
v_cvt_pk_bf16_f32 v66, v4, v5
v_cvt_pk_bf16_f32 v67, v6, v7
v_cvt_pk_bf16_f32 v68, v8, v9
v_cvt_pk_bf16_f32 v69, v10, v11
v_cvt_pk_bf16_f32 v70, v12, v13
v_cvt_pk_bf16_f32 v71, v14, v15
v_cvt_pk_bf16_f32 v72, v16, v17
v_cvt_pk_bf16_f32 v73, v18, v19
v_cvt_pk_bf16_f32 v74, v20, v21
v_cvt_pk_bf16_f32 v75, v22, v23
v_cvt_pk_bf16_f32 v76, v24, v25
v_cvt_pk_bf16_f32 v77, v26, v27
v_cvt_pk_bf16_f32 v78, v28, v29
v_cvt_pk_bf16_f32 v79, v30, v31
v_mbcnt_lo_u32_b32 v155, -1, 0
v_mbcnt_hi_u32_b32 v155, -1, v155
v_lshlrev_b32 v155, 4, v155
v_add_u32 v155, s52, v155
ds_write_b128 v155, v[64:67] offset:16384
ds_write_b128 v155, v[68:71] offset:17408
ds_write_b128 v155, v[72:75] offset:18432
ds_write_b128 v155, v[76:79] offset:19456
s_waitcnt lgkmcnt(0)
s_barrier
s_barrier
s_add_u32 s49, s49, 27
s_add_u32 s47, s47, 1
s_cmp_lt_u32 s47, 4
s_cbranch_scc1 A_unit
s_cmp_eq_u32 s69, 0
s_cbranch_scc0 CHK_done
s_mov_b64 exec, 1
s_lshl_b32 s39, s36, 3
v_mov_b32 v1, s39
s_mov_b32 s63, 0
CHK_poll:
global_load_dword v3, v1, s[74:75] sc1
s_waitcnt vmcnt(0)
v_readfirstlane_b32 s39, v3
s_nop 3
s_cmp_ge_u32 s39, 8
s_cbranch_scc1 CHK_ok
s_sleep 2
s_add_u32 s63, s63, 1
s_cmp_lt_u32 s63, 0x100000
s_cbranch_scc1 CHK_poll
CHK_ok:
s_mov_b64 exec, -1
CHK_done:
v_mbcnt_lo_u32_b32 v101, -1, 0
v_mbcnt_hi_u32_b32 v101, -1, v101
v_lshlrev_b32 v101, 0, v101
v_lshrrev_b32 v102, 3, v101
v_bfe_u32 v103, v101, 4, 1
v_lshlrev_b32 v103, 2, v103
v_and_b32 v104, 7, v101
v_xor_b32 v103, v103, v104
v_lshlrev_b32 v103, 4, v103
s_lshl_b32 s38, s3, 5
v_add_u32 v102, s38, v102
v_mul_u32_u24 v102, 1152, v102
v_add_u32 v100, v102, v103
s_mul_i32 s60, s37, 589824
s_add_u32 m0, s48, 32768
s_add_u32 s58, s60, 442624
buffer_load_dwordx4 v100, s[64:67], s58 offen offset:0 lds
s_add_u32 s58, s60, 450816
buffer_load_dwordx4 v100, s[64:67], s58 offen offset:1024 lds
s_add_u32 s58, s60, 459008
buffer_load_dwordx4 v100, s[64:67], s58 offen offset:2048 lds
s_add_u32 s58, s60, 467200
buffer_load_dwordx4 v100, s[64:67], s58 offen offset:3072 lds
s_barrier
s_add_u32 m0, s48, 49152
s_add_u32 s58, s60, 442752
buffer_load_dwordx4 v100, s[64:67], s58 offen offset:0 lds
s_add_u32 s58, s60, 450944
buffer_load_dwordx4 v100, s[64:67], s58 offen offset:1024 lds
s_add_u32 s58, s60, 459136
buffer_load_dwordx4 v100, s[64:67], s58 offen offset:2048 lds
s_add_u32 s58, s60, 467328
buffer_load_dwordx4 v100, s[64:67], s58 offen offset:3072 lds
s_barrier
s_add_u32 m0, s48, 65536
s_add_u32 s58, s60, 442880
buffer_load_dwordx4 v100, s[64:67], s58 offen offset:0 lds
s_add_u32 s58, s60, 451072
buffer_load_dwordx4 v100, s[64:67], s58 offen offset:1024 lds
s_add_u32 s58, s60, 459264
buffer_load_dwordx4 v100, s[64:67], s58 offen offset:2048 lds
s_add_u32 s58, s60, 467456
buffer_load_dwordx4 v100, s[64:67], s58 offen offset:3072 lds
s_waitcnt vmcnt(8)
s_barrier
s_add_u32 m0, s48, 81920
s_add_u32 s58, s60, 443008
buffer_load_dwordx4 v100, s[64:67], s58 offen offset:0 lds
s_add_u32 s58, s60, 451200
buffer_load_dwordx4 v100, s[64:67], s58 offen offset:1024 lds
s_add_u32 s58, s60, 459392
buffer_load_dwordx4 v100, s[64:67], s58 offen offset:2048 lds
s_add_u32 s58, s60, 467584
buffer_load_dwordx4 v100, s[64:67], s58 offen offset:3072 lds
s_waitcnt vmcnt(8)
s_barrier
s_add_u32 m0, s48, 98304
s_add_u32 s58, s60, 443136
buffer_load_dwordx4 v100, s[64:67], s58 offen offset:0 lds
s_add_u32 s58, s60, 451328
buffer_load_dwordx4 v100, s[64:67], s58 offen offset:1024 lds
s_add_u32 s58, s60, 459520
buffer_load_dwordx4 v100, s[64:67], s58 offen offset:2048 lds
s_add_u32 s58, s60, 467712
buffer_load_dwordx4 v100, s[64:67], s58 offen offset:3072 lds
s_waitcnt vmcnt(8)
s_barrier
s_add_u32 m0, s48, 114688
s_add_u32 s58, s60, 443264
buffer_load_dwordx4 v100, s[64:67], s58 offen offset:0 lds
s_add_u32 s58, s60, 451456
buffer_load_dwordx4 v100, s[64:67], s58 offen offset:1024 lds
s_add_u32 s58, s60, 459648
buffer_load_dwordx4 v100, s[64:67], s58 offen offset:2048 lds
s_add_u32 s58, s60, 467840
buffer_load_dwordx4 v100, s[64:67], s58 offen offset:3072 lds
s_waitcnt vmcnt(8)
s_barrier
s_add_u32 m0, s48, 0
s_add_u32 s58, s60, 443392
buffer_load_dwordx4 v100, s[64:67], s58 offen offset:0 lds
s_add_u32 s58, s60, 451584
buffer_load_dwordx4 v100, s[64:67], s58 offen offset:1024 lds
s_add_u32 s58, s60, 459776
buffer_load_dwordx4 v100, s[64:67], s58 offen offset:2048 lds
s_add_u32 s58, s60, 467968
buffer_load_dwordx4 v100, s[64:67], s58 offen offset:3072 lds
s_waitcnt vmcnt(8)
s_barrier
s_waitcnt vmcnt(4)
s_barrier
s_waitcnt vmcnt(0)
s_barrier
s_barrier
s_branch FIN0
P_start:
v_and_b32 v7, 31, v2
s_lshl_b32 s38, s36, 6
s_lshl_b32 s39, s42, 5
s_add_u32 s38, s38, s39
v_add_u32 v7, s38, v7
v_mul_u32_u24 v7, 1152, v7
v_lshlrev_b32 v8, 4, v3
v_add_u32 v7, v7, v8
s_lshl_b32 s39, s43, 6
v_add_u32 v9, s39, v7
s_lshl_b32 s50, s37, 10
s_mul_i32 s51, s36, 18
s_lshl_b32 s52, s3, 3
v_lshrrev_b32 v10, 3, v2
v_add_u32 v10, s52, v10
v_min_u32 v10, 17, v10
v_add_u32 v10, s51, v10
v_lshlrev_b32 v10, 13, v10
v_and_b32 v11, 7, v2
v_lshlrev_b32 v11, 7, v11
v_add_u32 v10, v10, v11
v_lshrrev_b32 v7, 3, v2
s_lshl_b32 s38, s3, 4
v_add_u32 v7, s38, v7
v_bfe_u32 v8, v7, 1, 3
v_and_b32 v10, 7, v2
v_xor_b32 v8, v8, v10
v_lshlrev_b32 v8, 4, v8
v_mul_u32_u24 v7, 1152, v7
v_add_u32 v158, v7, v8
v_add_u32 v159, 9216, v7
v_xor_b32 v8, 64, v8
v_add_u32 v159, v159, v8
s_mul_i32 s59, s36, 73728
s_lshl_b32 s41, s3, 11
v_and_b32 v10, 31, v2
s_lshl_b32 s38, s42, 5
v_add_u32 v10, s38, v10
v_bfe_u32 v11, v10, 1, 3
v_xor_b32 v12, v3, v11
v_lshlrev_b32 v10, 7, v10
v_lshlrev_b32 v12, 4, v12
v_add_u32 v150, v10, v12
v_add_u32 v156, 114688, v150
s_mul_i32 s54, s37, 589824
s_mul_i32 s51, s36, 144
s_mul_i32 s52, s3, 36
s_add_u32 s51, s51, s52
v_min_u32 v10, 35, v2
v_add_u32 v10, s51, v10
v_lshlrev_b32 v10, 7, v10
s_and_b32 s51, s36, 15
s_mul_i32 s51, s51, 72
s_mul_i32 s52, s3, 18
s_add_u32 s51, s51, s52
v_min_u32 v10, 17, v2
v_add_u32 v10, s51, v10
v_lshlrev_b32 v157, 7, v10
v_lshrrev_b32 v10, 4, v2
v_and_b32 v11, 15, v2
s_lshl_b32 s38, s3, 4
v_add_u32 v12, s38, v10
v_lshlrev_b32 v14, 8, v12
v_xor_b32 v13, v10, v11
v_lshlrev_b32 v13, 4, v13
v_add_u32 v132, v14, v13
v_xor_b32 v133, 64, v132
v_xor_b32 v134, 128, v132
v_xor_b32 v135, 192, v132
v_lshlrev_b32 v13, 2, v10
v_xor_b32 v13, v13, v11
v_lshlrev_b32 v13, 4, v13
v_add_u32 v136, v14, v13
v_lshlrev_b32 v14, 13, v12
v_add_u32 v137, v14, v13
v_add_u32 v138, 31744, v137
v_add_u32 v139, 63488, v137
v_add_u32 v140, 95232, v137
v_lshrrev_b32 v10, 3, v2
v_bfe_u32 v13, v2, 4, 1
v_lshlrev_b32 v13, 2, v13
v_and_b32 v11, 7, v2
v_xor_b32 v13, v13, v11
v_lshlrev_b32 v13, 4, v13
s_lshl_b32 s38, s3, 5
v_add_u32 v10, s38, v10
v_mul_u32_u24 v10, 1152, v10
v_add_u32 v141, v10, v13
v_add_u32 v142, 8192, v141
v_add_u32 v143, 16384, v141
v_add_u32 v144, 24576, v141
v_lshlrev_b32 v7, 3, v3
v_add_u32 v7, v7, v5
v_lshlrev_b32 v7, 8, v7
v_lshlrev_b32 v8, 1, v4
v_and_b32 v10, 1, v6
v_add_u32 v8, v8, v10
v_lshlrev_b32 v10, 2, v5
v_xor_b32 v8, v8, v10
v_lshlrev_b32 v8, 4, v8
v_lshrrev_b32 v10, 1, v6
v_lshlrev_b32 v10, 3, v10
v_add_u32 v7, v7, v8
v_add_u32 v7, v7, v10
s_lshl_b32 s38, s43, 7
v_xor_b32 v145, s38, v7
v_lshlrev_b32 v7, 2, v3
v_add_u32 v7, v7, v5
v_lshlrev_b32 v7, 7, v7
v_lshlrev_b32 v8, 1, v4
v_lshrrev_b32 v10, 1, v6
v_add_u32 v8, v8, v10
s_lshl_b32 s38, s43, 2
v_add_u32 v8, s38, v8
v_lshrrev_b32 v10, 1, v5
v_lshlrev_b32 v10, 2, v10
v_xor_b32 v8, v8, v10
v_lshlrev_b32 v8, 4, v8
v_and_b32 v10, 1, v6
v_lshlrev_b32 v10, 3, v10
v_add_u32 v7, v7, v8
v_add_u32 v146, v7, v10
v_lshlrev_b32 v147, 4, v2
s_lshl_b32 s51, s42, 13
s_lshl_b32 s52, s43, 12
s_add_u32 s52, s52, s51
s_lshl_b32 s48, s3, 12
s_add_u32 s48, s48, 32768
s_lshl_b32 s49, s36, 5
s_lshl_b32 s39, s37, 2
s_add_u32 s49, s49, s39
s_lshl_b32 s49, s49, 17
s_mul_i32 s61, s3, 18432
s_add_u32 s61, s61, s62
s_waitcnt vmcnt(20)
s_barrier
v_add_u32 v128, 32768, v145
v_xor_b32 v129, 64, v128
ds_read_b128 a[0:3], v150 offset:0
v_xor_b32 v151, 32, v150
ds_read_b128 a[4:7], v151 offset:0
v_xor_b32 v151, 64, v150
ds_read_b128 a[8:11], v151 offset:0
v_xor_b32 v151, 96, v150
ds_read_b128 a[12:15], v151 offset:0
ds_read_b64_tr_b16 v[112:113], v128 offset:0
ds_read_b64_tr_b16 v[114:115], v128 offset:1024
ds_read_b64_tr_b16 v[116:117], v129 offset:0
ds_read_b64_tr_b16 v[118:119], v129 offset:1024
ds_read_b64_tr_b16 v[120:121], v128 offset:4096
ds_read_b64_tr_b16 v[122:123], v128 offset:5120
ds_read_b64_tr_b16 v[124:125], v129 offset:4096
ds_read_b64_tr_b16 v[126:127], v129 offset:5120
s_barrier
s_add_u32 m0, s48, 65536
s_add_u32 s53, s50, 1048576
buffer_load_dwordx4 v137, s[28:31], s53 offen offset:0 lds
buffer_load_dwordx4 v138, s[28:31], s53 offen offset:1024 lds
buffer_load_dwordx4 v139, s[28:31], s53 offen offset:2048 lds
buffer_load_dwordx4 v140, s[28:31], s53 offen offset:3072 lds
ds_read_b64_tr_b16 v[152:153], v128 offset:8192
ds_read_b64_tr_b16 v[154:155], v128 offset:9216
s_waitcnt lgkmcnt(8)
v_mfma_f32_32x32x16_bf16 v[48:63], v[112:115], a[0:3], 0
ds_read_b64_tr_b16 v[112:113], v129 offset:8192
ds_read_b64_tr_b16 v[114:115], v129 offset:9216
s_waitcnt lgkmcnt(8)
v_mfma_f32_32x32x16_bf16 v[64:79], v[116:119], a[0:3], 0
ds_read_b64_tr_b16 v[116:117], v128 offset:12288
ds_read_b64_tr_b16 v[118:119], v128 offset:13312
s_waitcnt lgkmcnt(8)
v_mfma_f32_32x32x16_bf16 v[48:63], v[120:123], a[4:7], v[48:63]
ds_read_b64_tr_b16 v[120:121], v129 offset:12288
ds_read_b64_tr_b16 v[122:123], v129 offset:13312
s_waitcnt lgkmcnt(8)
v_mfma_f32_32x32x16_bf16 v[64:79], v[124:127], a[4:7], v[64:79]
s_waitcnt lgkmcnt(0)
s_waitcnt vmcnt(4)
s_barrier
v_add_u32 v128, 65536, v145
v_xor_b32 v129, 64, v128
ds_read_b128 a[16:19], v150 offset:8192
v_xor_b32 v151, 32, v150
ds_read_b128 a[20:23], v151 offset:8192
v_xor_b32 v151, 64, v150
ds_read_b128 a[24:27], v151 offset:8192
v_xor_b32 v151, 96, v150
ds_read_b128 a[28:31], v151 offset:8192
ds_read_b64_tr_b16 v[124:125], v128 offset:0
ds_read_b64_tr_b16 v[126:127], v128 offset:1024
v_mfma_f32_32x32x16_bf16 v[48:63], v[152:155], a[8:11], v[48:63]
ds_read_b64_tr_b16 v[152:153], v129 offset:0
ds_read_b64_tr_b16 v[154:155], v129 offset:1024
v_mfma_f32_32x32x16_bf16 v[64:79], v[112:115], a[8:11], v[64:79]
ds_read_b64_tr_b16 v[112:113], v128 offset:4096
ds_read_b64_tr_b16 v[114:115], v128 offset:5120
v_mfma_f32_32x32x16_bf16 v[48:63], v[116:119], a[12:15], v[48:63]
ds_read_b64_tr_b16 v[116:117], v129 offset:4096
ds_read_b64_tr_b16 v[118:119], v129 offset:5120
v_mfma_f32_32x32x16_bf16 v[64:79], v[120:123], a[12:15], v[64:79]
s_barrier
s_add_u32 m0, s48, 16384
s_add_u32 s53, s50, 1572864
buffer_load_dwordx4 v137, s[28:31], s53 offen offset:0 lds
buffer_load_dwordx4 v138, s[28:31], s53 offen offset:1024 lds
buffer_load_dwordx4 v139, s[28:31], s53 offen offset:2048 lds
buffer_load_dwordx4 v140, s[28:31], s53 offen offset:3072 lds
ds_read_b64_tr_b16 v[120:121], v128 offset:8192
ds_read_b64_tr_b16 v[122:123], v128 offset:9216
s_waitcnt lgkmcnt(8)
v_mfma_f32_32x32x16_bf16 v[48:63], v[124:127], a[16:19], v[48:63]
ds_read_b64_tr_b16 v[124:125], v129 offset:8192
ds_read_b64_tr_b16 v[126:127], v129 offset:9216
s_waitcnt lgkmcnt(8)
v_mfma_f32_32x32x16_bf16 v[64:79], v[152:155], a[16:19], v[64:79]
ds_read_b64_tr_b16 v[152:153], v128 offset:12288
ds_read_b64_tr_b16 v[154:155], v128 offset:13312
s_waitcnt lgkmcnt(8)
v_mfma_f32_32x32x16_bf16 v[48:63], v[112:115], a[20:23], v[48:63]
ds_read_b64_tr_b16 v[112:113], v129 offset:12288
ds_read_b64_tr_b16 v[114:115], v129 offset:13312
s_waitcnt lgkmcnt(8)
v_mfma_f32_32x32x16_bf16 v[64:79], v[116:119], a[20:23], v[64:79]
s_waitcnt lgkmcnt(0)
s_waitcnt vmcnt(4)
s_barrier
v_add_u32 v128, 98304, v145
v_xor_b32 v129, 64, v128
ds_read_b128 a[32:35], v150 offset:16384
v_xor_b32 v151, 32, v150
ds_read_b128 a[36:39], v151 offset:16384
v_xor_b32 v151, 64, v150
ds_read_b128 a[40:43], v151 offset:16384
v_xor_b32 v151, 96, v150
ds_read_b128 a[44:47], v151 offset:16384
ds_read_b64_tr_b16 v[116:117], v128 offset:0
ds_read_b64_tr_b16 v[118:119], v128 offset:1024
v_mfma_f32_32x32x16_bf16 v[48:63], v[120:123], a[24:27], v[48:63]
ds_read_b64_tr_b16 v[120:121], v129 offset:0
ds_read_b64_tr_b16 v[122:123], v129 offset:1024
v_mfma_f32_32x32x16_bf16 v[64:79], v[124:127], a[24:27], v[64:79]
ds_read_b64_tr_b16 v[124:125], v128 offset:4096
ds_read_b64_tr_b16 v[126:127], v128 offset:5120
v_mfma_f32_32x32x16_bf16 v[48:63], v[152:155], a[28:31], v[48:63]
ds_read_b64_tr_b16 v[152:153], v129 offset:4096
ds_read_b64_tr_b16 v[154:155], v129 offset:5120
v_mfma_f32_32x32x16_bf16 v[64:79], v[112:115], a[28:31], v[64:79]
s_barrier
s_add_u32 m0, s48, 49152
s_add_u32 s53, s50, 2097152
buffer_load_dwordx4 v137, s[28:31], s53 offen offset:0 lds
buffer_load_dwordx4 v138, s[28:31], s53 offen offset:1024 lds
buffer_load_dwordx4 v139, s[28:31], s53 offen offset:2048 lds
buffer_load_dwordx4 v140, s[28:31], s53 offen offset:3072 lds
ds_read_b64_tr_b16 v[112:113], v128 offset:8192
ds_read_b64_tr_b16 v[114:115], v128 offset:9216
s_waitcnt lgkmcnt(8)
v_mfma_f32_32x32x16_bf16 v[48:63], v[116:119], a[32:35], v[48:63]
ds_read_b64_tr_b16 v[116:117], v129 offset:8192
ds_read_b64_tr_b16 v[118:119], v129 offset:9216
s_waitcnt lgkmcnt(8)
v_mfma_f32_32x32x16_bf16 v[64:79], v[120:123], a[32:35], v[64:79]
ds_read_b64_tr_b16 v[120:121], v128 offset:12288
ds_read_b64_tr_b16 v[122:123], v128 offset:13312
s_waitcnt lgkmcnt(8)
v_mfma_f32_32x32x16_bf16 v[48:63], v[124:127], a[36:39], v[48:63]
ds_read_b64_tr_b16 v[124:125], v129 offset:12288
ds_read_b64_tr_b16 v[126:127], v129 offset:13312
s_waitcnt lgkmcnt(8)
v_mfma_f32_32x32x16_bf16 v[64:79], v[152:155], a[36:39], v[64:79]
s_waitcnt lgkmcnt(0)
s_waitcnt vmcnt(4)
s_barrier
buffer_load_dword v131, v131, s[28:31], s50 offen
v_add_u32 v128, 49152, v145
v_xor_b32 v129, 64, v128
ds_read_b128 a[48:51], v150 offset:24576
v_xor_b32 v151, 32, v150
ds_read_b128 a[52:55], v151 offset:24576
v_xor_b32 v151, 64, v150
ds_read_b128 a[56:59], v151 offset:24576
v_xor_b32 v151, 96, v150
ds_read_b128 a[60:63], v151 offset:24576
ds_read_b64_tr_b16 v[152:153], v128 offset:0
ds_read_b64_tr_b16 v[154:155], v128 offset:1024
v_mfma_f32_32x32x16_bf16 v[48:63], v[112:115], a[40:43], v[48:63]
ds_read_b64_tr_b16 v[112:113], v129 offset:0
ds_read_b64_tr_b16 v[114:115], v129 offset:1024
v_mfma_f32_32x32x16_bf16 v[64:79], v[116:119], a[40:43], v[64:79]
ds_read_b64_tr_b16 v[116:117], v128 offset:4096
ds_read_b64_tr_b16 v[118:119], v128 offset:5120
v_mfma_f32_32x32x16_bf16 v[48:63], v[120:123], a[44:47], v[48:63]
ds_read_b64_tr_b16 v[120:121], v129 offset:4096
ds_read_b64_tr_b16 v[122:123], v129 offset:5120
v_mfma_f32_32x32x16_bf16 v[64:79], v[124:127], a[44:47], v[64:79]
s_barrier
s_add_u32 m0, s48, 0
s_add_u32 s53, s50, 2621440
buffer_load_dwordx4 v137, s[28:31], s53 offen offset:0 lds
buffer_load_dwordx4 v138, s[28:31], s53 offen offset:1024 lds
buffer_load_dwordx4 v139, s[28:31], s53 offen offset:2048 lds
buffer_load_dwordx4 v140, s[28:31], s53 offen offset:3072 lds
ds_read_b64_tr_b16 v[124:125], v128 offset:8192
ds_read_b64_tr_b16 v[126:127], v128 offset:9216
s_waitcnt lgkmcnt(8)
v_mfma_f32_32x32x16_bf16 v[48:63], v[152:155], a[48:51], v[48:63]
ds_read_b64_tr_b16 v[152:153], v129 offset:8192
ds_read_b64_tr_b16 v[154:155], v129 offset:9216
s_waitcnt lgkmcnt(8)
v_mfma_f32_32x32x16_bf16 v[64:79], v[112:115], a[48:51], v[64:79]
ds_read_b64_tr_b16 v[112:113], v128 offset:12288
ds_read_b64_tr_b16 v[114:115], v128 offset:13312
s_waitcnt lgkmcnt(8)
v_mfma_f32_32x32x16_bf16 v[48:63], v[116:119], a[52:55], v[48:63]
ds_read_b64_tr_b16 v[116:117], v129 offset:12288
ds_read_b64_tr_b16 v[118:119], v129 offset:13312
s_waitcnt lgkmcnt(8)
v_mfma_f32_32x32x16_bf16 v[64:79], v[120:123], a[52:55], v[64:79]
s_waitcnt lgkmcnt(0)
s_waitcnt vmcnt(5)
s_barrier
v_add_u32 v128, 81920, v145
v_xor_b32 v129, 64, v128
ds_read_b128 a[64:67], v156 offset:0
v_xor_b32 v151, 32, v156
ds_read_b128 a[68:71], v151 offset:0
v_xor_b32 v151, 64, v156
ds_read_b128 a[72:75], v151 offset:0
v_xor_b32 v151, 96, v156
ds_read_b128 a[76:79], v151 offset:0
ds_read_b64_tr_b16 v[120:121], v128 offset:0
ds_read_b64_tr_b16 v[122:123], v128 offset:1024
v_mfma_f32_32x32x16_bf16 v[48:63], v[124:127], a[56:59], v[48:63]
ds_read_b64_tr_b16 v[124:125], v129 offset:0
ds_read_b64_tr_b16 v[126:127], v129 offset:1024
v_mfma_f32_32x32x16_bf16 v[64:79], v[152:155], a[56:59], v[64:79]
ds_read_b64_tr_b16 v[152:153], v128 offset:4096
ds_read_b64_tr_b16 v[154:155], v128 offset:5120
v_mfma_f32_32x32x16_bf16 v[48:63], v[112:115], a[60:63], v[48:63]
ds_read_b64_tr_b16 v[112:113], v129 offset:4096
ds_read_b64_tr_b16 v[114:115], v129 offset:5120
v_mfma_f32_32x32x16_bf16 v[64:79], v[116:119], a[60:63], v[64:79]
s_barrier
s_add_u32 m0, s48, 32768
s_add_u32 s53, s50, 3145728
buffer_load_dwordx4 v137, s[28:31], s53 offen offset:0 lds
buffer_load_dwordx4 v138, s[28:31], s53 offen offset:1024 lds
buffer_load_dwordx4 v139, s[28:31], s53 offen offset:2048 lds
buffer_load_dwordx4 v140, s[28:31], s53 offen offset:3072 lds
ds_read_b64_tr_b16 v[116:117], v128 offset:8192
ds_read_b64_tr_b16 v[118:119], v128 offset:9216
s_waitcnt lgkmcnt(8)
v_mfma_f32_32x32x16_bf16 v[48:63], v[120:123], a[64:67], v[48:63]
ds_read_b64_tr_b16 v[120:121], v129 offset:8192
ds_read_b64_tr_b16 v[122:123], v129 offset:9216
s_waitcnt lgkmcnt(8)
v_mfma_f32_32x32x16_bf16 v[64:79], v[124:127], a[64:67], v[64:79]
ds_read_b64_tr_b16 v[124:125], v128 offset:12288
ds_read_b64_tr_b16 v[126:127], v128 offset:13312
s_waitcnt lgkmcnt(8)
v_mfma_f32_32x32x16_bf16 v[48:63], v[152:155], a[68:71], v[48:63]
ds_read_b64_tr_b16 v[152:153], v129 offset:12288
ds_read_b64_tr_b16 v[154:155], v129 offset:13312
s_waitcnt lgkmcnt(8)
v_mfma_f32_32x32x16_bf16 v[64:79], v[112:115], a[68:71], v[64:79]
s_waitcnt lgkmcnt(0)
s_waitcnt vmcnt(4)
s_barrier
v_add_u32 v128, 32768, v145
v_xor_b32 v129, 64, v128
ds_read_b128 a[80:83], v156 offset:8192
v_xor_b32 v151, 32, v156
ds_read_b128 a[84:87], v151 offset:8192
v_xor_b32 v151, 64, v156
ds_read_b128 a[88:91], v151 offset:8192
v_xor_b32 v151, 96, v156
ds_read_b128 a[92:95], v151 offset:8192
ds_read_b64_tr_b16 v[112:113], v128 offset:0
ds_read_b64_tr_b16 v[114:115], v128 offset:1024
v_mfma_f32_32x32x16_bf16 v[48:63], v[116:119], a[72:75], v[48:63]
ds_read_b64_tr_b16 v[116:117], v129 offset:0
ds_read_b64_tr_b16 v[118:119], v129 offset:1024
v_mfma_f32_32x32x16_bf16 v[64:79], v[120:123], a[72:75], v[64:79]
ds_read_b64_tr_b16 v[120:121], v128 offset:4096
ds_read_b64_tr_b16 v[122:123], v128 offset:5120
v_mfma_f32_32x32x16_bf16 v[48:63], v[124:127], a[76:79], v[48:63]
ds_read_b64_tr_b16 v[124:125], v129 offset:4096
ds_read_b64_tr_b16 v[126:127], v129 offset:5120
v_mfma_f32_32x32x16_bf16 v[64:79], v[152:155], a[76:79], v[64:79]
s_barrier
s_add_u32 m0, s48, 65536
s_add_u32 s53, s50, 3670016
buffer_load_dwordx4 v137, s[28:31], s53 offen offset:0 lds
buffer_load_dwordx4 v138, s[28:31], s53 offen offset:1024 lds
buffer_load_dwordx4 v139, s[28:31], s53 offen offset:2048 lds
buffer_load_dwordx4 v140, s[28:31], s53 offen offset:3072 lds
ds_read_b64_tr_b16 v[152:153], v128 offset:8192
ds_read_b64_tr_b16 v[154:155], v128 offset:9216
s_waitcnt lgkmcnt(8)
v_mfma_f32_32x32x16_bf16 v[48:63], v[112:115], a[80:83], v[48:63]
ds_read_b64_tr_b16 v[112:113], v129 offset:8192
ds_read_b64_tr_b16 v[114:115], v129 offset:9216
s_waitcnt lgkmcnt(8)
v_mfma_f32_32x32x16_bf16 v[64:79], v[116:119], a[80:83], v[64:79]
ds_read_b64_tr_b16 v[116:117], v128 offset:12288
ds_read_b64_tr_b16 v[118:119], v128 offset:13312
s_waitcnt lgkmcnt(8)
v_mfma_f32_32x32x16_bf16 v[48:63], v[120:123], a[84:87], v[48:63]
ds_read_b64_tr_b16 v[120:121], v129 offset:12288
ds_read_b64_tr_b16 v[122:123], v129 offset:13312
s_waitcnt lgkmcnt(8)
v_mfma_f32_32x32x16_bf16 v[64:79], v[124:127], a[84:87], v[64:79]
s_waitcnt lgkmcnt(0)
s_waitcnt vmcnt(4)
s_barrier
v_add_u32 v128, 65536, v145
v_xor_b32 v129, 64, v128
ds_read_b128 v[0:3], v156 offset:16384
v_xor_b32 v151, 32, v156
ds_read_b128 v[4:7], v151 offset:16384
v_xor_b32 v151, 64, v156
ds_read_b128 v[8:11], v151 offset:16384
v_xor_b32 v151, 96, v156
ds_read_b128 v[12:15], v151 offset:16384
ds_read_b64_tr_b16 v[124:125], v128 offset:0
ds_read_b64_tr_b16 v[126:127], v128 offset:1024
v_mfma_f32_32x32x16_bf16 v[48:63], v[152:155], a[88:91], v[48:63]
ds_read_b64_tr_b16 v[152:153], v129 offset:0
ds_read_b64_tr_b16 v[154:155], v129 offset:1024
v_mfma_f32_32x32x16_bf16 v[64:79], v[112:115], a[88:91], v[64:79]
ds_read_b64_tr_b16 v[112:113], v128 offset:4096
ds_read_b64_tr_b16 v[114:115], v128 offset:5120
v_mfma_f32_32x32x16_bf16 v[48:63], v[116:119], a[92:95], v[48:63]
ds_read_b64_tr_b16 v[116:117], v129 offset:4096
ds_read_b64_tr_b16 v[118:119], v129 offset:5120
v_mfma_f32_32x32x16_bf16 v[64:79], v[120:123], a[92:95], v[64:79]
s_barrier
s_add_u32 m0, s48, 16384
s_add_u32 s53, s50, 4194304
buffer_load_dwordx4 v137, s[28:31], s53 offen offset:0 lds
buffer_load_dwordx4 v138, s[28:31], s53 offen offset:1024 lds
buffer_load_dwordx4 v139, s[28:31], s53 offen offset:2048 lds
buffer_load_dwordx4 v140, s[28:31], s53 offen offset:3072 lds
ds_read_b64_tr_b16 v[120:121], v128 offset:8192
ds_read_b64_tr_b16 v[122:123], v128 offset:9216
s_waitcnt lgkmcnt(8)
v_mfma_f32_32x32x16_bf16 v[48:63], v[124:127], v[0:3], v[48:63]
ds_read_b64_tr_b16 v[124:125], v129 offset:8192
ds_read_b64_tr_b16 v[126:127], v129 offset:9216
s_waitcnt lgkmcnt(8)
v_mfma_f32_32x32x16_bf16 v[64:79], v[152:155], v[0:3], v[64:79]
ds_read_b64_tr_b16 v[152:153], v128 offset:12288
ds_read_b64_tr_b16 v[154:155], v128 offset:13312
s_waitcnt lgkmcnt(8)
v_mfma_f32_32x32x16_bf16 v[48:63], v[112:115], v[4:7], v[48:63]
ds_read_b64_tr_b16 v[112:113], v129 offset:12288
ds_read_b64_tr_b16 v[114:115], v129 offset:13312
s_waitcnt lgkmcnt(8)
v_mfma_f32_32x32x16_bf16 v[64:79], v[116:119], v[4:7], v[64:79]
s_waitcnt lgkmcnt(0)
s_waitcnt vmcnt(4)
s_barrier
v_add_u32 v128, 98304, v145
v_xor_b32 v129, 64, v128
ds_read_b128 v[16:19], v156 offset:24576
v_xor_b32 v151, 32, v156
ds_read_b128 v[20:23], v151 offset:24576
v_xor_b32 v151, 64, v156
ds_read_b128 v[24:27], v151 offset:24576
v_xor_b32 v151, 96, v156
ds_read_b128 v[28:31], v151 offset:24576
ds_read_b64_tr_b16 v[116:117], v128 offset:0
ds_read_b64_tr_b16 v[118:119], v128 offset:1024
v_mfma_f32_32x32x16_bf16 v[48:63], v[120:123], v[8:11], v[48:63]
ds_read_b64_tr_b16 v[120:121], v129 offset:0
ds_read_b64_tr_b16 v[122:123], v129 offset:1024
v_mfma_f32_32x32x16_bf16 v[64:79], v[124:127], v[8:11], v[64:79]
ds_read_b64_tr_b16 v[124:125], v128 offset:4096
ds_read_b64_tr_b16 v[126:127], v128 offset:5120
v_mfma_f32_32x32x16_bf16 v[48:63], v[152:155], v[12:15], v[48:63]
ds_read_b64_tr_b16 v[152:153], v129 offset:4096
ds_read_b64_tr_b16 v[154:155], v129 offset:5120
v_mfma_f32_32x32x16_bf16 v[64:79], v[112:115], v[12:15], v[64:79]
s_barrier
ds_read_b64_tr_b16 v[112:113], v128 offset:8192
ds_read_b64_tr_b16 v[114:115], v128 offset:9216
s_waitcnt lgkmcnt(8)
v_mfma_f32_32x32x16_bf16 v[48:63], v[116:119], v[16:19], v[48:63]
ds_read_b64_tr_b16 v[116:117], v129 offset:8192
ds_read_b64_tr_b16 v[118:119], v129 offset:9216
s_waitcnt lgkmcnt(8)
v_mfma_f32_32x32x16_bf16 v[64:79], v[120:123], v[16:19], v[64:79]
ds_read_b64_tr_b16 v[120:121], v128 offset:12288
ds_read_b64_tr_b16 v[122:123], v128 offset:13312
s_waitcnt lgkmcnt(8)
v_mfma_f32_32x32x16_bf16 v[48:63], v[124:127], v[20:23], v[48:63]
ds_read_b64_tr_b16 v[124:125], v129 offset:12288
ds_read_b64_tr_b16 v[126:127], v129 offset:13312
s_waitcnt lgkmcnt(8)
v_mfma_f32_32x32x16_bf16 v[64:79], v[152:155], v[20:23], v[64:79]
s_waitcnt lgkmcnt(0)
s_waitcnt vmcnt(0)
s_barrier
s_add_u32 m0, s48, 49152
s_add_u32 s53, s49, 0
buffer_load_dwordx4 v132, s[20:23], s53 offen offset:0 nt lds
buffer_load_dwordx4 v133, s[20:23], s53 offen offset:1024 nt lds
buffer_load_dwordx4 v134, s[20:23], s53 offen offset:2048 nt lds
buffer_load_dwordx4 v135, s[20:23], s53 offen offset:3072 nt lds
v_add_u32 v128, 49152, v145
v_xor_b32 v129, 64, v128
ds_read_b128 v[32:35], v156 offset:32768
v_xor_b32 v151, 32, v156
ds_read_b128 v[36:39], v151 offset:32768
v_xor_b32 v151, 64, v156
ds_read_b128 v[40:43], v151 offset:32768
v_xor_b32 v151, 96, v156
ds_read_b128 v[44:47], v151 offset:32768
ds_read_b64_tr_b16 v[152:153], v128 offset:0
ds_read_b64_tr_b16 v[154:155], v128 offset:1024
v_mfma_f32_32x32x16_bf16 v[48:63], v[112:115], v[24:27], v[48:63]
ds_read_b64_tr_b16 v[112:113], v129 offset:0
ds_read_b64_tr_b16 v[114:115], v129 offset:1024
v_mfma_f32_32x32x16_bf16 v[64:79], v[116:119], v[24:27], v[64:79]
ds_read_b64_tr_b16 v[116:117], v128 offset:4096
ds_read_b64_tr_b16 v[118:119], v128 offset:5120
v_mfma_f32_32x32x16_bf16 v[48:63], v[120:123], v[28:31], v[48:63]
ds_read_b64_tr_b16 v[120:121], v129 offset:4096
ds_read_b64_tr_b16 v[122:123], v129 offset:5120
v_mfma_f32_32x32x16_bf16 v[64:79], v[124:127], v[28:31], v[64:79]
s_barrier
s_add_u32 m0, s48, 65536
s_add_u32 s53, s49, 16384
buffer_load_dwordx4 v132, s[20:23], s53 offen offset:0 nt lds
buffer_load_dwordx4 v133, s[20:23], s53 offen offset:1024 nt lds
buffer_load_dwordx4 v134, s[20:23], s53 offen offset:2048 nt lds
buffer_load_dwordx4 v135, s[20:23], s53 offen offset:3072 nt lds
ds_read_b64_tr_b16 v[124:125], v128 offset:8192
ds_read_b64_tr_b16 v[126:127], v128 offset:9216
s_waitcnt lgkmcnt(8)
v_mfma_f32_32x32x16_bf16 v[48:63], v[152:155], v[32:35], v[48:63]
ds_read_b64_tr_b16 v[152:153], v129 offset:8192
ds_read_b64_tr_b16 v[154:155], v129 offset:9216
s_waitcnt lgkmcnt(8)
v_mfma_f32_32x32x16_bf16 v[64:79], v[112:115], v[32:35], v[64:79]
ds_read_b64_tr_b16 v[112:113], v128 offset:12288
ds_read_b64_tr_b16 v[114:115], v128 offset:13312
s_waitcnt lgkmcnt(8)
v_mfma_f32_32x32x16_bf16 v[48:63], v[116:119], v[36:39], v[48:63]
ds_read_b64_tr_b16 v[116:117], v129 offset:12288
ds_read_b64_tr_b16 v[118:119], v129 offset:13312
s_waitcnt lgkmcnt(8)
v_mfma_f32_32x32x16_bf16 v[64:79], v[120:123], v[36:39], v[64:79]
s_waitcnt lgkmcnt(6)
v_mfma_f32_32x32x16_bf16 v[48:63], v[124:127], v[40:43], v[48:63]
s_waitcnt lgkmcnt(4)
v_mfma_f32_32x32x16_bf16 v[64:79], v[152:155], v[40:43], v[64:79]
s_waitcnt lgkmcnt(2)
v_mfma_f32_32x32x16_bf16 v[48:63], v[112:115], v[44:47], v[48:63]
s_waitcnt lgkmcnt(0)
v_mfma_f32_32x32x16_bf16 v[64:79], v[116:119], v[44:47], v[64:79]
s_barrier
s_add_u32 m0, s48, 81920
s_add_u32 s53, s50, 512
buffer_load_dwordx4 v137, s[28:31], s53 offen offset:0 lds
buffer_load_dwordx4 v138, s[28:31], s53 offen offset:1024 lds
buffer_load_dwordx4 v139, s[28:31], s53 offen offset:2048 lds
buffer_load_dwordx4 v140, s[28:31], s53 offen offset:3072 lds
s_nop 11
v_cvt_pk_bf16_f32 v112, v48, v49
v_cvt_pk_bf16_f32 v113, v50, v51
v_cvt_pk_bf16_f32 v114, v52, v53
v_cvt_pk_bf16_f32 v115, v54, v55
v_cvt_pk_bf16_f32 v116, v56, v57
v_cvt_pk_bf16_f32 v117, v58, v59
v_cvt_pk_bf16_f32 v118, v60, v61
v_cvt_pk_bf16_f32 v119, v62, v63
v_cvt_pk_bf16_f32 v120, v64, v65
v_cvt_pk_bf16_f32 v121, v66, v67
v_cvt_pk_bf16_f32 v122, v68, v69
v_cvt_pk_bf16_f32 v123, v70, v71
v_cvt_pk_bf16_f32 v124, v72, v73
v_cvt_pk_bf16_f32 v125, v74, v75
v_cvt_pk_bf16_f32 v126, v76, v77
v_cvt_pk_bf16_f32 v127, v78, v79
v_add_u32 v148, s52, v147
ds_write_b128 v148, v[112:115] offset:0
ds_write_b128 v148, v[116:119] offset:1024
ds_write_b128 v148, v[120:123] offset:2048
ds_write_b128 v148, v[124:127] offset:3072
s_waitcnt lgkmcnt(0)
s_waitcnt vmcnt(8)
s_barrier
s_add_u32 m0, s48, 98304
s_add_u32 s53, s50, 524800
buffer_load_dwordx4 v137, s[28:31], s53 offen offset:0 lds
buffer_load_dwordx4 v138, s[28:31], s53 offen offset:1024 lds
buffer_load_dwordx4 v139, s[28:31], s53 offen offset:2048 lds
buffer_load_dwordx4 v140, s[28:31], s53 offen offset:3072 lds
v_add_u32 v148, s52, v147
ds_read_b128 v[80:83], v148 offset:16384
ds_read_b128 v[84:87], v148 offset:17408
ds_read_b128 v[88:91], v148 offset:18432
ds_read_b128 v[92:95], v148 offset:19456
s_waitcnt lgkmcnt(0)
s_waitcnt vmcnt(8)
s_barrier
s_add_u32 m0, s48, 114688
s_add_u32 s53, s49, 32768
buffer_load_dwordx4 v132, s[20:23], s53 offen offset:0 nt lds
buffer_load_dwordx4 v133, s[20:23], s53 offen offset:1024 nt lds
buffer_load_dwordx4 v134, s[20:23], s53 offen offset:2048 nt lds
buffer_load_dwordx4 v135, s[20:23], s53 offen offset:3072 nt lds
s_waitcnt vmcnt(8)
s_barrier
s_add_u32 m0, s48, 0
s_add_u32 s53, s49, 49152
buffer_load_dwordx4 v132, s[20:23], s53 offen offset:0 nt lds
buffer_load_dwordx4 v133, s[20:23], s53 offen offset:1024 nt lds
buffer_load_dwordx4 v134, s[20:23], s53 offen offset:2048 nt lds
buffer_load_dwordx4 v135, s[20:23], s53 offen offset:3072 nt lds
s_waitcnt vmcnt(8)
s_barrier
s_add_u32 m0, s48, 16384
s_add_u32 s53, s50, 1049088
buffer_load_dwordx4 v137, s[28:31], s53 offen offset:0 lds
buffer_load_dwordx4 v138, s[28:31], s53 offen offset:1024 lds
buffer_load_dwordx4 v139, s[28:31], s53 offen offset:2048 lds
buffer_load_dwordx4 v140, s[28:31], s53 offen offset:3072 lds
v_add_u32 v128, 114688, v145
v_xor_b32 v129, 64, v128
ds_read_b64_tr_b16 v[120:121], v128 offset:0
ds_read_b64_tr_b16 v[122:123], v128 offset:1024
ds_read_b64_tr_b16 v[124:125], v129 offset:0
ds_read_b64_tr_b16 v[126:127], v129 offset:1024
ds_read_b64_tr_b16 v[152:153], v128 offset:4096
ds_read_b64_tr_b16 v[154:155], v128 offset:5120
ds_read_b64_tr_b16 v[112:113], v129 offset:4096
ds_read_b64_tr_b16 v[114:115], v129 offset:5120
ds_read_b64_tr_b16 v[116:117], v128 offset:8192
ds_read_b64_tr_b16 v[118:119], v128 offset:9216
s_waitcnt lgkmcnt(8)
v_mfma_f32_32x32x16_bf16 v[48:63], v[120:123], a[0:3], 0
ds_read_b64_tr_b16 v[120:121], v129 offset:8192
ds_read_b64_tr_b16 v[122:123], v129 offset:9216
s_waitcnt lgkmcnt(8)
v_mfma_f32_32x32x16_bf16 v[64:79], v[124:127], a[0:3], 0
ds_read_b64_tr_b16 v[124:125], v128 offset:12288
ds_read_b64_tr_b16 v[126:127], v128 offset:13312
s_waitcnt lgkmcnt(8)
v_mfma_f32_32x32x16_bf16 v[48:63], v[152:155], a[4:7], v[48:63]
ds_read_b64_tr_b16 v[152:153], v129 offset:12288
ds_read_b64_tr_b16 v[154:155], v129 offset:13312
s_waitcnt lgkmcnt(8)
v_mfma_f32_32x32x16_bf16 v[64:79], v[112:115], a[4:7], v[64:79]
v_add_u32 v128, 131072, v145
v_xor_b32 v129, 64, v128
ds_read_b64_tr_b16 v[112:113], v128 offset:0
ds_read_b64_tr_b16 v[114:115], v128 offset:1024
s_waitcnt lgkmcnt(8)
v_mfma_f32_32x32x16_bf16 v[48:63], v[116:119], a[8:11], v[48:63]
ds_read_b64_tr_b16 v[116:117], v129 offset:0
ds_read_b64_tr_b16 v[118:119], v129 offset:1024
s_waitcnt lgkmcnt(8)
v_mfma_f32_32x32x16_bf16 v[64:79], v[120:123], a[8:11], v[64:79]
ds_read_b64_tr_b16 v[120:121], v128 offset:4096
ds_read_b64_tr_b16 v[122:123], v128 offset:5120
s_waitcnt lgkmcnt(8)
v_mfma_f32_32x32x16_bf16 v[48:63], v[124:127], a[12:15], v[48:63]
ds_read_b64_tr_b16 v[124:125], v129 offset:4096
ds_read_b64_tr_b16 v[126:127], v129 offset:5120
s_waitcnt lgkmcnt(8)
v_mfma_f32_32x32x16_bf16 v[64:79], v[152:155], a[12:15], v[64:79]
ds_read_b64_tr_b16 v[152:153], v128 offset:8192
ds_read_b64_tr_b16 v[154:155], v128 offset:9216
s_waitcnt lgkmcnt(8)
v_mfma_f32_32x32x16_bf16 v[48:63], v[112:115], a[16:19], v[48:63]
ds_read_b64_tr_b16 v[112:113], v129 offset:8192
ds_read_b64_tr_b16 v[114:115], v129 offset:9216
s_waitcnt lgkmcnt(8)
v_mfma_f32_32x32x16_bf16 v[64:79], v[116:119], a[16:19], v[64:79]
s_waitcnt vmcnt(8)
s_barrier
s_add_u32 m0, s48, 32768
s_add_u32 s53, s50, 1573376
buffer_load_dwordx4 v137, s[28:31], s53 offen offset:0 lds
buffer_load_dwordx4 v138, s[28:31], s53 offen offset:1024 lds
buffer_load_dwordx4 v139, s[28:31], s53 offen offset:2048 lds
buffer_load_dwordx4 v140, s[28:31], s53 offen offset:3072 lds
ds_read_b64_tr_b16 v[116:117], v128 offset:12288
ds_read_b64_tr_b16 v[118:119], v128 offset:13312
s_waitcnt lgkmcnt(8)
v_mfma_f32_32x32x16_bf16 v[48:63], v[120:123], a[20:23], v[48:63]
ds_read_b64_tr_b16 v[120:121], v129 offset:12288
ds_read_b64_tr_b16 v[122:123], v129 offset:13312
s_waitcnt lgkmcnt(8)
v_mfma_f32_32x32x16_bf16 v[64:79], v[124:127], a[20:23], v[64:79]
s_waitcnt vmcnt(8)
s_barrier
s_add_u32 m0, s48, 49152
s_add_u32 s53, s50, 2097664
buffer_load_dwordx4 v137, s[28:31], s53 offen offset:0 lds
buffer_load_dwordx4 v138, s[28:31], s53 offen offset:1024 lds
buffer_load_dwordx4 v139, s[28:31], s53 offen offset:2048 lds
buffer_load_dwordx4 v140, s[28:31], s53 offen offset:3072 lds
s_waitcnt vmcnt(8)
s_barrier
s_add_u32 m0, s48, 65536
s_add_u32 s53, s49, 65536
buffer_load_dwordx4 v132, s[20:23], s53 offen offset:0 nt lds
buffer_load_dwordx4 v133, s[20:23], s53 offen offset:1024 nt lds
buffer_load_dwordx4 v134, s[20:23], s53 offen offset:2048 nt lds
buffer_load_dwordx4 v135, s[20:23], s53 offen offset:3072 nt lds
s_waitcnt lgkmcnt(0)
s_waitcnt vmcnt(8)
s_barrier
s_add_u32 m0, s48, 81920
s_add_u32 s53, s49, 81920
buffer_load_dwordx4 v132, s[20:23], s53 offen offset:0 nt lds
buffer_load_dwordx4 v133, s[20:23], s53 offen offset:1024 nt lds
buffer_load_dwordx4 v134, s[20:23], s53 offen offset:2048 nt lds
buffer_load_dwordx4 v135, s[20:23], s53 offen offset:3072 nt lds
s_waitcnt lgkmcnt(0)
s_waitcnt vmcnt(8)
s_barrier
s_add_u32 m0, s48, 98304
s_add_u32 s53, s50, 2621952
buffer_load_dwordx4 v137, s[28:31], s53 offen offset:0 lds
buffer_load_dwordx4 v138, s[28:31], s53 offen offset:1024 lds
buffer_load_dwordx4 v139, s[28:31], s53 offen offset:2048 lds
buffer_load_dwordx4 v140, s[28:31], s53 offen offset:3072 lds
v_add_u32 v128, 49152, v145
v_xor_b32 v129, 64, v128
ds_read_b64_tr_b16 v[124:125], v128 offset:0
ds_read_b64_tr_b16 v[126:127], v128 offset:1024
v_mfma_f32_32x32x16_bf16 v[48:63], v[152:155], a[24:27], v[48:63]
ds_read_b64_tr_b16 v[152:153], v129 offset:0
ds_read_b64_tr_b16 v[154:155], v129 offset:1024
v_mfma_f32_32x32x16_bf16 v[64:79], v[112:115], a[24:27], v[64:79]
ds_read_b64_tr_b16 v[112:113], v128 offset:4096
ds_read_b64_tr_b16 v[114:115], v128 offset:5120
v_mfma_f32_32x32x16_bf16 v[48:63], v[116:119], a[28:31], v[48:63]
ds_read_b64_tr_b16 v[116:117], v129 offset:4096
ds_read_b64_tr_b16 v[118:119], v129 offset:5120
v_mfma_f32_32x32x16_bf16 v[64:79], v[120:123], a[28:31], v[64:79]
ds_read_b64_tr_b16 v[120:121], v128 offset:8192
ds_read_b64_tr_b16 v[122:123], v128 offset:9216
s_waitcnt lgkmcnt(8)
v_mfma_f32_32x32x16_bf16 v[48:63], v[124:127], a[32:35], v[48:63]
ds_read_b64_tr_b16 v[124:125], v129 offset:8192
ds_read_b64_tr_b16 v[126:127], v129 offset:9216
s_waitcnt lgkmcnt(8)
v_mfma_f32_32x32x16_bf16 v[64:79], v[152:155], a[32:35], v[64:79]
ds_read_b64_tr_b16 v[152:153], v128 offset:12288
ds_read_b64_tr_b16 v[154:155], v128 offset:13312
s_waitcnt lgkmcnt(8)
v_mfma_f32_32x32x16_bf16 v[48:63], v[112:115], a[36:39], v[48:63]
ds_read_b64_tr_b16 v[112:113], v129 offset:12288
ds_read_b64_tr_b16 v[114:115], v129 offset:13312
s_waitcnt lgkmcnt(8)
v_mfma_f32_32x32x16_bf16 v[64:79], v[116:119], a[36:39], v[64:79]
v_add_u32 v128, 65536, v145
v_xor_b32 v129, 64, v128
ds_read_b64_tr_b16 v[116:117], v128 offset:0
ds_read_b64_tr_b16 v[118:119], v128 offset:1024
s_waitcnt lgkmcnt(8)
v_mfma_f32_32x32x16_bf16 v[48:63], v[120:123], a[40:43], v[48:63]
ds_read_b64_tr_b16 v[120:121], v129 offset:0
ds_read_b64_tr_b16 v[122:123], v129 offset:1024
s_waitcnt lgkmcnt(8)
v_mfma_f32_32x32x16_bf16 v[64:79], v[124:127], a[40:43], v[64:79]
ds_read_b64_tr_b16 v[124:125], v128 offset:4096
ds_read_b64_tr_b16 v[126:127], v128 offset:5120
s_waitcnt lgkmcnt(8)
v_mfma_f32_32x32x16_bf16 v[48:63], v[152:155], a[44:47], v[48:63]
ds_read_b64_tr_b16 v[152:153], v129 offset:4096
ds_read_b64_tr_b16 v[154:155], v129 offset:5120
s_waitcnt lgkmcnt(8)
v_mfma_f32_32x32x16_bf16 v[64:79], v[112:115], a[44:47], v[64:79]
ds_read_b64_tr_b16 v[112:113], v128 offset:8192
ds_read_b64_tr_b16 v[114:115], v128 offset:9216
s_waitcnt lgkmcnt(8)
v_mfma_f32_32x32x16_bf16 v[48:63], v[116:119], a[48:51], v[48:63]
ds_read_b64_tr_b16 v[116:117], v129 offset:8192
ds_read_b64_tr_b16 v[118:119], v129 offset:9216
s_waitcnt lgkmcnt(8)
v_mfma_f32_32x32x16_bf16 v[64:79], v[120:123], a[48:51], v[64:79]
s_waitcnt vmcnt(8)
s_barrier
s_add_u32 m0, s48, 114688
s_add_u32 s53, s50, 3146240
buffer_load_dwordx4 v137, s[28:31], s53 offen offset:0 lds
buffer_load_dwordx4 v138, s[28:31], s53 offen offset:1024 lds
buffer_load_dwordx4 v139, s[28:31], s53 offen offset:2048 lds
buffer_load_dwordx4 v140, s[28:31], s53 offen offset:3072 lds
ds_read_b64_tr_b16 v[120:121], v128 offset:12288
ds_read_b64_tr_b16 v[122:123], v128 offset:13312
s_waitcnt lgkmcnt(8)
v_mfma_f32_32x32x16_bf16 v[48:63], v[124:127], a[52:55], v[48:63]
ds_read_b64_tr_b16 v[124:125], v129 offset:12288
ds_read_b64_tr_b16 v[126:127], v129 offset:13312
s_waitcnt lgkmcnt(8)
v_mfma_f32_32x32x16_bf16 v[64:79], v[152:155], a[52:55], v[64:79]
v_add_u32 v128, 81920, v145
v_xor_b32 v129, 64, v128
ds_read_b64_tr_b16 v[152:153], v128 offset:0
ds_read_b64_tr_b16 v[154:155], v128 offset:1024
s_waitcnt lgkmcnt(8)
v_mfma_f32_32x32x16_bf16 v[48:63], v[112:115], a[56:59], v[48:63]
ds_read_b64_tr_b16 v[112:113], v129 offset:0
ds_read_b64_tr_b16 v[114:115], v129 offset:1024
s_waitcnt lgkmcnt(8)
v_mfma_f32_32x32x16_bf16 v[64:79], v[116:119], a[56:59], v[64:79]
ds_read_b64_tr_b16 v[116:117], v128 offset:4096
ds_read_b64_tr_b16 v[118:119], v128 offset:5120
s_waitcnt lgkmcnt(8)
v_mfma_f32_32x32x16_bf16 v[48:63], v[120:123], a[60:63], v[48:63]
ds_read_b64_tr_b16 v[120:121], v129 offset:4096
ds_read_b64_tr_b16 v[122:123], v129 offset:5120
s_waitcnt lgkmcnt(8)
v_mfma_f32_32x32x16_bf16 v[64:79], v[124:127], a[60:63], v[64:79]
ds_read_b64_tr_b16 v[124:125], v128 offset:8192
ds_read_b64_tr_b16 v[126:127], v128 offset:9216
s_waitcnt lgkmcnt(8)
v_mfma_f32_32x32x16_bf16 v[48:63], v[152:155], a[64:67], v[48:63]
ds_read_b64_tr_b16 v[152:153], v129 offset:8192
ds_read_b64_tr_b16 v[154:155], v129 offset:9216
s_waitcnt lgkmcnt(8)
v_mfma_f32_32x32x16_bf16 v[64:79], v[112:115], a[64:67], v[64:79]
ds_read_b64_tr_b16 v[112:113], v128 offset:12288
ds_read_b64_tr_b16 v[114:115], v128 offset:13312
s_waitcnt lgkmcnt(8)
v_mfma_f32_32x32x16_bf16 v[48:63], v[116:119], a[68:71], v[48:63]
ds_read_b64_tr_b16 v[116:117], v129 offset:12288
ds_read_b64_tr_b16 v[118:119], v129 offset:13312
s_waitcnt lgkmcnt(8)
v_mfma_f32_32x32x16_bf16 v[64:79], v[120:123], a[68:71], v[64:79]
s_waitcnt vmcnt(8)
s_barrier
s_add_u32 m0, s48, 0
s_add_u32 s53, s49, 98304
buffer_load_dwordx4 v132, s[20:23], s53 offen offset:0 nt lds
buffer_load_dwordx4 v133, s[20:23], s53 offen offset:1024 nt lds
buffer_load_dwordx4 v134, s[20:23], s53 offen offset:2048 nt lds
buffer_load_dwordx4 v135, s[20:23], s53 offen offset:3072 nt lds
s_waitcnt vmcnt(8)
s_barrier
s_add_u32 m0, s48, 16384
s_add_u32 s53, s49, 114688
buffer_load_dwordx4 v132, s[20:23], s53 offen offset:0 nt lds
buffer_load_dwordx4 v133, s[20:23], s53 offen offset:1024 nt lds
buffer_load_dwordx4 v134, s[20:23], s53 offen offset:2048 nt lds
buffer_load_dwordx4 v135, s[20:23], s53 offen offset:3072 nt lds
s_waitcnt lgkmcnt(0)
s_waitcnt vmcnt(8)
s_barrier
s_add_u32 m0, s48, 32768
s_add_u32 s53, s50, 3670528
buffer_load_dwordx4 v137, s[28:31], s53 offen offset:0 lds
buffer_load_dwordx4 v138, s[28:31], s53 offen offset:1024 lds
buffer_load_dwordx4 v139, s[28:31], s53 offen offset:2048 lds
buffer_load_dwordx4 v140, s[28:31], s53 offen offset:3072 lds
v_add_u32 v128, 131072, v145
v_xor_b32 v129, 64, v128
ds_read_b64_tr_b16 v[120:121], v128 offset:0
ds_read_b64_tr_b16 v[122:123], v128 offset:1024
v_mfma_f32_32x32x16_bf16 v[48:63], v[124:127], a[72:75], v[48:63]
ds_read_b64_tr_b16 v[124:125], v129 offset:0
ds_read_b64_tr_b16 v[126:127], v129 offset:1024
v_mfma_f32_32x32x16_bf16 v[64:79], v[152:155], a[72:75], v[64:79]
ds_read_b64_tr_b16 v[152:153], v128 offset:4096
ds_read_b64_tr_b16 v[154:155], v128 offset:5120
v_mfma_f32_32x32x16_bf16 v[48:63], v[112:115], a[76:79], v[48:63]
ds_read_b64_tr_b16 v[112:113], v129 offset:4096
ds_read_b64_tr_b16 v[114:115], v129 offset:5120
v_mfma_f32_32x32x16_bf16 v[64:79], v[116:119], a[76:79], v[64:79]
ds_read_b64_tr_b16 v[116:117], v128 offset:8192
ds_read_b64_tr_b16 v[118:119], v128 offset:9216
s_waitcnt lgkmcnt(8)
v_mfma_f32_32x32x16_bf16 v[48:63], v[120:123], a[80:83], v[48:63]
ds_read_b64_tr_b16 v[120:121], v129 offset:8192
ds_read_b64_tr_b16 v[122:123], v129 offset:9216
s_waitcnt lgkmcnt(8)
v_mfma_f32_32x32x16_bf16 v[64:79], v[124:127], a[80:83], v[64:79]
ds_read_b64_tr_b16 v[124:125], v128 offset:12288
ds_read_b64_tr_b16 v[126:127], v128 offset:13312
s_waitcnt lgkmcnt(8)
v_mfma_f32_32x32x16_bf16 v[48:63], v[152:155], a[84:87], v[48:63]
ds_read_b64_tr_b16 v[152:153], v129 offset:12288
ds_read_b64_tr_b16 v[154:155], v129 offset:13312
s_waitcnt lgkmcnt(8)
v_mfma_f32_32x32x16_bf16 v[64:79], v[112:115], a[84:87], v[64:79]
v_add_u32 v128, 147456, v145
v_xor_b32 v129, 64, v128
ds_read_b64_tr_b16 v[112:113], v128 offset:0
ds_read_b64_tr_b16 v[114:115], v128 offset:1024
s_waitcnt lgkmcnt(8)
v_mfma_f32_32x32x16_bf16 v[48:63], v[116:119], a[88:91], v[48:63]
ds_read_b64_tr_b16 v[116:117], v129 offset:0
ds_read_b64_tr_b16 v[118:119], v129 offset:1024
s_waitcnt lgkmcnt(8)
v_mfma_f32_32x32x16_bf16 v[64:79], v[120:123], a[88:91], v[64:79]
ds_read_b64_tr_b16 v[120:121], v128 offset:4096
ds_read_b64_tr_b16 v[122:123], v128 offset:5120
s_waitcnt lgkmcnt(8)
v_mfma_f32_32x32x16_bf16 v[48:63], v[124:127], a[92:95], v[48:63]
ds_read_b64_tr_b16 v[124:125], v129 offset:4096
ds_read_b64_tr_b16 v[126:127], v129 offset:5120
s_waitcnt lgkmcnt(8)
v_mfma_f32_32x32x16_bf16 v[64:79], v[152:155], a[92:95], v[64:79]
ds_read_b64_tr_b16 v[152:153], v128 offset:8192
ds_read_b64_tr_b16 v[154:155], v128 offset:9216
s_waitcnt lgkmcnt(8)
v_mfma_f32_32x32x16_bf16 v[48:63], v[112:115], v[0:3], v[48:63]
ds_read_b64_tr_b16 v[112:113], v129 offset:8192
ds_read_b64_tr_b16 v[114:115], v129 offset:9216
s_waitcnt lgkmcnt(8)
v_mfma_f32_32x32x16_bf16 v[64:79], v[116:119], v[0:3], v[64:79]
s_waitcnt vmcnt(8)
s_barrier
s_add_u32 m0, s48, 49152
s_add_u32 s53, s50, 4194816
buffer_load_dwordx4 v137, s[28:31], s53 offen offset:0 lds
buffer_load_dwordx4 v138, s[28:31], s53 offen offset:1024 lds
buffer_load_dwordx4 v139, s[28:31], s53 offen offset:2048 lds
buffer_load_dwordx4 v140, s[28:31], s53 offen offset:3072 lds
ds_read_b64_tr_b16 v[116:117], v128 offset:12288
ds_read_b64_tr_b16 v[118:119], v128 offset:13312
s_waitcnt lgkmcnt(8)
v_mfma_f32_32x32x16_bf16 v[48:63], v[120:123], v[4:7], v[48:63]
ds_read_b64_tr_b16 v[120:121], v129 offset:12288
ds_read_b64_tr_b16 v[122:123], v129 offset:13312
s_waitcnt lgkmcnt(8)
v_mfma_f32_32x32x16_bf16 v[64:79], v[124:127], v[4:7], v[64:79]
s_waitcnt vmcnt(8)
s_barrier
s_add_u32 m0, s48, 65536
s_add_u32 s53, s49, 0
buffer_load_dwordx4 v136, s[24:27], s53 offen offset:0 nt lds
buffer_load_dwordx4 v136, s[24:27], s53 offen offset:1024 nt lds
buffer_load_dwordx4 v136, s[24:27], s53 offen offset:2048 nt lds
buffer_load_dwordx4 v136, s[24:27], s53 offen offset:3072 nt lds
s_waitcnt vmcnt(8)
s_barrier
s_add_u32 m0, s48, 81920
s_add_u32 s53, s49, 16384
buffer_load_dwordx4 v136, s[24:27], s53 offen offset:0 nt lds
buffer_load_dwordx4 v136, s[24:27], s53 offen offset:1024 nt lds
buffer_load_dwordx4 v136, s[24:27], s53 offen offset:2048 nt lds
buffer_load_dwordx4 v136, s[24:27], s53 offen offset:3072 nt lds
s_waitcnt lgkmcnt(0)
s_waitcnt vmcnt(8)
s_barrier
s_add_u32 m0, s48, 98304
s_add_u32 s53, s50, 768
buffer_load_dwordx4 v137, s[28:31], s53 offen offset:0 lds
buffer_load_dwordx4 v138, s[28:31], s53 offen offset:1024 lds
buffer_load_dwordx4 v139, s[28:31], s53 offen offset:2048 lds
buffer_load_dwordx4 v140, s[28:31], s53 offen offset:3072 lds
v_add_u32 v128, 65536, v145
v_xor_b32 v129, 64, v128
ds_read_b64_tr_b16 v[124:125], v128 offset:0
ds_read_b64_tr_b16 v[126:127], v128 offset:1024
v_mfma_f32_32x32x16_bf16 v[48:63], v[152:155], v[8:11], v[48:63]
ds_read_b64_tr_b16 v[152:153], v129 offset:0
ds_read_b64_tr_b16 v[154:155], v129 offset:1024
v_mfma_f32_32x32x16_bf16 v[64:79], v[112:115], v[8:11], v[64:79]
ds_read_b64_tr_b16 v[112:113], v128 offset:4096
ds_read_b64_tr_b16 v[114:115], v128 offset:5120
v_mfma_f32_32x32x16_bf16 v[48:63], v[116:119], v[12:15], v[48:63]
ds_read_b64_tr_b16 v[116:117], v129 offset:4096
ds_read_b64_tr_b16 v[118:119], v129 offset:5120
v_mfma_f32_32x32x16_bf16 v[64:79], v[120:123], v[12:15], v[64:79]
ds_read_b64_tr_b16 v[120:121], v128 offset:8192
ds_read_b64_tr_b16 v[122:123], v128 offset:9216
s_waitcnt lgkmcnt(8)
v_mfma_f32_32x32x16_bf16 v[48:63], v[124:127], v[16:19], v[48:63]
ds_read_b64_tr_b16 v[124:125], v129 offset:8192
ds_read_b64_tr_b16 v[126:127], v129 offset:9216
s_waitcnt lgkmcnt(8)
v_mfma_f32_32x32x16_bf16 v[64:79], v[152:155], v[16:19], v[64:79]
ds_read_b64_tr_b16 v[152:153], v128 offset:12288
ds_read_b64_tr_b16 v[154:155], v128 offset:13312
s_waitcnt lgkmcnt(8)
v_mfma_f32_32x32x16_bf16 v[48:63], v[112:115], v[20:23], v[48:63]
ds_read_b64_tr_b16 v[112:113], v129 offset:12288
ds_read_b64_tr_b16 v[114:115], v129 offset:13312
s_waitcnt lgkmcnt(8)
v_mfma_f32_32x32x16_bf16 v[64:79], v[116:119], v[20:23], v[64:79]
v_add_u32 v128, 81920, v145
v_xor_b32 v129, 64, v128
ds_read_b64_tr_b16 v[116:117], v128 offset:0
ds_read_b64_tr_b16 v[118:119], v128 offset:1024
s_waitcnt lgkmcnt(8)
v_mfma_f32_32x32x16_bf16 v[48:63], v[120:123], v[24:27], v[48:63]
ds_read_b64_tr_b16 v[120:121], v129 offset:0
ds_read_b64_tr_b16 v[122:123], v129 offset:1024
s_waitcnt lgkmcnt(8)
v_mfma_f32_32x32x16_bf16 v[64:79], v[124:127], v[24:27], v[64:79]
ds_read_b64_tr_b16 v[124:125], v128 offset:4096
ds_read_b64_tr_b16 v[126:127], v128 offset:5120
s_waitcnt lgkmcnt(8)
v_mfma_f32_32x32x16_bf16 v[48:63], v[152:155], v[28:31], v[48:63]
ds_read_b64_tr_b16 v[152:153], v129 offset:4096
ds_read_b64_tr_b16 v[154:155], v129 offset:5120
s_waitcnt lgkmcnt(8)
v_mfma_f32_32x32x16_bf16 v[64:79], v[112:115], v[28:31], v[64:79]
ds_read_b64_tr_b16 v[112:113], v128 offset:8192
ds_read_b64_tr_b16 v[114:115], v128 offset:9216
s_waitcnt lgkmcnt(8)
v_mfma_f32_32x32x16_bf16 v[48:63], v[116:119], v[32:35], v[48:63]
ds_read_b64_tr_b16 v[116:117], v129 offset:8192
ds_read_b64_tr_b16 v[118:119], v129 offset:9216
s_waitcnt lgkmcnt(8)
v_mfma_f32_32x32x16_bf16 v[64:79], v[120:123], v[32:35], v[64:79]
s_waitcnt vmcnt(8)
s_barrier
s_add_u32 m0, s48, 114688
s_add_u32 s53, s50, 525056
buffer_load_dwordx4 v137, s[28:31], s53 offen offset:0 lds
buffer_load_dwordx4 v138, s[28:31], s53 offen offset:1024 lds
buffer_load_dwordx4 v139, s[28:31], s53 offen offset:2048 lds
buffer_load_dwordx4 v140, s[28:31], s53 offen offset:3072 lds
ds_read_b64_tr_b16 v[120:121], v128 offset:12288
ds_read_b64_tr_b16 v[122:123], v128 offset:13312
s_waitcnt lgkmcnt(8)
v_mfma_f32_32x32x16_bf16 v[48:63], v[124:127], v[36:39], v[48:63]
ds_read_b64_tr_b16 v[124:125], v129 offset:12288
ds_read_b64_tr_b16 v[126:127], v129 offset:13312
s_waitcnt lgkmcnt(8)
v_mfma_f32_32x32x16_bf16 v[64:79], v[152:155], v[36:39], v[64:79]
s_waitcnt lgkmcnt(6)
v_mfma_f32_32x32x16_bf16 v[48:63], v[112:115], v[40:43], v[48:63]
s_waitcnt lgkmcnt(4)
v_mfma_f32_32x32x16_bf16 v[64:79], v[116:119], v[40:43], v[64:79]
s_waitcnt lgkmcnt(2)
v_mfma_f32_32x32x16_bf16 v[48:63], v[120:123], v[44:47], v[48:63]
s_waitcnt lgkmcnt(0)
v_mfma_f32_32x32x16_bf16 v[64:79], v[124:127], v[44:47], v[64:79]
s_nop 11
v_cvt_pk_bf16_f32 v96, v48, v49
v_cvt_pk_bf16_f32 v97, v50, v51
v_cvt_pk_bf16_f32 v98, v52, v53
v_cvt_pk_bf16_f32 v99, v54, v55
v_cvt_pk_bf16_f32 v100, v56, v57
v_cvt_pk_bf16_f32 v101, v58, v59
v_cvt_pk_bf16_f32 v102, v60, v61
v_cvt_pk_bf16_f32 v103, v62, v63
v_cvt_pk_bf16_f32 v104, v64, v65
v_cvt_pk_bf16_f32 v105, v66, v67
v_cvt_pk_bf16_f32 v106, v68, v69
v_cvt_pk_bf16_f32 v107, v70, v71
v_cvt_pk_bf16_f32 v108, v72, v73
v_cvt_pk_bf16_f32 v109, v74, v75
v_cvt_pk_bf16_f32 v110, v76, v77
v_cvt_pk_bf16_f32 v111, v78, v79
s_waitcnt vmcnt(8)
s_barrier
s_add_u32 m0, s48, 0
s_add_u32 s53, s49, 32768
buffer_load_dwordx4 v136, s[24:27], s53 offen offset:0 nt lds
buffer_load_dwordx4 v136, s[24:27], s53 offen offset:1024 nt lds
buffer_load_dwordx4 v136, s[24:27], s53 offen offset:2048 nt lds
buffer_load_dwordx4 v136, s[24:27], s53 offen offset:3072 nt lds
v_add_u32 v148, s52, v147
ds_write_b128 v148, v[80:83] offset:0
ds_write_b128 v148, v[84:87] offset:1024
ds_write_b128 v148, v[88:91] offset:2048
ds_write_b128 v148, v[92:95] offset:3072
s_waitcnt lgkmcnt(0)
s_waitcnt vmcnt(8)
s_barrier
s_add_u32 m0, s48, 16384
s_add_u32 s53, s49, 49152
buffer_load_dwordx4 v136, s[24:27], s53 offen offset:0 nt lds
buffer_load_dwordx4 v136, s[24:27], s53 offen offset:1024 nt lds
buffer_load_dwordx4 v136, s[24:27], s53 offen offset:2048 nt lds
buffer_load_dwordx4 v136, s[24:27], s53 offen offset:3072 nt lds
s_waitcnt vmcnt(8)
s_barrier
s_add_u32 m0, s48, 32768
s_add_u32 s53, s50, 1049344
buffer_load_dwordx4 v137, s[28:31], s53 offen offset:0 lds
buffer_load_dwordx4 v138, s[28:31], s53 offen offset:1024 lds
buffer_load_dwordx4 v139, s[28:31], s53 offen offset:2048 lds
buffer_load_dwordx4 v140, s[28:31], s53 offen offset:3072 lds
v_add_u32 v128, 131072, v145
v_xor_b32 v129, 64, v128
ds_read_b64_tr_b16 v[152:153], v128 offset:0
ds_read_b64_tr_b16 v[154:155], v128 offset:1024
ds_read_b64_tr_b16 v[112:113], v129 offset:0
ds_read_b64_tr_b16 v[114:115], v129 offset:1024
ds_read_b64_tr_b16 v[116:117], v128 offset:4096
ds_read_b64_tr_b16 v[118:119], v128 offset:5120
ds_read_b64_tr_b16 v[120:121], v129 offset:4096
ds_read_b64_tr_b16 v[122:123], v129 offset:5120
ds_read_b64_tr_b16 v[124:125], v128 offset:8192
ds_read_b64_tr_b16 v[126:127], v128 offset:9216
s_waitcnt lgkmcnt(8)
v_mfma_f32_32x32x16_bf16 v[48:63], v[152:155], a[0:3], 0
ds_read_b64_tr_b16 v[152:153], v129 offset:8192
ds_read_b64_tr_b16 v[154:155], v129 offset:9216
s_waitcnt lgkmcnt(8)
v_mfma_f32_32x32x16_bf16 v[64:79], v[112:115], a[0:3], 0
ds_read_b64_tr_b16 v[112:113], v128 offset:12288
ds_read_b64_tr_b16 v[114:115], v128 offset:13312
s_waitcnt lgkmcnt(8)
v_mfma_f32_32x32x16_bf16 v[48:63], v[116:119], a[4:7], v[48:63]
ds_read_b64_tr_b16 v[116:117], v129 offset:12288
ds_read_b64_tr_b16 v[118:119], v129 offset:13312
s_waitcnt lgkmcnt(8)
v_mfma_f32_32x32x16_bf16 v[64:79], v[120:123], a[4:7], v[64:79]
v_add_u32 v128, 147456, v145
v_xor_b32 v129, 64, v128
ds_read_b64_tr_b16 v[120:121], v128 offset:0
ds_read_b64_tr_b16 v[122:123], v128 offset:1024
s_waitcnt lgkmcnt(8)
v_mfma_f32_32x32x16_bf16 v[48:63], v[124:127], a[8:11], v[48:63]
ds_read_b64_tr_b16 v[124:125], v129 offset:0
ds_read_b64_tr_b16 v[126:127], v129 offset:1024
s_waitcnt lgkmcnt(8)
v_mfma_f32_32x32x16_bf16 v[64:79], v[152:155], a[8:11], v[64:79]
ds_read_b64_tr_b16 v[152:153], v128 offset:4096
ds_read_b64_tr_b16 v[154:155], v128 offset:5120
s_waitcnt lgkmcnt(8)
v_mfma_f32_32x32x16_bf16 v[48:63], v[112:115], a[12:15], v[48:63]
ds_read_b64_tr_b16 v[112:113], v129 offset:4096
ds_read_b64_tr_b16 v[114:115], v129 offset:5120
s_waitcnt lgkmcnt(8)
v_mfma_f32_32x32x16_bf16 v[64:79], v[116:119], a[12:15], v[64:79]
ds_read_b64_tr_b16 v[116:117], v128 offset:8192
ds_read_b64_tr_b16 v[118:119], v128 offset:9216
s_waitcnt lgkmcnt(8)
v_mfma_f32_32x32x16_bf16 v[48:63], v[120:123], a[16:19], v[48:63]
ds_read_b64_tr_b16 v[120:121], v129 offset:8192
ds_read_b64_tr_b16 v[122:123], v129 offset:9216
s_waitcnt lgkmcnt(8)
v_mfma_f32_32x32x16_bf16 v[64:79], v[124:127], a[16:19], v[64:79]
s_waitcnt vmcnt(8)
s_barrier
s_add_u32 m0, s48, 49152
s_add_u32 s53, s50, 1573632
buffer_load_dwordx4 v137, s[28:31], s53 offen offset:0 lds
buffer_load_dwordx4 v138, s[28:31], s53 offen offset:1024 lds
buffer_load_dwordx4 v139, s[28:31], s53 offen offset:2048 lds
buffer_load_dwordx4 v140, s[28:31], s53 offen offset:3072 lds
ds_read_b64_tr_b16 v[124:125], v128 offset:12288
ds_read_b64_tr_b16 v[126:127], v128 offset:13312
s_waitcnt lgkmcnt(8)
v_mfma_f32_32x32x16_bf16 v[48:63], v[152:155], a[20:23], v[48:63]
ds_read_b64_tr_b16 v[152:153], v129 offset:12288
ds_read_b64_tr_b16 v[154:155], v129 offset:13312
s_waitcnt lgkmcnt(8)
v_mfma_f32_32x32x16_bf16 v[64:79], v[112:115], a[20:23], v[64:79]
s_waitcnt vmcnt(8)
s_barrier
s_add_u32 m0, s48, 65536
s_add_u32 s53, s50, 2097920
buffer_load_dwordx4 v137, s[28:31], s53 offen offset:0 lds
buffer_load_dwordx4 v138, s[28:31], s53 offen offset:1024 lds
buffer_load_dwordx4 v139, s[28:31], s53 offen offset:2048 lds
buffer_load_dwordx4 v140, s[28:31], s53 offen offset:3072 lds
s_waitcnt vmcnt(8)
s_barrier
s_add_u32 m0, s48, 81920
s_add_u32 s53, s49, 65536
buffer_load_dwordx4 v136, s[24:27], s53 offen offset:0 nt lds
buffer_load_dwordx4 v136, s[24:27], s53 offen offset:1024 nt lds
buffer_load_dwordx4 v136, s[24:27], s53 offen offset:2048 nt lds
buffer_load_dwordx4 v136, s[24:27], s53 offen offset:3072 nt lds
s_waitcnt lgkmcnt(0)
s_waitcnt vmcnt(8)
s_barrier
s_add_u32 m0, s48, 98304
s_add_u32 s53, s49, 81920
buffer_load_dwordx4 v136, s[24:27], s53 offen offset:0 nt lds
buffer_load_dwordx4 v136, s[24:27], s53 offen offset:1024 nt lds
buffer_load_dwordx4 v136, s[24:27], s53 offen offset:2048 nt lds
buffer_load_dwordx4 v136, s[24:27], s53 offen offset:3072 nt lds
s_add_u32 s53, s54, 0
buffer_load_dword v159, v157, s[64:67], s53 offen
s_waitcnt lgkmcnt(0)
s_waitcnt vmcnt(9)
s_barrier
s_add_u32 m0, s48, 114688
s_add_u32 s53, s50, 2622208
buffer_load_dwordx4 v137, s[28:31], s53 offen offset:0 lds
buffer_load_dwordx4 v138, s[28:31], s53 offen offset:1024 lds
buffer_load_dwordx4 v139, s[28:31], s53 offen offset:2048 lds
buffer_load_dwordx4 v140, s[28:31], s53 offen offset:3072 lds
v_add_u32 v128, 65536, v145
v_xor_b32 v129, 64, v128
ds_read_b64_tr_b16 v[112:113], v128 offset:0
ds_read_b64_tr_b16 v[114:115], v128 offset:1024
v_mfma_f32_32x32x16_bf16 v[48:63], v[116:119], a[24:27], v[48:63]
ds_read_b64_tr_b16 v[116:117], v129 offset:0
ds_read_b64_tr_b16 v[118:119], v129 offset:1024
v_mfma_f32_32x32x16_bf16 v[64:79], v[120:123], a[24:27], v[64:79]
ds_read_b64_tr_b16 v[120:121], v128 offset:4096
ds_read_b64_tr_b16 v[122:123], v128 offset:5120
v_mfma_f32_32x32x16_bf16 v[48:63], v[124:127], a[28:31], v[48:63]
ds_read_b64_tr_b16 v[124:125], v129 offset:4096
ds_read_b64_tr_b16 v[126:127], v129 offset:5120
v_mfma_f32_32x32x16_bf16 v[64:79], v[152:155], a[28:31], v[64:79]
ds_read_b64_tr_b16 v[152:153], v128 offset:8192
ds_read_b64_tr_b16 v[154:155], v128 offset:9216
s_waitcnt lgkmcnt(8)
v_mfma_f32_32x32x16_bf16 v[48:63], v[112:115], a[32:35], v[48:63]
ds_read_b64_tr_b16 v[112:113], v129 offset:8192
ds_read_b64_tr_b16 v[114:115], v129 offset:9216
s_waitcnt lgkmcnt(8)
v_mfma_f32_32x32x16_bf16 v[64:79], v[116:119], a[32:35], v[64:79]
ds_read_b64_tr_b16 v[116:117], v128 offset:12288
ds_read_b64_tr_b16 v[118:119], v128 offset:13312
s_waitcnt lgkmcnt(8)
v_mfma_f32_32x32x16_bf16 v[48:63], v[120:123], a[36:39], v[48:63]
ds_read_b64_tr_b16 v[120:121], v129 offset:12288
ds_read_b64_tr_b16 v[122:123], v129 offset:13312
s_waitcnt lgkmcnt(8)
v_mfma_f32_32x32x16_bf16 v[64:79], v[124:127], a[36:39], v[64:79]
v_add_u32 v128, 81920, v145
v_xor_b32 v129, 64, v128
ds_read_b64_tr_b16 v[124:125], v128 offset:0
ds_read_b64_tr_b16 v[126:127], v128 offset:1024
s_waitcnt lgkmcnt(8)
v_mfma_f32_32x32x16_bf16 v[48:63], v[152:155], a[40:43], v[48:63]
ds_read_b64_tr_b16 v[152:153], v129 offset:0
ds_read_b64_tr_b16 v[154:155], v129 offset:1024
s_waitcnt lgkmcnt(8)
v_mfma_f32_32x32x16_bf16 v[64:79], v[112:115], a[40:43], v[64:79]
ds_read_b64_tr_b16 v[112:113], v128 offset:4096
ds_read_b64_tr_b16 v[114:115], v128 offset:5120
s_waitcnt lgkmcnt(8)
v_mfma_f32_32x32x16_bf16 v[48:63], v[116:119], a[44:47], v[48:63]
ds_read_b64_tr_b16 v[116:117], v129 offset:4096
ds_read_b64_tr_b16 v[118:119], v129 offset:5120
s_waitcnt lgkmcnt(8)
v_mfma_f32_32x32x16_bf16 v[64:79], v[120:123], a[44:47], v[64:79]
ds_read_b64_tr_b16 v[120:121], v128 offset:8192
ds_read_b64_tr_b16 v[122:123], v128 offset:9216
s_waitcnt lgkmcnt(8)
v_mfma_f32_32x32x16_bf16 v[48:63], v[124:127], a[48:51], v[48:63]
ds_read_b64_tr_b16 v[124:125], v129 offset:8192
ds_read_b64_tr_b16 v[126:127], v129 offset:9216
s_waitcnt lgkmcnt(8)
v_mfma_f32_32x32x16_bf16 v[64:79], v[152:155], a[48:51], v[64:79]
s_waitcnt vmcnt(9)
s_barrier
s_add_u32 m0, s48, 0
s_add_u32 s53, s50, 3146496
buffer_load_dwordx4 v137, s[28:31], s53 offen offset:0 lds
buffer_load_dwordx4 v138, s[28:31], s53 offen offset:1024 lds
buffer_load_dwordx4 v139, s[28:31], s53 offen offset:2048 lds
buffer_load_dwordx4 v140, s[28:31], s53 offen offset:3072 lds
ds_read_b64_tr_b16 v[152:153], v128 offset:12288
ds_read_b64_tr_b16 v[154:155], v128 offset:13312
s_waitcnt lgkmcnt(8)
v_mfma_f32_32x32x16_bf16 v[48:63], v[112:115], a[52:55], v[48:63]
ds_read_b64_tr_b16 v[112:113], v129 offset:12288
ds_read_b64_tr_b16 v[114:115], v129 offset:13312
s_waitcnt lgkmcnt(8)
v_mfma_f32_32x32x16_bf16 v[64:79], v[116:119], a[52:55], v[64:79]
v_add_u32 v128, 98304, v145
v_xor_b32 v129, 64, v128
ds_read_b64_tr_b16 v[116:117], v128 offset:0
ds_read_b64_tr_b16 v[118:119], v128 offset:1024
s_waitcnt lgkmcnt(8)
v_mfma_f32_32x32x16_bf16 v[48:63], v[120:123], a[56:59], v[48:63]
ds_read_b64_tr_b16 v[120:121], v129 offset:0
ds_read_b64_tr_b16 v[122:123], v129 offset:1024
s_waitcnt lgkmcnt(8)
v_mfma_f32_32x32x16_bf16 v[64:79], v[124:127], a[56:59], v[64:79]
ds_read_b64_tr_b16 v[124:125], v128 offset:4096
ds_read_b64_tr_b16 v[126:127], v128 offset:5120
s_waitcnt lgkmcnt(8)
v_mfma_f32_32x32x16_bf16 v[48:63], v[152:155], a[60:63], v[48:63]
ds_read_b64_tr_b16 v[152:153], v129 offset:4096
ds_read_b64_tr_b16 v[154:155], v129 offset:5120
s_waitcnt lgkmcnt(8)
v_mfma_f32_32x32x16_bf16 v[64:79], v[112:115], a[60:63], v[64:79]
ds_read_b64_tr_b16 v[112:113], v128 offset:8192
ds_read_b64_tr_b16 v[114:115], v128 offset:9216
s_waitcnt lgkmcnt(8)
v_mfma_f32_32x32x16_bf16 v[48:63], v[116:119], a[64:67], v[48:63]
ds_read_b64_tr_b16 v[116:117], v129 offset:8192
ds_read_b64_tr_b16 v[118:119], v129 offset:9216
s_waitcnt lgkmcnt(8)
v_mfma_f32_32x32x16_bf16 v[64:79], v[120:123], a[64:67], v[64:79]
ds_read_b64_tr_b16 v[120:121], v128 offset:12288
ds_read_b64_tr_b16 v[122:123], v128 offset:13312
s_waitcnt lgkmcnt(8)
v_mfma_f32_32x32x16_bf16 v[48:63], v[124:127], a[68:71], v[48:63]
ds_read_b64_tr_b16 v[124:125], v129 offset:12288
ds_read_b64_tr_b16 v[126:127], v129 offset:13312
s_waitcnt lgkmcnt(8)
v_mfma_f32_32x32x16_bf16 v[64:79], v[152:155], a[68:71], v[64:79]
s_waitcnt vmcnt(9)
s_barrier
s_add_u32 m0, s48, 16384
s_add_u32 s53, s49, 98304
buffer_load_dwordx4 v136, s[24:27], s53 offen offset:0 nt lds
buffer_load_dwordx4 v136, s[24:27], s53 offen offset:1024 nt lds
buffer_load_dwordx4 v136, s[24:27], s53 offen offset:2048 nt lds
buffer_load_dwordx4 v136, s[24:27], s53 offen offset:3072 nt lds
s_waitcnt vmcnt(8)
s_barrier
s_add_u32 m0, s48, 32768
s_add_u32 s53, s49, 114688
buffer_load_dwordx4 v136, s[24:27], s53 offen offset:0 nt lds
buffer_load_dwordx4 v136, s[24:27], s53 offen offset:1024 nt lds
buffer_load_dwordx4 v136, s[24:27], s53 offen offset:2048 nt lds
buffer_load_dwordx4 v136, s[24:27], s53 offen offset:3072 nt lds
s_waitcnt lgkmcnt(0)
s_waitcnt vmcnt(8)
s_barrier
s_add_u32 m0, s48, 49152
s_add_u32 s53, s50, 3670784
buffer_load_dwordx4 v137, s[28:31], s53 offen offset:0 lds
buffer_load_dwordx4 v138, s[28:31], s53 offen offset:1024 lds
buffer_load_dwordx4 v139, s[28:31], s53 offen offset:2048 lds
buffer_load_dwordx4 v140, s[28:31], s53 offen offset:3072 lds
v_add_u32 v128, 147456, v145
v_xor_b32 v129, 64, v128
ds_read_b64_tr_b16 v[152:153], v128 offset:0
ds_read_b64_tr_b16 v[154:155], v128 offset:1024
v_mfma_f32_32x32x16_bf16 v[48:63], v[112:115], a[72:75], v[48:63]
ds_read_b64_tr_b16 v[112:113], v129 offset:0
ds_read_b64_tr_b16 v[114:115], v129 offset:1024
v_mfma_f32_32x32x16_bf16 v[64:79], v[116:119], a[72:75], v[64:79]
ds_read_b64_tr_b16 v[116:117], v128 offset:4096
ds_read_b64_tr_b16 v[118:119], v128 offset:5120
v_mfma_f32_32x32x16_bf16 v[48:63], v[120:123], a[76:79], v[48:63]
ds_read_b64_tr_b16 v[120:121], v129 offset:4096
ds_read_b64_tr_b16 v[122:123], v129 offset:5120
v_mfma_f32_32x32x16_bf16 v[64:79], v[124:127], a[76:79], v[64:79]
ds_read_b64_tr_b16 v[124:125], v128 offset:8192
ds_read_b64_tr_b16 v[126:127], v128 offset:9216
s_waitcnt lgkmcnt(8)
v_mfma_f32_32x32x16_bf16 v[48:63], v[152:155], a[80:83], v[48:63]
ds_read_b64_tr_b16 v[152:153], v129 offset:8192
ds_read_b64_tr_b16 v[154:155], v129 offset:9216
s_waitcnt lgkmcnt(8)
v_mfma_f32_32x32x16_bf16 v[64:79], v[112:115], a[80:83], v[64:79]
ds_read_b64_tr_b16 v[112:113], v128 offset:12288
ds_read_b64_tr_b16 v[114:115], v128 offset:13312
s_waitcnt lgkmcnt(8)
v_mfma_f32_32x32x16_bf16 v[48:63], v[116:119], a[84:87], v[48:63]
ds_read_b64_tr_b16 v[116:117], v129 offset:12288
ds_read_b64_tr_b16 v[118:119], v129 offset:13312
s_waitcnt lgkmcnt(8)
v_mfma_f32_32x32x16_bf16 v[64:79], v[120:123], a[84:87], v[64:79]
v_add_u32 v128, 32768, v145
v_xor_b32 v129, 64, v128
ds_read_b64_tr_b16 v[120:121], v128 offset:0
ds_read_b64_tr_b16 v[122:123], v128 offset:1024
s_waitcnt lgkmcnt(8)
v_mfma_f32_32x32x16_bf16 v[48:63], v[124:127], a[88:91], v[48:63]
ds_read_b64_tr_b16 v[124:125], v129 offset:0
ds_read_b64_tr_b16 v[126:127], v129 offset:1024
s_waitcnt lgkmcnt(8)
v_mfma_f32_32x32x16_bf16 v[64:79], v[152:155], a[88:91], v[64:79]
ds_read_b64_tr_b16 v[152:153], v128 offset:4096
ds_read_b64_tr_b16 v[154:155], v128 offset:5120
s_waitcnt lgkmcnt(8)
v_mfma_f32_32x32x16_bf16 v[48:63], v[112:115], a[92:95], v[48:63]
ds_read_b64_tr_b16 v[112:113], v129 offset:4096
ds_read_b64_tr_b16 v[114:115], v129 offset:5120
s_waitcnt lgkmcnt(8)
v_mfma_f32_32x32x16_bf16 v[64:79], v[116:119], a[92:95], v[64:79]
ds_read_b64_tr_b16 v[116:117], v128 offset:8192
ds_read_b64_tr_b16 v[118:119], v128 offset:9216
s_waitcnt lgkmcnt(8)
v_mfma_f32_32x32x16_bf16 v[48:63], v[120:123], v[0:3], v[48:63]
ds_read_b64_tr_b16 v[120:121], v129 offset:8192
ds_read_b64_tr_b16 v[122:123], v129 offset:9216
s_waitcnt lgkmcnt(8)
v_mfma_f32_32x32x16_bf16 v[64:79], v[124:127], v[0:3], v[64:79]
s_waitcnt vmcnt(8)
s_barrier
s_add_u32 m0, s48, 65536
s_add_u32 s53, s50, 4195072
buffer_load_dwordx4 v137, s[28:31], s53 offen offset:0 lds
buffer_load_dwordx4 v138, s[28:31], s53 offen offset:1024 lds
buffer_load_dwordx4 v139, s[28:31], s53 offen offset:2048 lds
buffer_load_dwordx4 v140, s[28:31], s53 offen offset:3072 lds
ds_read_b64_tr_b16 v[124:125], v128 offset:12288
ds_read_b64_tr_b16 v[126:127], v128 offset:13312
s_waitcnt lgkmcnt(8)
v_mfma_f32_32x32x16_bf16 v[48:63], v[152:155], v[4:7], v[48:63]
ds_read_b64_tr_b16 v[152:153], v129 offset:12288
ds_read_b64_tr_b16 v[154:155], v129 offset:13312
s_waitcnt lgkmcnt(8)
v_mfma_f32_32x32x16_bf16 v[64:79], v[112:115], v[4:7], v[64:79]
s_waitcnt vmcnt(8)
s_barrier
s_waitcnt vmcnt(4)
s_barrier
s_add_u32 m0, s48, 114688
s_add_u32 s53, s49, 131072
buffer_load_dwordx4 v132, s[20:23], s53 offen offset:0 nt lds
buffer_load_dwordx4 v133, s[20:23], s53 offen offset:1024 nt lds
buffer_load_dwordx4 v134, s[20:23], s53 offen offset:2048 nt lds
buffer_load_dwordx4 v135, s[20:23], s53 offen offset:3072 nt lds
s_waitcnt lgkmcnt(0)
s_waitcnt vmcnt(4)
s_barrier
s_add_u32 m0, s48, 0
s_add_u32 s53, s49, 147456
buffer_load_dwordx4 v132, s[20:23], s53 offen offset:0 nt lds
buffer_load_dwordx4 v133, s[20:23], s53 offen offset:1024 nt lds
buffer_load_dwordx4 v134, s[20:23], s53 offen offset:2048 nt lds
buffer_load_dwordx4 v135, s[20:23], s53 offen offset:3072 nt lds
s_waitcnt lgkmcnt(0)
s_barrier
s_add_u32 m0, s48, 16384
s_add_u32 s53, s54, 0
buffer_load_dwordx4 v141, s[64:67], s53 offen offset:0 lds
buffer_load_dwordx4 v142, s[64:67], s53 offen offset:1024 lds
buffer_load_dwordx4 v143, s[64:67], s53 offen offset:2048 lds
buffer_load_dwordx4 v144, s[64:67], s53 offen offset:3072 lds
s_waitcnt lgkmcnt(0)
s_barrier
v_add_u32 v128, 81920, v145
v_xor_b32 v129, 64, v128
ds_read_b64_tr_b16 v[112:113], v128 offset:0
ds_read_b64_tr_b16 v[114:115], v128 offset:1024
v_mfma_f32_32x32x16_bf16 v[48:63], v[116:119], v[8:11], v[48:63]
ds_read_b64_tr_b16 v[116:117], v129 offset:0
ds_read_b64_tr_b16 v[118:119], v129 offset:1024
v_mfma_f32_32x32x16_bf16 v[64:79], v[120:123], v[8:11], v[64:79]
ds_read_b64_tr_b16 v[120:121], v128 offset:4096
ds_read_b64_tr_b16 v[122:123], v128 offset:5120
v_mfma_f32_32x32x16_bf16 v[48:63], v[124:127], v[12:15], v[48:63]
ds_read_b64_tr_b16 v[124:125], v129 offset:4096
ds_read_b64_tr_b16 v[126:127], v129 offset:5120
v_mfma_f32_32x32x16_bf16 v[64:79], v[152:155], v[12:15], v[64:79]
ds_read_b64_tr_b16 v[152:153], v128 offset:8192
ds_read_b64_tr_b16 v[154:155], v128 offset:9216
s_waitcnt lgkmcnt(8)
v_mfma_f32_32x32x16_bf16 v[48:63], v[112:115], v[16:19], v[48:63]
ds_read_b64_tr_b16 v[112:113], v129 offset:8192
ds_read_b64_tr_b16 v[114:115], v129 offset:9216
s_waitcnt lgkmcnt(8)
v_mfma_f32_32x32x16_bf16 v[64:79], v[116:119], v[16:19], v[64:79]
ds_read_b64_tr_b16 v[116:117], v128 offset:12288
ds_read_b64_tr_b16 v[118:119], v128 offset:13312
s_waitcnt lgkmcnt(8)
v_mfma_f32_32x32x16_bf16 v[48:63], v[120:123], v[20:23], v[48:63]
ds_read_b64_tr_b16 v[120:121], v129 offset:12288
ds_read_b64_tr_b16 v[122:123], v129 offset:13312
s_waitcnt lgkmcnt(8)
v_mfma_f32_32x32x16_bf16 v[64:79], v[124:127], v[20:23], v[64:79]
v_add_u32 v128, 98304, v145
v_xor_b32 v129, 64, v128
ds_read_b64_tr_b16 v[124:125], v128 offset:0
ds_read_b64_tr_b16 v[126:127], v128 offset:1024
s_waitcnt lgkmcnt(8)
v_mfma_f32_32x32x16_bf16 v[48:63], v[152:155], v[24:27], v[48:63]
ds_read_b64_tr_b16 v[152:153], v129 offset:0
ds_read_b64_tr_b16 v[154:155], v129 offset:1024
s_waitcnt lgkmcnt(8)
v_mfma_f32_32x32x16_bf16 v[64:79], v[112:115], v[24:27], v[64:79]
ds_read_b64_tr_b16 v[112:113], v128 offset:4096
ds_read_b64_tr_b16 v[114:115], v128 offset:5120
s_waitcnt lgkmcnt(8)
v_mfma_f32_32x32x16_bf16 v[48:63], v[116:119], v[28:31], v[48:63]
ds_read_b64_tr_b16 v[116:117], v129 offset:4096
ds_read_b64_tr_b16 v[118:119], v129 offset:5120
s_waitcnt lgkmcnt(8)
v_mfma_f32_32x32x16_bf16 v[64:79], v[120:123], v[28:31], v[64:79]
ds_read_b64_tr_b16 v[120:121], v128 offset:8192
ds_read_b64_tr_b16 v[122:123], v128 offset:9216
s_waitcnt lgkmcnt(8)
v_mfma_f32_32x32x16_bf16 v[48:63], v[124:127], v[32:35], v[48:63]
ds_read_b64_tr_b16 v[124:125], v129 offset:8192
ds_read_b64_tr_b16 v[126:127], v129 offset:9216
s_waitcnt lgkmcnt(8)
v_mfma_f32_32x32x16_bf16 v[64:79], v[152:155], v[32:35], v[64:79]
s_waitcnt vmcnt(8)
s_barrier
s_add_u32 m0, s48, 32768
s_add_u32 s53, s49, 163840
buffer_load_dwordx4 v132, s[20:23], s53 offen offset:0 nt lds
buffer_load_dwordx4 v133, s[20:23], s53 offen offset:1024 nt lds
buffer_load_dwordx4 v134, s[20:23], s53 offen offset:2048 nt lds
buffer_load_dwordx4 v135, s[20:23], s53 offen offset:3072 nt lds
ds_read_b64_tr_b16 v[152:153], v128 offset:12288
ds_read_b64_tr_b16 v[154:155], v128 offset:13312
s_waitcnt lgkmcnt(8)
v_mfma_f32_32x32x16_bf16 v[48:63], v[112:115], v[36:39], v[48:63]
ds_read_b64_tr_b16 v[112:113], v129 offset:12288
ds_read_b64_tr_b16 v[114:115], v129 offset:13312
s_waitcnt lgkmcnt(8)
v_mfma_f32_32x32x16_bf16 v[64:79], v[116:119], v[36:39], v[64:79]
s_waitcnt lgkmcnt(6)
v_mfma_f32_32x32x16_bf16 v[48:63], v[120:123], v[40:43], v[48:63]
s_waitcnt lgkmcnt(4)
v_mfma_f32_32x32x16_bf16 v[64:79], v[124:127], v[40:43], v[64:79]
s_waitcnt lgkmcnt(2)
v_mfma_f32_32x32x16_bf16 v[48:63], v[152:155], v[44:47], v[48:63]
s_waitcnt lgkmcnt(0)
v_mfma_f32_32x32x16_bf16 v[64:79], v[112:115], v[44:47], v[64:79]
s_nop 11
v_cvt_pk_bf16_f32 v80, v48, v49
v_cvt_pk_bf16_f32 v81, v50, v51
v_cvt_pk_bf16_f32 v82, v52, v53
v_cvt_pk_bf16_f32 v83, v54, v55
v_cvt_pk_bf16_f32 v84, v56, v57
v_cvt_pk_bf16_f32 v85, v58, v59
v_cvt_pk_bf16_f32 v86, v60, v61
v_cvt_pk_bf16_f32 v87, v62, v63
v_cvt_pk_bf16_f32 v88, v64, v65
v_cvt_pk_bf16_f32 v89, v66, v67
v_cvt_pk_bf16_f32 v90, v68, v69
v_cvt_pk_bf16_f32 v91, v70, v71
v_cvt_pk_bf16_f32 v92, v72, v73
v_cvt_pk_bf16_f32 v93, v74, v75
v_cvt_pk_bf16_f32 v94, v76, v77
v_cvt_pk_bf16_f32 v95, v78, v79
v_add_u32 v148, s51, v147
ds_read_b128 v[48:51], v148 offset:16384
ds_read_b128 v[52:55], v148 offset:17408
ds_read_b128 v[56:59], v148 offset:18432
ds_read_b128 v[60:63], v148 offset:19456
ds_read_b128 v[64:67], v148 offset:20480
ds_read_b128 v[68:71], v148 offset:21504
ds_read_b128 v[72:75], v148 offset:22528
ds_read_b128 v[76:79], v148 offset:23552
s_waitcnt lgkmcnt(0)
s_waitcnt vmcnt(8)
s_barrier
s_add_u32 m0, s48, 49152
s_add_u32 s53, s49, 180224
buffer_load_dwordx4 v132, s[20:23], s53 offen offset:0 nt lds
buffer_load_dwordx4 v133, s[20:23], s53 offen offset:1024 nt lds
buffer_load_dwordx4 v134, s[20:23], s53 offen offset:2048 nt lds
buffer_load_dwordx4 v135, s[20:23], s53 offen offset:3072 nt lds
s_waitcnt vmcnt(8)
s_barrier
s_add_u32 m0, s48, 65536
s_add_u32 s53, s54, 128
buffer_load_dwordx4 v141, s[64:67], s53 offen offset:0 lds
buffer_load_dwordx4 v142, s[64:67], s53 offen offset:1024 lds
buffer_load_dwordx4 v143, s[64:67], s53 offen offset:2048 lds
buffer_load_dwordx4 v144, s[64:67], s53 offen offset:3072 lds
v_add_u32 v128, 49152, v146
ds_read_b64_tr_b16 v[112:113], v128 offset:0
ds_read_b64_tr_b16 v[114:115], v128 offset:1024
ds_read_b64_tr_b16 v[116:117], v128 offset:2048
ds_read_b64_tr_b16 v[118:119], v128 offset:3072
ds_read_b64_tr_b16 v[120:121], v128 offset:4096
ds_read_b64_tr_b16 v[122:123], v128 offset:5120
ds_read_b64_tr_b16 v[124:125], v128 offset:6144
ds_read_b64_tr_b16 v[126:127], v128 offset:7168
ds_read_b64_tr_b16 v[152:153], v128 offset:8192
ds_read_b64_tr_b16 v[154:155], v128 offset:9216
s_waitcnt lgkmcnt(8)
v_mfma_f32_32x32x16_bf16 a[0:15], v[112:115], v[48:51], 0
ds_read_b64_tr_b16 v[112:113], v128 offset:10240
ds_read_b64_tr_b16 v[114:115], v128 offset:11264
s_waitcnt lgkmcnt(8)
v_mfma_f32_32x32x16_bf16 a[0:15], v[116:119], v[52:55], a[0:15]
ds_read_b64_tr_b16 v[116:117], v128 offset:12288
ds_read_b64_tr_b16 v[118:119], v128 offset:13312
s_waitcnt lgkmcnt(8)
v_mfma_f32_32x32x16_bf16 a[0:15], v[120:123], v[56:59], a[0:15]
ds_read_b64_tr_b16 v[120:121], v128 offset:14336
ds_read_b64_tr_b16 v[122:123], v128 offset:15360
s_waitcnt lgkmcnt(8)
v_mfma_f32_32x32x16_bf16 a[0:15], v[124:127], v[60:63], a[0:15]
s_waitcnt vmcnt(8)
s_barrier
s_add_u32 m0, s48, 81920
s_add_u32 s53, s49, 196608
buffer_load_dwordx4 v132, s[20:23], s53 offen offset:0 nt lds
buffer_load_dwordx4 v133, s[20:23], s53 offen offset:1024 nt lds
buffer_load_dwordx4 v134, s[20:23], s53 offen offset:2048 nt lds
buffer_load_dwordx4 v135, s[20:23], s53 offen offset:3072 nt lds
s_waitcnt vmcnt(8)
s_barrier
s_add_u32 m0, s48, 98304
s_add_u32 s53, s49, 212992
buffer_load_dwordx4 v132, s[20:23], s53 offen offset:0 nt lds
buffer_load_dwordx4 v133, s[20:23], s53 offen offset:1024 nt lds
buffer_load_dwordx4 v134, s[20:23], s53 offen offset:2048 nt lds
buffer_load_dwordx4 v135, s[20:23], s53 offen offset:3072 nt lds
s_waitcnt vmcnt(8)
s_barrier
s_add_u32 m0, s48, 114688
s_add_u32 s53, s54, 256
buffer_load_dwordx4 v141, s[64:67], s53 offen offset:0 lds
buffer_load_dwordx4 v142, s[64:67], s53 offen offset:1024 lds
buffer_load_dwordx4 v143, s[64:67], s53 offen offset:2048 lds
buffer_load_dwordx4 v144, s[64:67], s53 offen offset:3072 lds
v_add_u32 v128, 98304, v146
ds_read_b64_tr_b16 v[124:125], v128 offset:0
ds_read_b64_tr_b16 v[126:127], v128 offset:1024
s_waitcnt lgkmcnt(8)
v_mfma_f32_32x32x16_bf16 a[0:15], v[152:155], v[64:67], a[0:15]
ds_read_b64_tr_b16 v[152:153], v128 offset:2048
ds_read_b64_tr_b16 v[154:155], v128 offset:3072
s_waitcnt lgkmcnt(8)
v_mfma_f32_32x32x16_bf16 a[0:15], v[112:115], v[68:71], a[0:15]
ds_read_b64_tr_b16 v[112:113], v128 offset:4096
ds_read_b64_tr_b16 v[114:115], v128 offset:5120
s_waitcnt lgkmcnt(8)
v_mfma_f32_32x32x16_bf16 a[0:15], v[116:119], v[72:75], a[0:15]
ds_read_b64_tr_b16 v[116:117], v128 offset:6144
ds_read_b64_tr_b16 v[118:119], v128 offset:7168
s_waitcnt lgkmcnt(8)
v_mfma_f32_32x32x16_bf16 a[0:15], v[120:123], v[76:79], a[0:15]
ds_read_b64_tr_b16 v[120:121], v128 offset:8192
ds_read_b64_tr_b16 v[122:123], v128 offset:9216
s_waitcnt lgkmcnt(8)
v_mfma_f32_32x32x16_bf16 a[16:31], v[124:127], v[48:51], 0
ds_read_b64_tr_b16 v[124:125], v128 offset:10240
ds_read_b64_tr_b16 v[126:127], v128 offset:11264
s_waitcnt lgkmcnt(8)
v_mfma_f32_32x32x16_bf16 a[16:31], v[152:155], v[52:55], a[16:31]
ds_read_b64_tr_b16 v[152:153], v128 offset:12288
ds_read_b64_tr_b16 v[154:155], v128 offset:13312
s_waitcnt lgkmcnt(8)
v_mfma_f32_32x32x16_bf16 a[16:31], v[112:115], v[56:59], a[16:31]
ds_read_b64_tr_b16 v[112:113], v128 offset:14336
ds_read_b64_tr_b16 v[114:115], v128 offset:15360
s_waitcnt lgkmcnt(8)
v_mfma_f32_32x32x16_bf16 a[16:31], v[116:119], v[60:63], a[16:31]
s_waitcnt vmcnt(8)
s_barrier
s_add_u32 m0, s48, 0
s_add_u32 s53, s49, 229376
buffer_load_dwordx4 v132, s[20:23], s53 offen offset:0 nt lds
buffer_load_dwordx4 v133, s[20:23], s53 offen offset:1024 nt lds
buffer_load_dwordx4 v134, s[20:23], s53 offen offset:2048 nt lds
buffer_load_dwordx4 v135, s[20:23], s53 offen offset:3072 nt lds
s_waitcnt vmcnt(8)
s_barrier
s_add_u32 m0, s48, 16384
s_add_u32 s53, s49, 245760
buffer_load_dwordx4 v132, s[20:23], s53 offen offset:0 nt lds
buffer_load_dwordx4 v133, s[20:23], s53 offen offset:1024 nt lds
buffer_load_dwordx4 v134, s[20:23], s53 offen offset:2048 nt lds
buffer_load_dwordx4 v135, s[20:23], s53 offen offset:3072 nt lds
s_waitcnt vmcnt(8)
s_barrier
s_add_u32 m0, s48, 32768
s_add_u32 s53, s54, 384
buffer_load_dwordx4 v141, s[64:67], s53 offen offset:0 lds
buffer_load_dwordx4 v142, s[64:67], s53 offen offset:1024 lds
buffer_load_dwordx4 v143, s[64:67], s53 offen offset:2048 lds
buffer_load_dwordx4 v144, s[64:67], s53 offen offset:3072 lds
v_add_u32 v128, 147456, v146
ds_read_b64_tr_b16 v[116:117], v128 offset:0
ds_read_b64_tr_b16 v[118:119], v128 offset:1024
s_waitcnt lgkmcnt(8)
v_mfma_f32_32x32x16_bf16 a[16:31], v[120:123], v[64:67], a[16:31]
ds_read_b64_tr_b16 v[120:121], v128 offset:2048
ds_read_b64_tr_b16 v[122:123], v128 offset:3072
s_waitcnt lgkmcnt(8)
v_mfma_f32_32x32x16_bf16 a[16:31], v[124:127], v[68:71], a[16:31]
ds_read_b64_tr_b16 v[124:125], v128 offset:4096
ds_read_b64_tr_b16 v[126:127], v128 offset:5120
s_waitcnt lgkmcnt(8)
v_mfma_f32_32x32x16_bf16 a[16:31], v[152:155], v[72:75], a[16:31]
ds_read_b64_tr_b16 v[152:153], v128 offset:6144
ds_read_b64_tr_b16 v[154:155], v128 offset:7168
s_waitcnt lgkmcnt(8)
v_mfma_f32_32x32x16_bf16 a[16:31], v[112:115], v[76:79], a[16:31]
ds_read_b64_tr_b16 v[112:113], v128 offset:8192
ds_read_b64_tr_b16 v[114:115], v128 offset:9216
s_waitcnt lgkmcnt(8)
v_mfma_f32_32x32x16_bf16 a[32:47], v[116:119], v[48:51], 0
ds_read_b64_tr_b16 v[116:117], v128 offset:10240
ds_read_b64_tr_b16 v[118:119], v128 offset:11264
s_waitcnt lgkmcnt(8)
v_mfma_f32_32x32x16_bf16 a[32:47], v[120:123], v[52:55], a[32:47]
ds_read_b64_tr_b16 v[120:121], v128 offset:12288
ds_read_b64_tr_b16 v[122:123], v128 offset:13312
s_waitcnt lgkmcnt(8)
v_mfma_f32_32x32x16_bf16 a[32:47], v[124:127], v[56:59], a[32:47]
ds_read_b64_tr_b16 v[124:125], v128 offset:14336
ds_read_b64_tr_b16 v[126:127], v128 offset:15360
s_waitcnt lgkmcnt(8)
v_mfma_f32_32x32x16_bf16 a[32:47], v[152:155], v[60:63], a[32:47]
s_waitcnt vmcnt(8)
s_barrier
s_add_u32 m0, s48, 49152
s_add_u32 s53, s54, 512
buffer_load_dwordx4 v141, s[64:67], s53 offen offset:0 lds
buffer_load_dwordx4 v142, s[64:67], s53 offen offset:1024 lds
buffer_load_dwordx4 v143, s[64:67], s53 offen offset:2048 lds
buffer_load_dwordx4 v144, s[64:67], s53 offen offset:3072 lds
s_waitcnt vmcnt(8)
s_barrier
s_add_u32 m0, s48, 65536
s_add_u32 s53, s49, 131072
buffer_load_dwordx4 v136, s[24:27], s53 offen offset:0 nt lds
buffer_load_dwordx4 v136, s[24:27], s53 offen offset:1024 nt lds
buffer_load_dwordx4 v136, s[24:27], s53 offen offset:2048 nt lds
buffer_load_dwordx4 v136, s[24:27], s53 offen offset:3072 nt lds
s_waitcnt vmcnt(8)
s_barrier
s_add_u32 m0, s48, 81920
s_add_u32 s53, s49, 147456
buffer_load_dwordx4 v136, s[24:27], s53 offen offset:0 nt lds
buffer_load_dwordx4 v136, s[24:27], s53 offen offset:1024 nt lds
buffer_load_dwordx4 v136, s[24:27], s53 offen offset:2048 nt lds
buffer_load_dwordx4 v136, s[24:27], s53 offen offset:3072 nt lds
s_waitcnt lgkmcnt(0)
s_waitcnt vmcnt(8)
s_barrier
s_add_u32 m0, s48, 98304
s_add_u32 s53, s54, 640
buffer_load_dwordx4 v141, s[64:67], s53 offen offset:0 lds
buffer_load_dwordx4 v142, s[64:67], s53 offen offset:1024 lds
buffer_load_dwordx4 v143, s[64:67], s53 offen offset:2048 lds
buffer_load_dwordx4 v144, s[64:67], s53 offen offset:3072 lds
v_add_u32 v128, 65536, v146
ds_read_b64_tr_b16 v[152:153], v128 offset:0
ds_read_b64_tr_b16 v[154:155], v128 offset:1024
v_mfma_f32_32x32x16_bf16 a[32:47], v[112:115], v[64:67], a[32:47]
ds_read_b64_tr_b16 v[112:113], v128 offset:2048
ds_read_b64_tr_b16 v[114:115], v128 offset:3072
v_mfma_f32_32x32x16_bf16 a[32:47], v[116:119], v[68:71], a[32:47]
ds_read_b64_tr_b16 v[116:117], v128 offset:4096
ds_read_b64_tr_b16 v[118:119], v128 offset:5120
v_mfma_f32_32x32x16_bf16 a[32:47], v[120:123], v[72:75], a[32:47]
ds_read_b64_tr_b16 v[120:121], v128 offset:6144
ds_read_b64_tr_b16 v[122:123], v128 offset:7168
v_mfma_f32_32x32x16_bf16 a[32:47], v[124:127], v[76:79], a[32:47]
ds_read_b64_tr_b16 v[124:125], v128 offset:8192
ds_read_b64_tr_b16 v[126:127], v128 offset:9216
s_waitcnt lgkmcnt(8)
v_mfma_f32_32x32x16_bf16 a[48:63], v[152:155], v[48:51], 0
ds_read_b64_tr_b16 v[152:153], v128 offset:10240
ds_read_b64_tr_b16 v[154:155], v128 offset:11264
s_waitcnt lgkmcnt(8)
v_mfma_f32_32x32x16_bf16 a[48:63], v[112:115], v[52:55], a[48:63]
ds_read_b64_tr_b16 v[112:113], v128 offset:12288
ds_read_b64_tr_b16 v[114:115], v128 offset:13312
s_waitcnt lgkmcnt(8)
v_mfma_f32_32x32x16_bf16 a[48:63], v[116:119], v[56:59], a[48:63]
ds_read_b64_tr_b16 v[116:117], v128 offset:14336
ds_read_b64_tr_b16 v[118:119], v128 offset:15360
s_waitcnt lgkmcnt(8)
v_mfma_f32_32x32x16_bf16 a[48:63], v[120:123], v[60:63], a[48:63]
v_add_u32 v128, 81920, v146
ds_read_b64_tr_b16 v[120:121], v128 offset:0
ds_read_b64_tr_b16 v[122:123], v128 offset:1024
s_waitcnt lgkmcnt(8)
v_mfma_f32_32x32x16_bf16 a[48:63], v[124:127], v[64:67], a[48:63]
ds_read_b64_tr_b16 v[124:125], v128 offset:2048
ds_read_b64_tr_b16 v[126:127], v128 offset:3072
s_waitcnt lgkmcnt(8)
v_mfma_f32_32x32x16_bf16 a[48:63], v[152:155], v[68:71], a[48:63]
ds_read_b64_tr_b16 v[152:153], v128 offset:4096
ds_read_b64_tr_b16 v[154:155], v128 offset:5120
s_waitcnt lgkmcnt(8)
v_mfma_f32_32x32x16_bf16 a[48:63], v[112:115], v[72:75], a[48:63]
ds_read_b64_tr_b16 v[112:113], v128 offset:6144
ds_read_b64_tr_b16 v[114:115], v128 offset:7168
s_waitcnt lgkmcnt(8)
v_mfma_f32_32x32x16_bf16 a[48:63], v[116:119], v[76:79], a[48:63]
ds_read_b64_tr_b16 v[116:117], v128 offset:8192
ds_read_b64_tr_b16 v[118:119], v128 offset:9216
s_waitcnt lgkmcnt(8)
v_mfma_f32_32x32x16_bf16 a[64:79], v[120:123], v[48:51], 0
ds_read_b64_tr_b16 v[120:121], v128 offset:10240
ds_read_b64_tr_b16 v[122:123], v128 offset:11264
s_waitcnt lgkmcnt(8)
v_mfma_f32_32x32x16_bf16 a[64:79], v[124:127], v[52:55], a[64:79]
ds_read_b64_tr_b16 v[124:125], v128 offset:12288
ds_read_b64_tr_b16 v[126:127], v128 offset:13312
s_waitcnt lgkmcnt(8)
v_mfma_f32_32x32x16_bf16 a[64:79], v[152:155], v[56:59], a[64:79]
s_waitcnt vmcnt(8)
s_barrier
s_add_u32 m0, s48, 114688
s_add_u32 s53, s49, 163840
buffer_load_dwordx4 v136, s[24:27], s53 offen offset:0 nt lds
buffer_load_dwordx4 v136, s[24:27], s53 offen offset:1024 nt lds
buffer_load_dwordx4 v136, s[24:27], s53 offen offset:2048 nt lds
buffer_load_dwordx4 v136, s[24:27], s53 offen offset:3072 nt lds
ds_read_b64_tr_b16 v[152:153], v128 offset:14336
ds_read_b64_tr_b16 v[154:155], v128 offset:15360
s_waitcnt lgkmcnt(8)
v_mfma_f32_32x32x16_bf16 a[64:79], v[112:115], v[60:63], a[64:79]
s_waitcnt lgkmcnt(6)
v_mfma_f32_32x32x16_bf16 a[64:79], v[116:119], v[64:67], a[64:79]
s_waitcnt lgkmcnt(4)
v_mfma_f32_32x32x16_bf16 a[64:79], v[120:123], v[68:71], a[64:79]
s_waitcnt lgkmcnt(2)
v_mfma_f32_32x32x16_bf16 a[64:79], v[124:127], v[72:75], a[64:79]
s_waitcnt lgkmcnt(0)
v_mfma_f32_32x32x16_bf16 a[64:79], v[152:155], v[76:79], a[64:79]
s_waitcnt vmcnt(8)
s_barrier
s_add_u32 m0, s48, 0
s_add_u32 s53, s49, 180224
buffer_load_dwordx4 v136, s[24:27], s53 offen offset:0 nt lds
buffer_load_dwordx4 v136, s[24:27], s53 offen offset:1024 nt lds
buffer_load_dwordx4 v136, s[24:27], s53 offen offset:2048 nt lds
buffer_load_dwordx4 v136, s[24:27], s53 offen offset:3072 nt lds
v_add_u32 v148, s52, v147
ds_write_b128 v148, v[96:99] offset:0
ds_write_b128 v148, v[100:103] offset:1024
ds_write_b128 v148, v[104:107] offset:2048
ds_write_b128 v148, v[108:111] offset:3072
s_waitcnt lgkmcnt(0)
s_waitcnt vmcnt(8)
s_barrier
s_add_u32 m0, s48, 16384
s_add_u32 s53, s54, 768
buffer_load_dwordx4 v141, s[64:67], s53 offen offset:0 lds
buffer_load_dwordx4 v142, s[64:67], s53 offen offset:1024 lds
buffer_load_dwordx4 v143, s[64:67], s53 offen offset:2048 lds
buffer_load_dwordx4 v144, s[64:67], s53 offen offset:3072 lds
v_add_u32 v128, 131072, v146
ds_read_b64_tr_b16 v[112:113], v128 offset:0
ds_read_b64_tr_b16 v[114:115], v128 offset:1024
ds_read_b64_tr_b16 v[116:117], v128 offset:2048
ds_read_b64_tr_b16 v[118:119], v128 offset:3072
ds_read_b64_tr_b16 v[120:121], v128 offset:4096
ds_read_b64_tr_b16 v[122:123], v128 offset:5120
ds_read_b64_tr_b16 v[124:125], v128 offset:6144
ds_read_b64_tr_b16 v[126:127], v128 offset:7168
ds_read_b64_tr_b16 v[152:153], v128 offset:8192
ds_read_b64_tr_b16 v[154:155], v128 offset:9216
s_waitcnt lgkmcnt(8)
v_mfma_f32_32x32x16_bf16 a[80:95], v[112:115], v[48:51], 0
ds_read_b64_tr_b16 v[112:113], v128 offset:10240
ds_read_b64_tr_b16 v[114:115], v128 offset:11264
s_waitcnt lgkmcnt(8)
v_mfma_f32_32x32x16_bf16 a[80:95], v[116:119], v[52:55], a[80:95]
ds_read_b64_tr_b16 v[116:117], v128 offset:12288
ds_read_b64_tr_b16 v[118:119], v128 offset:13312
s_waitcnt lgkmcnt(8)
v_mfma_f32_32x32x16_bf16 a[80:95], v[120:123], v[56:59], a[80:95]
ds_read_b64_tr_b16 v[120:121], v128 offset:14336
ds_read_b64_tr_b16 v[122:123], v128 offset:15360
s_waitcnt lgkmcnt(8)
v_mfma_f32_32x32x16_bf16 a[80:95], v[124:127], v[60:63], a[80:95]
s_waitcnt vmcnt(8)
s_barrier
s_add_u32 m0, s48, 32768
s_add_u32 s53, s49, 196608
buffer_load_dwordx4 v136, s[24:27], s53 offen offset:0 nt lds
buffer_load_dwordx4 v136, s[24:27], s53 offen offset:1024 nt lds
buffer_load_dwordx4 v136, s[24:27], s53 offen offset:2048 nt lds
buffer_load_dwordx4 v136, s[24:27], s53 offen offset:3072 nt lds
s_waitcnt vmcnt(8)
s_barrier
s_add_u32 m0, s48, 49152
s_add_u32 s53, s49, 212992
buffer_load_dwordx4 v136, s[24:27], s53 offen offset:0 nt lds
buffer_load_dwordx4 v136, s[24:27], s53 offen offset:1024 nt lds
buffer_load_dwordx4 v136, s[24:27], s53 offen offset:2048 nt lds
buffer_load_dwordx4 v136, s[24:27], s53 offen offset:3072 nt lds
s_waitcnt vmcnt(8)
s_barrier
s_add_u32 m0, s48, 65536
s_add_u32 s53, s54, 896
buffer_load_dwordx4 v141, s[64:67], s53 offen offset:0 lds
buffer_load_dwordx4 v142, s[64:67], s53 offen offset:1024 lds
buffer_load_dwordx4 v143, s[64:67], s53 offen offset:2048 lds
buffer_load_dwordx4 v144, s[64:67], s53 offen offset:3072 lds
v_add_u32 v128, 49152, v146
ds_read_b64_tr_b16 v[124:125], v128 offset:0
ds_read_b64_tr_b16 v[126:127], v128 offset:1024
s_waitcnt lgkmcnt(8)
v_mfma_f32_32x32x16_bf16 a[80:95], v[152:155], v[64:67], a[80:95]
ds_read_b64_tr_b16 v[152:153], v128 offset:2048
ds_read_b64_tr_b16 v[154:155], v128 offset:3072
s_waitcnt lgkmcnt(8)
v_mfma_f32_32x32x16_bf16 a[80:95], v[112:115], v[68:71], a[80:95]
ds_read_b64_tr_b16 v[112:113], v128 offset:4096
ds_read_b64_tr_b16 v[114:115], v128 offset:5120
s_waitcnt lgkmcnt(8)
v_mfma_f32_32x32x16_bf16 a[80:95], v[116:119], v[72:75], a[80:95]
ds_read_b64_tr_b16 v[116:117], v128 offset:6144
ds_read_b64_tr_b16 v[118:119], v128 offset:7168
s_waitcnt lgkmcnt(8)
v_mfma_f32_32x32x16_bf16 a[80:95], v[120:123], v[76:79], a[80:95]
ds_read_b64_tr_b16 v[120:121], v128 offset:8192
ds_read_b64_tr_b16 v[122:123], v128 offset:9216
s_waitcnt lgkmcnt(8)
v_mfma_f32_32x32x16_bf16 v[0:15], v[124:127], v[48:51], 0
ds_read_b64_tr_b16 v[124:125], v128 offset:10240
ds_read_b64_tr_b16 v[126:127], v128 offset:11264
s_waitcnt lgkmcnt(8)
v_mfma_f32_32x32x16_bf16 v[0:15], v[152:155], v[52:55], v[0:15]
ds_read_b64_tr_b16 v[152:153], v128 offset:12288
ds_read_b64_tr_b16 v[154:155], v128 offset:13312
s_waitcnt lgkmcnt(8)
v_mfma_f32_32x32x16_bf16 v[0:15], v[112:115], v[56:59], v[0:15]
ds_read_b64_tr_b16 v[112:113], v128 offset:14336
ds_read_b64_tr_b16 v[114:115], v128 offset:15360
s_waitcnt lgkmcnt(8)
v_mfma_f32_32x32x16_bf16 v[0:15], v[116:119], v[60:63], v[0:15]
s_waitcnt vmcnt(8)
s_barrier
s_add_u32 m0, s48, 81920
s_add_u32 s53, s49, 229376
buffer_load_dwordx4 v136, s[24:27], s53 offen offset:0 nt lds
buffer_load_dwordx4 v136, s[24:27], s53 offen offset:1024 nt lds
buffer_load_dwordx4 v136, s[24:27], s53 offen offset:2048 nt lds
buffer_load_dwordx4 v136, s[24:27], s53 offen offset:3072 nt lds
s_waitcnt vmcnt(8)
s_barrier
s_add_u32 m0, s48, 98304
s_add_u32 s53, s49, 245760
buffer_load_dwordx4 v136, s[24:27], s53 offen offset:0 nt lds
buffer_load_dwordx4 v136, s[24:27], s53 offen offset:1024 nt lds
buffer_load_dwordx4 v136, s[24:27], s53 offen offset:2048 nt lds
buffer_load_dwordx4 v136, s[24:27], s53 offen offset:3072 nt lds
s_waitcnt vmcnt(8)
s_barrier
s_add_u32 m0, s48, 114688
s_add_u32 s53, s54, 1024
buffer_load_dwordx4 v141, s[64:67], s53 offen offset:0 lds
buffer_load_dwordx4 v142, s[64:67], s53 offen offset:1024 lds
buffer_load_dwordx4 v143, s[64:67], s53 offen offset:2048 lds
buffer_load_dwordx4 v144, s[64:67], s53 offen offset:3072 lds
v_add_u32 v128, 98304, v146
ds_read_b64_tr_b16 v[116:117], v128 offset:0
ds_read_b64_tr_b16 v[118:119], v128 offset:1024
s_waitcnt lgkmcnt(8)
v_mfma_f32_32x32x16_bf16 v[0:15], v[120:123], v[64:67], v[0:15]
ds_read_b64_tr_b16 v[120:121], v128 offset:2048
ds_read_b64_tr_b16 v[122:123], v128 offset:3072
s_waitcnt lgkmcnt(8)
v_mfma_f32_32x32x16_bf16 v[0:15], v[124:127], v[68:71], v[0:15]
ds_read_b64_tr_b16 v[124:125], v128 offset:4096
ds_read_b64_tr_b16 v[126:127], v128 offset:5120
s_waitcnt lgkmcnt(8)
v_mfma_f32_32x32x16_bf16 v[0:15], v[152:155], v[72:75], v[0:15]
ds_read_b64_tr_b16 v[152:153], v128 offset:6144
ds_read_b64_tr_b16 v[154:155], v128 offset:7168
s_waitcnt lgkmcnt(8)
v_mfma_f32_32x32x16_bf16 v[0:15], v[112:115], v[76:79], v[0:15]
ds_read_b64_tr_b16 v[112:113], v128 offset:8192
ds_read_b64_tr_b16 v[114:115], v128 offset:9216
s_waitcnt lgkmcnt(8)
v_mfma_f32_32x32x16_bf16 v[16:31], v[116:119], v[48:51], 0
ds_read_b64_tr_b16 v[116:117], v128 offset:10240
ds_read_b64_tr_b16 v[118:119], v128 offset:11264
s_waitcnt lgkmcnt(8)
v_mfma_f32_32x32x16_bf16 v[16:31], v[120:123], v[52:55], v[16:31]
ds_read_b64_tr_b16 v[120:121], v128 offset:12288
ds_read_b64_tr_b16 v[122:123], v128 offset:13312
s_waitcnt lgkmcnt(8)
v_mfma_f32_32x32x16_bf16 v[16:31], v[124:127], v[56:59], v[16:31]
ds_read_b64_tr_b16 v[124:125], v128 offset:14336
ds_read_b64_tr_b16 v[126:127], v128 offset:15360
s_waitcnt lgkmcnt(8)
v_mfma_f32_32x32x16_bf16 v[16:31], v[152:155], v[60:63], v[16:31]
s_waitcnt vmcnt(8)
s_barrier
s_waitcnt vmcnt(4)
s_barrier
s_add_u32 m0, s48, 32768
s_add_u32 s53, s49, 262144
buffer_load_dwordx4 v132, s[20:23], s53 offen offset:0 nt lds
buffer_load_dwordx4 v133, s[20:23], s53 offen offset:1024 nt lds
buffer_load_dwordx4 v134, s[20:23], s53 offen offset:2048 nt lds
buffer_load_dwordx4 v135, s[20:23], s53 offen offset:3072 nt lds
s_waitcnt vmcnt(4)
s_barrier
s_add_u32 m0, s48, 49152
s_add_u32 s53, s49, 278528
buffer_load_dwordx4 v132, s[20:23], s53 offen offset:0 nt lds
buffer_load_dwordx4 v133, s[20:23], s53 offen offset:1024 nt lds
buffer_load_dwordx4 v134, s[20:23], s53 offen offset:2048 nt lds
buffer_load_dwordx4 v135, s[20:23], s53 offen offset:3072 nt lds
s_add_u32 s53, s54, 147456
buffer_load_dword v159, v157, s[64:67], s53 offen
s_waitcnt lgkmcnt(0)
s_barrier
s_add_u32 m0, s48, 65536
s_add_u32 s53, s54, 147456
buffer_load_dwordx4 v141, s[64:67], s53 offen offset:0 lds
buffer_load_dwordx4 v142, s[64:67], s53 offen offset:1024 lds
buffer_load_dwordx4 v143, s[64:67], s53 offen offset:2048 lds
buffer_load_dwordx4 v144, s[64:67], s53 offen offset:3072 lds
s_waitcnt lgkmcnt(0)
s_barrier
v_add_u32 v128, 147456, v146
ds_read_b64_tr_b16 v[152:153], v128 offset:0
ds_read_b64_tr_b16 v[154:155], v128 offset:1024
v_mfma_f32_32x32x16_bf16 v[16:31], v[112:115], v[64:67], v[16:31]
ds_read_b64_tr_b16 v[112:113], v128 offset:2048
ds_read_b64_tr_b16 v[114:115], v128 offset:3072
v_mfma_f32_32x32x16_bf16 v[16:31], v[116:119], v[68:71], v[16:31]
ds_read_b64_tr_b16 v[116:117], v128 offset:4096
ds_read_b64_tr_b16 v[118:119], v128 offset:5120
v_mfma_f32_32x32x16_bf16 v[16:31], v[120:123], v[72:75], v[16:31]
ds_read_b64_tr_b16 v[120:121], v128 offset:6144
ds_read_b64_tr_b16 v[122:123], v128 offset:7168
v_mfma_f32_32x32x16_bf16 v[16:31], v[124:127], v[76:79], v[16:31]
ds_read_b64_tr_b16 v[124:125], v128 offset:8192
ds_read_b64_tr_b16 v[126:127], v128 offset:9216
s_waitcnt lgkmcnt(8)
v_mfma_f32_32x32x16_bf16 v[32:47], v[152:155], v[48:51], 0
ds_read_b64_tr_b16 v[152:153], v128 offset:10240
ds_read_b64_tr_b16 v[154:155], v128 offset:11264
s_waitcnt lgkmcnt(8)
v_mfma_f32_32x32x16_bf16 v[32:47], v[112:115], v[52:55], v[32:47]
ds_read_b64_tr_b16 v[112:113], v128 offset:12288
ds_read_b64_tr_b16 v[114:115], v128 offset:13312
s_waitcnt lgkmcnt(8)
v_mfma_f32_32x32x16_bf16 v[32:47], v[116:119], v[56:59], v[32:47]
ds_read_b64_tr_b16 v[116:117], v128 offset:14336
ds_read_b64_tr_b16 v[118:119], v128 offset:15360
s_waitcnt lgkmcnt(8)
v_mfma_f32_32x32x16_bf16 v[32:47], v[120:123], v[60:63], v[32:47]
s_waitcnt lgkmcnt(6)
v_mfma_f32_32x32x16_bf16 v[32:47], v[124:127], v[64:67], v[32:47]
s_waitcnt lgkmcnt(4)
v_mfma_f32_32x32x16_bf16 v[32:47], v[152:155], v[68:71], v[32:47]
s_waitcnt lgkmcnt(2)
v_mfma_f32_32x32x16_bf16 v[32:47], v[112:115], v[72:75], v[32:47]
s_waitcnt lgkmcnt(0)
v_mfma_f32_32x32x16_bf16 v[32:47], v[116:119], v[76:79], v[32:47]
s_waitcnt vmcnt(9)
s_barrier
s_add_u32 m0, s48, 81920
s_add_u32 s53, s49, 294912
buffer_load_dwordx4 v132, s[20:23], s53 offen offset:0 nt lds
buffer_load_dwordx4 v133, s[20:23], s53 offen offset:1024 nt lds
buffer_load_dwordx4 v134, s[20:23], s53 offen offset:2048 nt lds
buffer_load_dwordx4 v135, s[20:23], s53 offen offset:3072 nt lds
v_add_u32 v148, s51, v147
ds_read_b128 v[48:51], v148 offset:16384
ds_read_b128 v[52:55], v148 offset:17408
ds_read_b128 v[56:59], v148 offset:18432
ds_read_b128 v[60:63], v148 offset:19456
ds_read_b128 v[64:67], v148 offset:20480
ds_read_b128 v[68:71], v148 offset:21504
ds_read_b128 v[72:75], v148 offset:22528
ds_read_b128 v[76:79], v148 offset:23552
s_waitcnt lgkmcnt(0)
s_waitcnt vmcnt(9)
s_barrier
s_add_u32 m0, s48, 98304
s_add_u32 s53, s49, 311296
buffer_load_dwordx4 v132, s[20:23], s53 offen offset:0 nt lds
buffer_load_dwordx4 v133, s[20:23], s53 offen offset:1024 nt lds
buffer_load_dwordx4 v134, s[20:23], s53 offen offset:2048 nt lds
buffer_load_dwordx4 v135, s[20:23], s53 offen offset:3072 nt lds
s_waitcnt vmcnt(8)
s_barrier
s_add_u32 m0, s48, 114688
s_add_u32 s53, s54, 147584
buffer_load_dwordx4 v141, s[64:67], s53 offen offset:0 lds
buffer_load_dwordx4 v142, s[64:67], s53 offen offset:1024 lds
buffer_load_dwordx4 v143, s[64:67], s53 offen offset:2048 lds
buffer_load_dwordx4 v144, s[64:67], s53 offen offset:3072 lds
v_add_u32 v128, 98304, v146
ds_read_b64_tr_b16 v[112:113], v128 offset:0
ds_read_b64_tr_b16 v[114:115], v128 offset:1024
ds_read_b64_tr_b16 v[116:117], v128 offset:2048
ds_read_b64_tr_b16 v[118:119], v128 offset:3072
ds_read_b64_tr_b16 v[120:121], v128 offset:4096
ds_read_b64_tr_b16 v[122:123], v128 offset:5120
ds_read_b64_tr_b16 v[124:125], v128 offset:6144
ds_read_b64_tr_b16 v[126:127], v128 offset:7168
ds_read_b64_tr_b16 v[152:153], v128 offset:8192
ds_read_b64_tr_b16 v[154:155], v128 offset:9216
s_waitcnt lgkmcnt(8)
v_mfma_f32_32x32x16_bf16 a[0:15], v[112:115], v[48:51], a[0:15]
ds_read_b64_tr_b16 v[112:113], v128 offset:10240
ds_read_b64_tr_b16 v[114:115], v128 offset:11264
s_waitcnt lgkmcnt(8)
v_mfma_f32_32x32x16_bf16 a[0:15], v[116:119], v[52:55], a[0:15]
ds_read_b64_tr_b16 v[116:117], v128 offset:12288
ds_read_b64_tr_b16 v[118:119], v128 offset:13312
s_waitcnt lgkmcnt(8)
v_mfma_f32_32x32x16_bf16 a[0:15], v[120:123], v[56:59], a[0:15]
ds_read_b64_tr_b16 v[120:121], v128 offset:14336
ds_read_b64_tr_b16 v[122:123], v128 offset:15360
s_waitcnt lgkmcnt(8)
v_mfma_f32_32x32x16_bf16 a[0:15], v[124:127], v[60:63], a[0:15]
s_waitcnt vmcnt(8)
s_barrier
s_add_u32 m0, s48, 0
s_add_u32 s53, s49, 327680
buffer_load_dwordx4 v132, s[20:23], s53 offen offset:0 nt lds
buffer_load_dwordx4 v133, s[20:23], s53 offen offset:1024 nt lds
buffer_load_dwordx4 v134, s[20:23], s53 offen offset:2048 nt lds
buffer_load_dwordx4 v135, s[20:23], s53 offen offset:3072 nt lds
s_waitcnt vmcnt(8)
s_barrier
s_add_u32 m0, s48, 16384
s_add_u32 s53, s49, 344064
buffer_load_dwordx4 v132, s[20:23], s53 offen offset:0 nt lds
buffer_load_dwordx4 v133, s[20:23], s53 offen offset:1024 nt lds
buffer_load_dwordx4 v134, s[20:23], s53 offen offset:2048 nt lds
buffer_load_dwordx4 v135, s[20:23], s53 offen offset:3072 nt lds
s_waitcnt vmcnt(8)
s_barrier
s_add_u32 m0, s48, 32768
s_add_u32 s53, s54, 147712
buffer_load_dwordx4 v141, s[64:67], s53 offen offset:0 lds
buffer_load_dwordx4 v142, s[64:67], s53 offen offset:1024 lds
buffer_load_dwordx4 v143, s[64:67], s53 offen offset:2048 lds
buffer_load_dwordx4 v144, s[64:67], s53 offen offset:3072 lds
v_add_u32 v128, 147456, v146
ds_read_b64_tr_b16 v[124:125], v128 offset:0
ds_read_b64_tr_b16 v[126:127], v128 offset:1024
s_waitcnt lgkmcnt(8)
v_mfma_f32_32x32x16_bf16 a[0:15], v[152:155], v[64:67], a[0:15]
ds_read_b64_tr_b16 v[152:153], v128 offset:2048
ds_read_b64_tr_b16 v[154:155], v128 offset:3072
s_waitcnt lgkmcnt(8)
v_mfma_f32_32x32x16_bf16 a[0:15], v[112:115], v[68:71], a[0:15]
ds_read_b64_tr_b16 v[112:113], v128 offset:4096
ds_read_b64_tr_b16 v[114:115], v128 offset:5120
s_waitcnt lgkmcnt(8)
v_mfma_f32_32x32x16_bf16 a[0:15], v[116:119], v[72:75], a[0:15]
ds_read_b64_tr_b16 v[116:117], v128 offset:6144
ds_read_b64_tr_b16 v[118:119], v128 offset:7168
s_waitcnt lgkmcnt(8)
v_mfma_f32_32x32x16_bf16 a[0:15], v[120:123], v[76:79], a[0:15]
ds_read_b64_tr_b16 v[120:121], v128 offset:8192
ds_read_b64_tr_b16 v[122:123], v128 offset:9216
s_waitcnt lgkmcnt(8)
v_mfma_f32_32x32x16_bf16 a[16:31], v[124:127], v[48:51], a[16:31]
ds_read_b64_tr_b16 v[124:125], v128 offset:10240
ds_read_b64_tr_b16 v[126:127], v128 offset:11264
s_waitcnt lgkmcnt(8)
v_mfma_f32_32x32x16_bf16 a[16:31], v[152:155], v[52:55], a[16:31]
ds_read_b64_tr_b16 v[152:153], v128 offset:12288
ds_read_b64_tr_b16 v[154:155], v128 offset:13312
s_waitcnt lgkmcnt(8)
v_mfma_f32_32x32x16_bf16 a[16:31], v[112:115], v[56:59], a[16:31]
ds_read_b64_tr_b16 v[112:113], v128 offset:14336
ds_read_b64_tr_b16 v[114:115], v128 offset:15360
s_waitcnt lgkmcnt(8)
v_mfma_f32_32x32x16_bf16 a[16:31], v[116:119], v[60:63], a[16:31]
s_waitcnt vmcnt(8)
s_barrier
s_add_u32 m0, s48, 49152
s_add_u32 s53, s49, 360448
buffer_load_dwordx4 v132, s[20:23], s53 offen offset:0 nt lds
buffer_load_dwordx4 v133, s[20:23], s53 offen offset:1024 nt lds
buffer_load_dwordx4 v134, s[20:23], s53 offen offset:2048 nt lds
buffer_load_dwordx4 v135, s[20:23], s53 offen offset:3072 nt lds
s_waitcnt vmcnt(8)
s_barrier
s_add_u32 m0, s48, 65536
s_add_u32 s53, s49, 376832
buffer_load_dwordx4 v132, s[20:23], s53 offen offset:0 nt lds
buffer_load_dwordx4 v133, s[20:23], s53 offen offset:1024 nt lds
buffer_load_dwordx4 v134, s[20:23], s53 offen offset:2048 nt lds
buffer_load_dwordx4 v135, s[20:23], s53 offen offset:3072 nt lds
s_waitcnt vmcnt(8)
s_barrier
s_add_u32 m0, s48, 81920
s_add_u32 s53, s54, 147840
buffer_load_dwordx4 v141, s[64:67], s53 offen offset:0 lds
buffer_load_dwordx4 v142, s[64:67], s53 offen offset:1024 lds
buffer_load_dwordx4 v143, s[64:67], s53 offen offset:2048 lds
buffer_load_dwordx4 v144, s[64:67], s53 offen offset:3072 lds
v_add_u32 v128, 65536, v146
ds_read_b64_tr_b16 v[116:117], v128 offset:0
ds_read_b64_tr_b16 v[118:119], v128 offset:1024
s_waitcnt lgkmcnt(8)
v_mfma_f32_32x32x16_bf16 a[16:31], v[120:123], v[64:67], a[16:31]
ds_read_b64_tr_b16 v[120:121], v128 offset:2048
ds_read_b64_tr_b16 v[122:123], v128 offset:3072
s_waitcnt lgkmcnt(8)
v_mfma_f32_32x32x16_bf16 a[16:31], v[124:127], v[68:71], a[16:31]
ds_read_b64_tr_b16 v[124:125], v128 offset:4096
ds_read_b64_tr_b16 v[126:127], v128 offset:5120
s_waitcnt lgkmcnt(8)
v_mfma_f32_32x32x16_bf16 a[16:31], v[152:155], v[72:75], a[16:31]
ds_read_b64_tr_b16 v[152:153], v128 offset:6144
ds_read_b64_tr_b16 v[154:155], v128 offset:7168
s_waitcnt lgkmcnt(8)
v_mfma_f32_32x32x16_bf16 a[16:31], v[112:115], v[76:79], a[16:31]
ds_read_b64_tr_b16 v[112:113], v128 offset:8192
ds_read_b64_tr_b16 v[114:115], v128 offset:9216
s_waitcnt lgkmcnt(8)
v_mfma_f32_32x32x16_bf16 a[32:47], v[116:119], v[48:51], a[32:47]
ds_read_b64_tr_b16 v[116:117], v128 offset:10240
ds_read_b64_tr_b16 v[118:119], v128 offset:11264
s_waitcnt lgkmcnt(8)
v_mfma_f32_32x32x16_bf16 a[32:47], v[120:123], v[52:55], a[32:47]
ds_read_b64_tr_b16 v[120:121], v128 offset:12288
ds_read_b64_tr_b16 v[122:123], v128 offset:13312
s_waitcnt lgkmcnt(8)
v_mfma_f32_32x32x16_bf16 a[32:47], v[124:127], v[56:59], a[32:47]
ds_read_b64_tr_b16 v[124:125], v128 offset:14336
ds_read_b64_tr_b16 v[126:127], v128 offset:15360
s_waitcnt lgkmcnt(8)
v_mfma_f32_32x32x16_bf16 a[32:47], v[152:155], v[60:63], a[32:47]
s_waitcnt vmcnt(8)
s_barrier
s_add_u32 m0, s48, 98304
s_add_u32 s53, s54, 147968
buffer_load_dwordx4 v141, s[64:67], s53 offen offset:0 lds
buffer_load_dwordx4 v142, s[64:67], s53 offen offset:1024 lds
buffer_load_dwordx4 v143, s[64:67], s53 offen offset:2048 lds
buffer_load_dwordx4 v144, s[64:67], s53 offen offset:3072 lds
s_waitcnt vmcnt(8)
s_barrier
s_add_u32 m0, s48, 114688
s_add_u32 s53, s49, 262144
buffer_load_dwordx4 v136, s[24:27], s53 offen offset:0 nt lds
buffer_load_dwordx4 v136, s[24:27], s53 offen offset:1024 nt lds
buffer_load_dwordx4 v136, s[24:27], s53 offen offset:2048 nt lds
buffer_load_dwordx4 v136, s[24:27], s53 offen offset:3072 nt lds
s_waitcnt vmcnt(8)
s_barrier
s_add_u32 m0, s48, 0
s_add_u32 s53, s49, 278528
buffer_load_dwordx4 v136, s[24:27], s53 offen offset:0 nt lds
buffer_load_dwordx4 v136, s[24:27], s53 offen offset:1024 nt lds
buffer_load_dwordx4 v136, s[24:27], s53 offen offset:2048 nt lds
buffer_load_dwordx4 v136, s[24:27], s53 offen offset:3072 nt lds
s_waitcnt lgkmcnt(0)
s_waitcnt vmcnt(8)
s_barrier
s_add_u32 m0, s48, 16384
s_add_u32 s53, s54, 148096
buffer_load_dwordx4 v141, s[64:67], s53 offen offset:0 lds
buffer_load_dwordx4 v142, s[64:67], s53 offen offset:1024 lds
buffer_load_dwordx4 v143, s[64:67], s53 offen offset:2048 lds
buffer_load_dwordx4 v144, s[64:67], s53 offen offset:3072 lds
v_add_u32 v128, 114688, v146
ds_read_b64_tr_b16 v[152:153], v128 offset:0
ds_read_b64_tr_b16 v[154:155], v128 offset:1024
v_mfma_f32_32x32x16_bf16 a[32:47], v[112:115], v[64:67], a[32:47]
ds_read_b64_tr_b16 v[112:113], v128 offset:2048
ds_read_b64_tr_b16 v[114:115], v128 offset:3072
v_mfma_f32_32x32x16_bf16 a[32:47], v[116:119], v[68:71], a[32:47]
ds_read_b64_tr_b16 v[116:117], v128 offset:4096
ds_read_b64_tr_b16 v[118:119], v128 offset:5120
v_mfma_f32_32x32x16_bf16 a[32:47], v[120:123], v[72:75], a[32:47]
ds_read_b64_tr_b16 v[120:121], v128 offset:6144
ds_read_b64_tr_b16 v[122:123], v128 offset:7168
v_mfma_f32_32x32x16_bf16 a[32:47], v[124:127], v[76:79], a[32:47]
ds_read_b64_tr_b16 v[124:125], v128 offset:8192
ds_read_b64_tr_b16 v[126:127], v128 offset:9216
s_waitcnt lgkmcnt(8)
v_mfma_f32_32x32x16_bf16 a[48:63], v[152:155], v[48:51], a[48:63]
ds_read_b64_tr_b16 v[152:153], v128 offset:10240
ds_read_b64_tr_b16 v[154:155], v128 offset:11264
s_waitcnt lgkmcnt(8)
v_mfma_f32_32x32x16_bf16 a[48:63], v[112:115], v[52:55], a[48:63]
ds_read_b64_tr_b16 v[112:113], v128 offset:12288
ds_read_b64_tr_b16 v[114:115], v128 offset:13312
s_waitcnt lgkmcnt(8)
v_mfma_f32_32x32x16_bf16 a[48:63], v[116:119], v[56:59], a[48:63]
ds_read_b64_tr_b16 v[116:117], v128 offset:14336
ds_read_b64_tr_b16 v[118:119], v128 offset:15360
s_waitcnt lgkmcnt(8)
v_mfma_f32_32x32x16_bf16 a[48:63], v[120:123], v[60:63], a[48:63]
v_add_u32 v128, 131072, v146
ds_read_b64_tr_b16 v[120:121], v128 offset:0
ds_read_b64_tr_b16 v[122:123], v128 offset:1024
s_waitcnt lgkmcnt(8)
v_mfma_f32_32x32x16_bf16 a[48:63], v[124:127], v[64:67], a[48:63]
ds_read_b64_tr_b16 v[124:125], v128 offset:2048
ds_read_b64_tr_b16 v[126:127], v128 offset:3072
s_waitcnt lgkmcnt(8)
v_mfma_f32_32x32x16_bf16 a[48:63], v[152:155], v[68:71], a[48:63]
ds_read_b64_tr_b16 v[152:153], v128 offset:4096
ds_read_b64_tr_b16 v[154:155], v128 offset:5120
s_waitcnt lgkmcnt(8)
v_mfma_f32_32x32x16_bf16 a[48:63], v[112:115], v[72:75], a[48:63]
ds_read_b64_tr_b16 v[112:113], v128 offset:6144
ds_read_b64_tr_b16 v[114:115], v128 offset:7168
s_waitcnt lgkmcnt(8)
v_mfma_f32_32x32x16_bf16 a[48:63], v[116:119], v[76:79], a[48:63]
ds_read_b64_tr_b16 v[116:117], v128 offset:8192
ds_read_b64_tr_b16 v[118:119], v128 offset:9216
s_waitcnt lgkmcnt(8)
v_mfma_f32_32x32x16_bf16 a[64:79], v[120:123], v[48:51], a[64:79]
ds_read_b64_tr_b16 v[120:121], v128 offset:10240
ds_read_b64_tr_b16 v[122:123], v128 offset:11264
s_waitcnt lgkmcnt(8)
v_mfma_f32_32x32x16_bf16 a[64:79], v[124:127], v[52:55], a[64:79]
ds_read_b64_tr_b16 v[124:125], v128 offset:12288
ds_read_b64_tr_b16 v[126:127], v128 offset:13312
s_waitcnt lgkmcnt(8)
v_mfma_f32_32x32x16_bf16 a[64:79], v[152:155], v[56:59], a[64:79]
s_waitcnt vmcnt(8)
s_barrier
s_add_u32 m0, s48, 32768
s_add_u32 s53, s49, 294912
buffer_load_dwordx4 v136, s[24:27], s53 offen offset:0 nt lds
buffer_load_dwordx4 v136, s[24:27], s53 offen offset:1024 nt lds
buffer_load_dwordx4 v136, s[24:27], s53 offen offset:2048 nt lds
buffer_load_dwordx4 v136, s[24:27], s53 offen offset:3072 nt lds
ds_read_b64_tr_b16 v[152:153], v128 offset:14336
ds_read_b64_tr_b16 v[154:155], v128 offset:15360
s_waitcnt lgkmcnt(8)
v_mfma_f32_32x32x16_bf16 a[64:79], v[112:115], v[60:63], a[64:79]
s_waitcnt lgkmcnt(6)
v_mfma_f32_32x32x16_bf16 a[64:79], v[116:119], v[64:67], a[64:79]
s_waitcnt lgkmcnt(4)
v_mfma_f32_32x32x16_bf16 a[64:79], v[120:123], v[68:71], a[64:79]
s_waitcnt lgkmcnt(2)
v_mfma_f32_32x32x16_bf16 a[64:79], v[124:127], v[72:75], a[64:79]
s_waitcnt lgkmcnt(0)
v_mfma_f32_32x32x16_bf16 a[64:79], v[152:155], v[76:79], a[64:79]
s_waitcnt vmcnt(8)
s_barrier
s_add_u32 m0, s48, 49152
s_add_u32 s53, s49, 311296
buffer_load_dwordx4 v136, s[24:27], s53 offen offset:0 nt lds
buffer_load_dwordx4 v136, s[24:27], s53 offen offset:1024 nt lds
buffer_load_dwordx4 v136, s[24:27], s53 offen offset:2048 nt lds
buffer_load_dwordx4 v136, s[24:27], s53 offen offset:3072 nt lds
v_add_u32 v148, s52, v147
ds_write_b128 v148, v[80:83] offset:0
ds_write_b128 v148, v[84:87] offset:1024
ds_write_b128 v148, v[88:91] offset:2048
ds_write_b128 v148, v[92:95] offset:3072
s_waitcnt lgkmcnt(0)
s_waitcnt vmcnt(8)
s_barrier
s_add_u32 m0, s48, 65536
s_add_u32 s53, s54, 148224
buffer_load_dwordx4 v141, s[64:67], s53 offen offset:0 lds
buffer_load_dwordx4 v142, s[64:67], s53 offen offset:1024 lds
buffer_load_dwordx4 v143, s[64:67], s53 offen offset:2048 lds
buffer_load_dwordx4 v144, s[64:67], s53 offen offset:3072 lds
v_add_u32 v128, 49152, v146
ds_read_b64_tr_b16 v[112:113], v128 offset:0
ds_read_b64_tr_b16 v[114:115], v128 offset:1024
ds_read_b64_tr_b16 v[116:117], v128 offset:2048
ds_read_b64_tr_b16 v[118:119], v128 offset:3072
ds_read_b64_tr_b16 v[120:121], v128 offset:4096
ds_read_b64_tr_b16 v[122:123], v128 offset:5120
ds_read_b64_tr_b16 v[124:125], v128 offset:6144
ds_read_b64_tr_b16 v[126:127], v128 offset:7168
ds_read_b64_tr_b16 v[152:153], v128 offset:8192
ds_read_b64_tr_b16 v[154:155], v128 offset:9216
s_waitcnt lgkmcnt(8)
v_mfma_f32_32x32x16_bf16 a[80:95], v[112:115], v[48:51], a[80:95]
ds_read_b64_tr_b16 v[112:113], v128 offset:10240
ds_read_b64_tr_b16 v[114:115], v128 offset:11264
s_waitcnt lgkmcnt(8)
v_mfma_f32_32x32x16_bf16 a[80:95], v[116:119], v[52:55], a[80:95]
ds_read_b64_tr_b16 v[116:117], v128 offset:12288
ds_read_b64_tr_b16 v[118:119], v128 offset:13312
s_waitcnt lgkmcnt(8)
v_mfma_f32_32x32x16_bf16 a[80:95], v[120:123], v[56:59], a[80:95]
ds_read_b64_tr_b16 v[120:121], v128 offset:14336
ds_read_b64_tr_b16 v[122:123], v128 offset:15360
s_waitcnt lgkmcnt(8)
v_mfma_f32_32x32x16_bf16 a[80:95], v[124:127], v[60:63], a[80:95]
s_waitcnt vmcnt(8)
s_barrier
s_add_u32 m0, s48, 81920
s_add_u32 s53, s49, 327680
buffer_load_dwordx4 v136, s[24:27], s53 offen offset:0 nt lds
buffer_load_dwordx4 v136, s[24:27], s53 offen offset:1024 nt lds
buffer_load_dwordx4 v136, s[24:27], s53 offen offset:2048 nt lds
buffer_load_dwordx4 v136, s[24:27], s53 offen offset:3072 nt lds
s_waitcnt vmcnt(8)
s_barrier
s_add_u32 m0, s48, 98304
s_add_u32 s53, s49, 344064
buffer_load_dwordx4 v136, s[24:27], s53 offen offset:0 nt lds
buffer_load_dwordx4 v136, s[24:27], s53 offen offset:1024 nt lds
buffer_load_dwordx4 v136, s[24:27], s53 offen offset:2048 nt lds
buffer_load_dwordx4 v136, s[24:27], s53 offen offset:3072 nt lds
s_waitcnt vmcnt(8)
s_barrier
s_add_u32 m0, s48, 114688
s_add_u32 s53, s54, 148352
buffer_load_dwordx4 v141, s[64:67], s53 offen offset:0 lds
buffer_load_dwordx4 v142, s[64:67], s53 offen offset:1024 lds
buffer_load_dwordx4 v143, s[64:67], s53 offen offset:2048 lds
buffer_load_dwordx4 v144, s[64:67], s53 offen offset:3072 lds
v_add_u32 v128, 98304, v146
ds_read_b64_tr_b16 v[124:125], v128 offset:0
ds_read_b64_tr_b16 v[126:127], v128 offset:1024
s_waitcnt lgkmcnt(8)
v_mfma_f32_32x32x16_bf16 a[80:95], v[152:155], v[64:67], a[80:95]
ds_read_b64_tr_b16 v[152:153], v128 offset:2048
ds_read_b64_tr_b16 v[154:155], v128 offset:3072
s_waitcnt lgkmcnt(8)
v_mfma_f32_32x32x16_bf16 a[80:95], v[112:115], v[68:71], a[80:95]
ds_read_b64_tr_b16 v[112:113], v128 offset:4096
ds_read_b64_tr_b16 v[114:115], v128 offset:5120
s_waitcnt lgkmcnt(8)
v_mfma_f32_32x32x16_bf16 a[80:95], v[116:119], v[72:75], a[80:95]
ds_read_b64_tr_b16 v[116:117], v128 offset:6144
ds_read_b64_tr_b16 v[118:119], v128 offset:7168
s_waitcnt lgkmcnt(8)
v_mfma_f32_32x32x16_bf16 a[80:95], v[120:123], v[76:79], a[80:95]
ds_read_b64_tr_b16 v[120:121], v128 offset:8192
ds_read_b64_tr_b16 v[122:123], v128 offset:9216
s_waitcnt lgkmcnt(8)
v_mfma_f32_32x32x16_bf16 v[0:15], v[124:127], v[48:51], v[0:15]
ds_read_b64_tr_b16 v[124:125], v128 offset:10240
ds_read_b64_tr_b16 v[126:127], v128 offset:11264
s_waitcnt lgkmcnt(8)
v_mfma_f32_32x32x16_bf16 v[0:15], v[152:155], v[52:55], v[0:15]
ds_read_b64_tr_b16 v[152:153], v128 offset:12288
ds_read_b64_tr_b16 v[154:155], v128 offset:13312
s_waitcnt lgkmcnt(8)
v_mfma_f32_32x32x16_bf16 v[0:15], v[112:115], v[56:59], v[0:15]
ds_read_b64_tr_b16 v[112:113], v128 offset:14336
ds_read_b64_tr_b16 v[114:115], v128 offset:15360
s_waitcnt lgkmcnt(8)
v_mfma_f32_32x32x16_bf16 v[0:15], v[116:119], v[60:63], v[0:15]
s_waitcnt vmcnt(8)
s_barrier
s_add_u32 m0, s48, 0
s_add_u32 s53, s49, 360448
buffer_load_dwordx4 v136, s[24:27], s53 offen offset:0 nt lds
buffer_load_dwordx4 v136, s[24:27], s53 offen offset:1024 nt lds
buffer_load_dwordx4 v136, s[24:27], s53 offen offset:2048 nt lds
buffer_load_dwordx4 v136, s[24:27], s53 offen offset:3072 nt lds
s_waitcnt vmcnt(8)
s_barrier
s_add_u32 m0, s48, 16384
s_add_u32 s53, s49, 376832
buffer_load_dwordx4 v136, s[24:27], s53 offen offset:0 nt lds
buffer_load_dwordx4 v136, s[24:27], s53 offen offset:1024 nt lds
buffer_load_dwordx4 v136, s[24:27], s53 offen offset:2048 nt lds
buffer_load_dwordx4 v136, s[24:27], s53 offen offset:3072 nt lds
s_waitcnt vmcnt(8)
s_barrier
s_add_u32 m0, s48, 32768
s_add_u32 s53, s54, 148480
buffer_load_dwordx4 v141, s[64:67], s53 offen offset:0 lds
buffer_load_dwordx4 v142, s[64:67], s53 offen offset:1024 lds
buffer_load_dwordx4 v143, s[64:67], s53 offen offset:2048 lds
buffer_load_dwordx4 v144, s[64:67], s53 offen offset:3072 lds
v_add_u32 v128, 147456, v146
ds_read_b64_tr_b16 v[116:117], v128 offset:0
ds_read_b64_tr_b16 v[118:119], v128 offset:1024
s_waitcnt lgkmcnt(8)
v_mfma_f32_32x32x16_bf16 v[0:15], v[120:123], v[64:67], v[0:15]
ds_read_b64_tr_b16 v[120:121], v128 offset:2048
ds_read_b64_tr_b16 v[122:123], v128 offset:3072
s_waitcnt lgkmcnt(8)
v_mfma_f32_32x32x16_bf16 v[0:15], v[124:127], v[68:71], v[0:15]
ds_read_b64_tr_b16 v[124:125], v128 offset:4096
ds_read_b64_tr_b16 v[126:127], v128 offset:5120
s_waitcnt lgkmcnt(8)
v_mfma_f32_32x32x16_bf16 v[0:15], v[152:155], v[72:75], v[0:15]
ds_read_b64_tr_b16 v[152:153], v128 offset:6144
ds_read_b64_tr_b16 v[154:155], v128 offset:7168
s_waitcnt lgkmcnt(8)
v_mfma_f32_32x32x16_bf16 v[0:15], v[112:115], v[76:79], v[0:15]
ds_read_b64_tr_b16 v[112:113], v128 offset:8192
ds_read_b64_tr_b16 v[114:115], v128 offset:9216
s_waitcnt lgkmcnt(8)
v_mfma_f32_32x32x16_bf16 v[16:31], v[116:119], v[48:51], v[16:31]
ds_read_b64_tr_b16 v[116:117], v128 offset:10240
ds_read_b64_tr_b16 v[118:119], v128 offset:11264
s_waitcnt lgkmcnt(8)
v_mfma_f32_32x32x16_bf16 v[16:31], v[120:123], v[52:55], v[16:31]
ds_read_b64_tr_b16 v[120:121], v128 offset:12288
ds_read_b64_tr_b16 v[122:123], v128 offset:13312
s_waitcnt lgkmcnt(8)
v_mfma_f32_32x32x16_bf16 v[16:31], v[124:127], v[56:59], v[16:31]
ds_read_b64_tr_b16 v[124:125], v128 offset:14336
ds_read_b64_tr_b16 v[126:127], v128 offset:15360
s_waitcnt lgkmcnt(8)
v_mfma_f32_32x32x16_bf16 v[16:31], v[152:155], v[60:63], v[16:31]
s_waitcnt vmcnt(8)
s_barrier
s_waitcnt vmcnt(4)
s_barrier
s_add_u32 m0, s48, 81920
s_add_u32 s53, s49, 393216
buffer_load_dwordx4 v132, s[20:23], s53 offen offset:0 nt lds
buffer_load_dwordx4 v133, s[20:23], s53 offen offset:1024 nt lds
buffer_load_dwordx4 v134, s[20:23], s53 offen offset:2048 nt lds
buffer_load_dwordx4 v135, s[20:23], s53 offen offset:3072 nt lds
s_waitcnt vmcnt(4)
s_barrier
s_add_u32 m0, s48, 98304
s_add_u32 s53, s49, 409600
buffer_load_dwordx4 v132, s[20:23], s53 offen offset:0 nt lds
buffer_load_dwordx4 v133, s[20:23], s53 offen offset:1024 nt lds
buffer_load_dwordx4 v134, s[20:23], s53 offen offset:2048 nt lds
buffer_load_dwordx4 v135, s[20:23], s53 offen offset:3072 nt lds
s_add_u32 s53, s54, 294912
buffer_load_dword v159, v157, s[64:67], s53 offen
s_waitcnt lgkmcnt(0)
s_barrier
s_add_u32 m0, s48, 114688
s_add_u32 s53, s54, 294912
buffer_load_dwordx4 v141, s[64:67], s53 offen offset:0 lds
buffer_load_dwordx4 v142, s[64:67], s53 offen offset:1024 lds
buffer_load_dwordx4 v143, s[64:67], s53 offen offset:2048 lds
buffer_load_dwordx4 v144, s[64:67], s53 offen offset:3072 lds
s_waitcnt lgkmcnt(0)
s_barrier
v_add_u32 v128, 65536, v146
ds_read_b64_tr_b16 v[152:153], v128 offset:0
ds_read_b64_tr_b16 v[154:155], v128 offset:1024
v_mfma_f32_32x32x16_bf16 v[16:31], v[112:115], v[64:67], v[16:31]
ds_read_b64_tr_b16 v[112:113], v128 offset:2048
ds_read_b64_tr_b16 v[114:115], v128 offset:3072
v_mfma_f32_32x32x16_bf16 v[16:31], v[116:119], v[68:71], v[16:31]
ds_read_b64_tr_b16 v[116:117], v128 offset:4096
ds_read_b64_tr_b16 v[118:119], v128 offset:5120
v_mfma_f32_32x32x16_bf16 v[16:31], v[120:123], v[72:75], v[16:31]
ds_read_b64_tr_b16 v[120:121], v128 offset:6144
ds_read_b64_tr_b16 v[122:123], v128 offset:7168
v_mfma_f32_32x32x16_bf16 v[16:31], v[124:127], v[76:79], v[16:31]
ds_read_b64_tr_b16 v[124:125], v128 offset:8192
ds_read_b64_tr_b16 v[126:127], v128 offset:9216
s_waitcnt lgkmcnt(8)
v_mfma_f32_32x32x16_bf16 v[32:47], v[152:155], v[48:51], v[32:47]
ds_read_b64_tr_b16 v[152:153], v128 offset:10240
ds_read_b64_tr_b16 v[154:155], v128 offset:11264
s_waitcnt lgkmcnt(8)
v_mfma_f32_32x32x16_bf16 v[32:47], v[112:115], v[52:55], v[32:47]
ds_read_b64_tr_b16 v[112:113], v128 offset:12288
ds_read_b64_tr_b16 v[114:115], v128 offset:13312
s_waitcnt lgkmcnt(8)
v_mfma_f32_32x32x16_bf16 v[32:47], v[116:119], v[56:59], v[32:47]
ds_read_b64_tr_b16 v[116:117], v128 offset:14336
ds_read_b64_tr_b16 v[118:119], v128 offset:15360
s_waitcnt lgkmcnt(8)
v_mfma_f32_32x32x16_bf16 v[32:47], v[120:123], v[60:63], v[32:47]
s_waitcnt lgkmcnt(6)
v_mfma_f32_32x32x16_bf16 v[32:47], v[124:127], v[64:67], v[32:47]
s_waitcnt lgkmcnt(4)
v_mfma_f32_32x32x16_bf16 v[32:47], v[152:155], v[68:71], v[32:47]
s_waitcnt lgkmcnt(2)
v_mfma_f32_32x32x16_bf16 v[32:47], v[112:115], v[72:75], v[32:47]
s_waitcnt lgkmcnt(0)
v_mfma_f32_32x32x16_bf16 v[32:47], v[116:119], v[76:79], v[32:47]
s_waitcnt vmcnt(9)
s_barrier
s_add_u32 m0, s48, 0
s_add_u32 s53, s49, 425984
buffer_load_dwordx4 v132, s[20:23], s53 offen offset:0 nt lds
buffer_load_dwordx4 v133, s[20:23], s53 offen offset:1024 nt lds
buffer_load_dwordx4 v134, s[20:23], s53 offen offset:2048 nt lds
buffer_load_dwordx4 v135, s[20:23], s53 offen offset:3072 nt lds
v_add_u32 v148, s51, v147
ds_read_b128 v[48:51], v148 offset:16384
ds_read_b128 v[52:55], v148 offset:17408
ds_read_b128 v[56:59], v148 offset:18432
ds_read_b128 v[60:63], v148 offset:19456
ds_read_b128 v[64:67], v148 offset:20480
ds_read_b128 v[68:71], v148 offset:21504
ds_read_b128 v[72:75], v148 offset:22528
ds_read_b128 v[76:79], v148 offset:23552
s_waitcnt lgkmcnt(0)
s_waitcnt vmcnt(9)
s_barrier
s_add_u32 m0, s48, 16384
s_add_u32 s53, s49, 442368
buffer_load_dwordx4 v132, s[20:23], s53 offen offset:0 nt lds
buffer_load_dwordx4 v133, s[20:23], s53 offen offset:1024 nt lds
buffer_load_dwordx4 v134, s[20:23], s53 offen offset:2048 nt lds
buffer_load_dwordx4 v135, s[20:23], s53 offen offset:3072 nt lds
s_waitcnt vmcnt(8)
s_barrier
s_add_u32 m0, s48, 32768
s_add_u32 s53, s54, 295040
buffer_load_dwordx4 v141, s[64:67], s53 offen offset:0 lds
buffer_load_dwordx4 v142, s[64:67], s53 offen offset:1024 lds
buffer_load_dwordx4 v143, s[64:67], s53 offen offset:2048 lds
buffer_load_dwordx4 v144, s[64:67], s53 offen offset:3072 lds
v_add_u32 v128, 147456, v146
ds_read_b64_tr_b16 v[112:113], v128 offset:0
ds_read_b64_tr_b16 v[114:115], v128 offset:1024
ds_read_b64_tr_b16 v[116:117], v128 offset:2048
ds_read_b64_tr_b16 v[118:119], v128 offset:3072
ds_read_b64_tr_b16 v[120:121], v128 offset:4096
ds_read_b64_tr_b16 v[122:123], v128 offset:5120
ds_read_b64_tr_b16 v[124:125], v128 offset:6144
ds_read_b64_tr_b16 v[126:127], v128 offset:7168
ds_read_b64_tr_b16 v[152:153], v128 offset:8192
ds_read_b64_tr_b16 v[154:155], v128 offset:9216
s_waitcnt lgkmcnt(8)
v_mfma_f32_32x32x16_bf16 a[0:15], v[112:115], v[48:51], a[0:15]
ds_read_b64_tr_b16 v[112:113], v128 offset:10240
ds_read_b64_tr_b16 v[114:115], v128 offset:11264
s_waitcnt lgkmcnt(8)
v_mfma_f32_32x32x16_bf16 a[0:15], v[116:119], v[52:55], a[0:15]
ds_read_b64_tr_b16 v[116:117], v128 offset:12288
ds_read_b64_tr_b16 v[118:119], v128 offset:13312
s_waitcnt lgkmcnt(8)
v_mfma_f32_32x32x16_bf16 a[0:15], v[120:123], v[56:59], a[0:15]
ds_read_b64_tr_b16 v[120:121], v128 offset:14336
ds_read_b64_tr_b16 v[122:123], v128 offset:15360
s_waitcnt lgkmcnt(8)
v_mfma_f32_32x32x16_bf16 a[0:15], v[124:127], v[60:63], a[0:15]
s_waitcnt vmcnt(8)
s_barrier
s_add_u32 m0, s48, 49152
s_add_u32 s53, s49, 458752
buffer_load_dwordx4 v132, s[20:23], s53 offen offset:0 nt lds
buffer_load_dwordx4 v133, s[20:23], s53 offen offset:1024 nt lds
buffer_load_dwordx4 v134, s[20:23], s53 offen offset:2048 nt lds
buffer_load_dwordx4 v135, s[20:23], s53 offen offset:3072 nt lds
s_waitcnt vmcnt(8)
s_barrier
s_add_u32 m0, s48, 65536
s_add_u32 s53, s49, 475136
buffer_load_dwordx4 v132, s[20:23], s53 offen offset:0 nt lds
buffer_load_dwordx4 v133, s[20:23], s53 offen offset:1024 nt lds
buffer_load_dwordx4 v134, s[20:23], s53 offen offset:2048 nt lds
buffer_load_dwordx4 v135, s[20:23], s53 offen offset:3072 nt lds
s_cmp_eq_u32 s69, 5
s_cbranch_scc0 TLBW_done
s_mov_b64 exec, 1
s_mul_i32 s38, s36, 589824
v_mov_b32 v148, s38
global_load_dword v159, v148, s[12:13]
s_mul_i32 s38, s36, 73728
v_mov_b32 v148, s38
global_load_dword v159, v148, s[72:73]
s_mov_b64 exec, -1
TLBW_done:
s_waitcnt vmcnt(8)
s_barrier
s_add_u32 m0, s48, 81920
s_add_u32 s53, s54, 295168
buffer_load_dwordx4 v141, s[64:67], s53 offen offset:0 lds
buffer_load_dwordx4 v142, s[64:67], s53 offen offset:1024 lds
buffer_load_dwordx4 v143, s[64:67], s53 offen offset:2048 lds
buffer_load_dwordx4 v144, s[64:67], s53 offen offset:3072 lds
v_add_u32 v128, 65536, v146
ds_read_b64_tr_b16 v[124:125], v128 offset:0
ds_read_b64_tr_b16 v[126:127], v128 offset:1024
s_waitcnt lgkmcnt(8)
v_mfma_f32_32x32x16_bf16 a[0:15], v[152:155], v[64:67], a[0:15]
ds_read_b64_tr_b16 v[152:153], v128 offset:2048
ds_read_b64_tr_b16 v[154:155], v128 offset:3072
s_waitcnt lgkmcnt(8)
v_mfma_f32_32x32x16_bf16 a[0:15], v[112:115], v[68:71], a[0:15]
ds_read_b64_tr_b16 v[112:113], v128 offset:4096
ds_read_b64_tr_b16 v[114:115], v128 offset:5120
s_waitcnt lgkmcnt(8)
v_mfma_f32_32x32x16_bf16 a[0:15], v[116:119], v[72:75], a[0:15]
ds_read_b64_tr_b16 v[116:117], v128 offset:6144
ds_read_b64_tr_b16 v[118:119], v128 offset:7168
s_waitcnt lgkmcnt(8)
v_mfma_f32_32x32x16_bf16 a[0:15], v[120:123], v[76:79], a[0:15]
ds_read_b64_tr_b16 v[120:121], v128 offset:8192
ds_read_b64_tr_b16 v[122:123], v128 offset:9216
s_waitcnt lgkmcnt(8)
v_mfma_f32_32x32x16_bf16 a[16:31], v[124:127], v[48:51], a[16:31]
ds_read_b64_tr_b16 v[124:125], v128 offset:10240
ds_read_b64_tr_b16 v[126:127], v128 offset:11264
s_waitcnt lgkmcnt(8)
v_mfma_f32_32x32x16_bf16 a[16:31], v[152:155], v[52:55], a[16:31]
ds_read_b64_tr_b16 v[152:153], v128 offset:12288
ds_read_b64_tr_b16 v[154:155], v128 offset:13312
s_waitcnt lgkmcnt(8)
v_mfma_f32_32x32x16_bf16 a[16:31], v[112:115], v[56:59], a[16:31]
ds_read_b64_tr_b16 v[112:113], v128 offset:14336
ds_read_b64_tr_b16 v[114:115], v128 offset:15360
s_waitcnt lgkmcnt(8)
v_mfma_f32_32x32x16_bf16 a[16:31], v[116:119], v[60:63], a[16:31]
s_waitcnt vmcnt(8)
s_barrier
s_add_u32 m0, s48, 98304
s_add_u32 s53, s49, 491520
buffer_load_dwordx4 v132, s[20:23], s53 offen offset:0 nt lds
buffer_load_dwordx4 v133, s[20:23], s53 offen offset:1024 nt lds
buffer_load_dwordx4 v134, s[20:23], s53 offen offset:2048 nt lds
buffer_load_dwordx4 v135, s[20:23], s53 offen offset:3072 nt lds
s_waitcnt vmcnt(8)
s_barrier
s_add_u32 m0, s48, 114688
s_add_u32 s53, s49, 507904
buffer_load_dwordx4 v132, s[20:23], s53 offen offset:0 nt lds
buffer_load_dwordx4 v133, s[20:23], s53 offen offset:1024 nt lds
buffer_load_dwordx4 v134, s[20:23], s53 offen offset:2048 nt lds
buffer_load_dwordx4 v135, s[20:23], s53 offen offset:3072 nt lds
s_waitcnt vmcnt(8)
s_barrier
s_add_u32 m0, s48, 0
s_add_u32 s53, s54, 295296
buffer_load_dwordx4 v141, s[64:67], s53 offen offset:0 lds
buffer_load_dwordx4 v142, s[64:67], s53 offen offset:1024 lds
buffer_load_dwordx4 v143, s[64:67], s53 offen offset:2048 lds
buffer_load_dwordx4 v144, s[64:67], s53 offen offset:3072 lds
v_add_u32 v128, 114688, v146
ds_read_b64_tr_b16 v[116:117], v128 offset:0
ds_read_b64_tr_b16 v[118:119], v128 offset:1024
s_waitcnt lgkmcnt(8)
v_mfma_f32_32x32x16_bf16 a[16:31], v[120:123], v[64:67], a[16:31]
ds_read_b64_tr_b16 v[120:121], v128 offset:2048
ds_read_b64_tr_b16 v[122:123], v128 offset:3072
s_waitcnt lgkmcnt(8)
v_mfma_f32_32x32x16_bf16 a[16:31], v[124:127], v[68:71], a[16:31]
ds_read_b64_tr_b16 v[124:125], v128 offset:4096
ds_read_b64_tr_b16 v[126:127], v128 offset:5120
s_waitcnt lgkmcnt(8)
v_mfma_f32_32x32x16_bf16 a[16:31], v[152:155], v[72:75], a[16:31]
ds_read_b64_tr_b16 v[152:153], v128 offset:6144
ds_read_b64_tr_b16 v[154:155], v128 offset:7168
s_waitcnt lgkmcnt(8)
v_mfma_f32_32x32x16_bf16 a[16:31], v[112:115], v[76:79], a[16:31]
ds_read_b64_tr_b16 v[112:113], v128 offset:8192
ds_read_b64_tr_b16 v[114:115], v128 offset:9216
s_waitcnt lgkmcnt(8)
v_mfma_f32_32x32x16_bf16 a[32:47], v[116:119], v[48:51], a[32:47]
ds_read_b64_tr_b16 v[116:117], v128 offset:10240
ds_read_b64_tr_b16 v[118:119], v128 offset:11264
s_waitcnt lgkmcnt(8)
v_mfma_f32_32x32x16_bf16 a[32:47], v[120:123], v[52:55], a[32:47]
ds_read_b64_tr_b16 v[120:121], v128 offset:12288
ds_read_b64_tr_b16 v[122:123], v128 offset:13312
s_waitcnt lgkmcnt(8)
v_mfma_f32_32x32x16_bf16 a[32:47], v[124:127], v[56:59], a[32:47]
ds_read_b64_tr_b16 v[124:125], v128 offset:14336
ds_read_b64_tr_b16 v[126:127], v128 offset:15360
s_waitcnt lgkmcnt(8)
v_mfma_f32_32x32x16_bf16 a[32:47], v[152:155], v[60:63], a[32:47]
s_waitcnt vmcnt(8)
s_barrier
s_add_u32 m0, s48, 16384
s_add_u32 s53, s54, 295424
buffer_load_dwordx4 v141, s[64:67], s53 offen offset:0 lds
buffer_load_dwordx4 v142, s[64:67], s53 offen offset:1024 lds
buffer_load_dwordx4 v143, s[64:67], s53 offen offset:2048 lds
buffer_load_dwordx4 v144, s[64:67], s53 offen offset:3072 lds
s_waitcnt vmcnt(8)
s_barrier
s_add_u32 m0, s48, 32768
s_add_u32 s53, s49, 393216
buffer_load_dwordx4 v136, s[24:27], s53 offen offset:0 nt lds
buffer_load_dwordx4 v136, s[24:27], s53 offen offset:1024 nt lds
buffer_load_dwordx4 v136, s[24:27], s53 offen offset:2048 nt lds
buffer_load_dwordx4 v136, s[24:27], s53 offen offset:3072 nt lds
s_waitcnt vmcnt(8)
s_barrier
s_add_u32 m0, s48, 49152
s_add_u32 s53, s49, 409600
buffer_load_dwordx4 v136, s[24:27], s53 offen offset:0 nt lds
buffer_load_dwordx4 v136, s[24:27], s53 offen offset:1024 nt lds
buffer_load_dwordx4 v136, s[24:27], s53 offen offset:2048 nt lds
buffer_load_dwordx4 v136, s[24:27], s53 offen offset:3072 nt lds
s_waitcnt lgkmcnt(0)
s_waitcnt vmcnt(8)
s_barrier
s_add_u32 m0, s48, 65536
s_add_u32 s53, s54, 295552
buffer_load_dwordx4 v141, s[64:67], s53 offen offset:0 lds
buffer_load_dwordx4 v142, s[64:67], s53 offen offset:1024 lds
buffer_load_dwordx4 v143, s[64:67], s53 offen offset:2048 lds
buffer_load_dwordx4 v144, s[64:67], s53 offen offset:3072 lds
v_add_u32 v128, 32768, v146
ds_read_b64_tr_b16 v[152:153], v128 offset:0
ds_read_b64_tr_b16 v[154:155], v128 offset:1024
v_mfma_f32_32x32x16_bf16 a[32:47], v[112:115], v[64:67], a[32:47]
ds_read_b64_tr_b16 v[112:113], v128 offset:2048
ds_read_b64_tr_b16 v[114:115], v128 offset:3072
v_mfma_f32_32x32x16_bf16 a[32:47], v[116:119], v[68:71], a[32:47]
ds_read_b64_tr_b16 v[116:117], v128 offset:4096
ds_read_b64_tr_b16 v[118:119], v128 offset:5120
v_mfma_f32_32x32x16_bf16 a[32:47], v[120:123], v[72:75], a[32:47]
ds_read_b64_tr_b16 v[120:121], v128 offset:6144
ds_read_b64_tr_b16 v[122:123], v128 offset:7168
v_mfma_f32_32x32x16_bf16 a[32:47], v[124:127], v[76:79], a[32:47]
ds_read_b64_tr_b16 v[124:125], v128 offset:8192
ds_read_b64_tr_b16 v[126:127], v128 offset:9216
s_waitcnt lgkmcnt(8)
v_mfma_f32_32x32x16_bf16 a[48:63], v[152:155], v[48:51], a[48:63]
ds_read_b64_tr_b16 v[152:153], v128 offset:10240
ds_read_b64_tr_b16 v[154:155], v128 offset:11264
s_waitcnt lgkmcnt(8)
v_mfma_f32_32x32x16_bf16 a[48:63], v[112:115], v[52:55], a[48:63]
ds_read_b64_tr_b16 v[112:113], v128 offset:12288
ds_read_b64_tr_b16 v[114:115], v128 offset:13312
s_waitcnt lgkmcnt(8)
v_mfma_f32_32x32x16_bf16 a[48:63], v[116:119], v[56:59], a[48:63]
ds_read_b64_tr_b16 v[116:117], v128 offset:14336
ds_read_b64_tr_b16 v[118:119], v128 offset:15360
s_waitcnt lgkmcnt(8)
v_mfma_f32_32x32x16_bf16 a[48:63], v[120:123], v[60:63], a[48:63]
v_add_u32 v128, 49152, v146
ds_read_b64_tr_b16 v[120:121], v128 offset:0
ds_read_b64_tr_b16 v[122:123], v128 offset:1024
s_waitcnt lgkmcnt(8)
v_mfma_f32_32x32x16_bf16 a[48:63], v[124:127], v[64:67], a[48:63]
ds_read_b64_tr_b16 v[124:125], v128 offset:2048
ds_read_b64_tr_b16 v[126:127], v128 offset:3072
s_waitcnt lgkmcnt(8)
v_mfma_f32_32x32x16_bf16 a[48:63], v[152:155], v[68:71], a[48:63]
ds_read_b64_tr_b16 v[152:153], v128 offset:4096
ds_read_b64_tr_b16 v[154:155], v128 offset:5120
s_waitcnt lgkmcnt(8)
v_mfma_f32_32x32x16_bf16 a[48:63], v[112:115], v[72:75], a[48:63]
ds_read_b64_tr_b16 v[112:113], v128 offset:6144
ds_read_b64_tr_b16 v[114:115], v128 offset:7168
s_waitcnt lgkmcnt(8)
v_mfma_f32_32x32x16_bf16 a[48:63], v[116:119], v[76:79], a[48:63]
ds_read_b64_tr_b16 v[116:117], v128 offset:8192
ds_read_b64_tr_b16 v[118:119], v128 offset:9216
s_waitcnt lgkmcnt(8)
v_mfma_f32_32x32x16_bf16 a[64:79], v[120:123], v[48:51], a[64:79]
ds_read_b64_tr_b16 v[120:121], v128 offset:10240
ds_read_b64_tr_b16 v[122:123], v128 offset:11264
s_waitcnt lgkmcnt(8)
v_mfma_f32_32x32x16_bf16 a[64:79], v[124:127], v[52:55], a[64:79]
ds_read_b64_tr_b16 v[124:125], v128 offset:12288
ds_read_b64_tr_b16 v[126:127], v128 offset:13312
s_waitcnt lgkmcnt(8)
v_mfma_f32_32x32x16_bf16 a[64:79], v[152:155], v[56:59], a[64:79]
s_waitcnt vmcnt(8)
s_barrier
s_add_u32 m0, s48, 81920
s_add_u32 s53, s49, 425984
buffer_load_dwordx4 v136, s[24:27], s53 offen offset:0 nt lds
buffer_load_dwordx4 v136, s[24:27], s53 offen offset:1024 nt lds
buffer_load_dwordx4 v136, s[24:27], s53 offen offset:2048 nt lds
buffer_load_dwordx4 v136, s[24:27], s53 offen offset:3072 nt lds
ds_read_b64_tr_b16 v[152:153], v128 offset:14336
ds_read_b64_tr_b16 v[154:155], v128 offset:15360
s_waitcnt lgkmcnt(8)
v_mfma_f32_32x32x16_bf16 a[64:79], v[112:115], v[60:63], a[64:79]
s_waitcnt vmcnt(8)
s_barrier
s_add_u32 m0, s48, 98304
s_add_u32 s53, s49, 442368
buffer_load_dwordx4 v136, s[24:27], s53 offen offset:0 nt lds
buffer_load_dwordx4 v136, s[24:27], s53 offen offset:1024 nt lds
buffer_load_dwordx4 v136, s[24:27], s53 offen offset:2048 nt lds
buffer_load_dwordx4 v136, s[24:27], s53 offen offset:3072 nt lds
s_waitcnt vmcnt(8)
s_barrier
s_add_u32 m0, s48, 114688
s_add_u32 s53, s54, 295680
buffer_load_dwordx4 v141, s[64:67], s53 offen offset:0 lds
buffer_load_dwordx4 v142, s[64:67], s53 offen offset:1024 lds
buffer_load_dwordx4 v143, s[64:67], s53 offen offset:2048 lds
buffer_load_dwordx4 v144, s[64:67], s53 offen offset:3072 lds
v_add_u32 v128, 98304, v146
ds_read_b64_tr_b16 v[112:113], v128 offset:0
ds_read_b64_tr_b16 v[114:115], v128 offset:1024
s_waitcnt lgkmcnt(8)
v_mfma_f32_32x32x16_bf16 a[64:79], v[116:119], v[64:67], a[64:79]
ds_read_b64_tr_b16 v[116:117], v128 offset:2048
ds_read_b64_tr_b16 v[118:119], v128 offset:3072
s_waitcnt lgkmcnt(8)
v_mfma_f32_32x32x16_bf16 a[64:79], v[120:123], v[68:71], a[64:79]
ds_read_b64_tr_b16 v[120:121], v128 offset:4096
ds_read_b64_tr_b16 v[122:123], v128 offset:5120
s_waitcnt lgkmcnt(8)
v_mfma_f32_32x32x16_bf16 a[64:79], v[124:127], v[72:75], a[64:79]
ds_read_b64_tr_b16 v[124:125], v128 offset:6144
ds_read_b64_tr_b16 v[126:127], v128 offset:7168
s_waitcnt lgkmcnt(8)
v_mfma_f32_32x32x16_bf16 a[64:79], v[152:155], v[76:79], a[64:79]
ds_read_b64_tr_b16 v[152:153], v128 offset:8192
ds_read_b64_tr_b16 v[154:155], v128 offset:9216
s_waitcnt lgkmcnt(8)
v_mfma_f32_32x32x16_bf16 a[80:95], v[112:115], v[48:51], a[80:95]
ds_read_b64_tr_b16 v[112:113], v128 offset:10240
ds_read_b64_tr_b16 v[114:115], v128 offset:11264
s_waitcnt lgkmcnt(8)
v_mfma_f32_32x32x16_bf16 a[80:95], v[116:119], v[52:55], a[80:95]
ds_read_b64_tr_b16 v[116:117], v128 offset:12288
ds_read_b64_tr_b16 v[118:119], v128 offset:13312
s_waitcnt lgkmcnt(8)
v_mfma_f32_32x32x16_bf16 a[80:95], v[120:123], v[56:59], a[80:95]
ds_read_b64_tr_b16 v[120:121], v128 offset:14336
ds_read_b64_tr_b16 v[122:123], v128 offset:15360
s_waitcnt lgkmcnt(8)
v_mfma_f32_32x32x16_bf16 a[80:95], v[124:127], v[60:63], a[80:95]
s_waitcnt vmcnt(8)
s_barrier
s_add_u32 m0, s48, 0
s_add_u32 s53, s49, 458752
buffer_load_dwordx4 v136, s[24:27], s53 offen offset:0 nt lds
buffer_load_dwordx4 v136, s[24:27], s53 offen offset:1024 nt lds
buffer_load_dwordx4 v136, s[24:27], s53 offen offset:2048 nt lds
buffer_load_dwordx4 v136, s[24:27], s53 offen offset:3072 nt lds
s_waitcnt vmcnt(8)
s_barrier
s_add_u32 m0, s48, 16384
s_add_u32 s53, s49, 475136
buffer_load_dwordx4 v136, s[24:27], s53 offen offset:0 nt lds
buffer_load_dwordx4 v136, s[24:27], s53 offen offset:1024 nt lds
buffer_load_dwordx4 v136, s[24:27], s53 offen offset:2048 nt lds
buffer_load_dwordx4 v136, s[24:27], s53 offen offset:3072 nt lds
s_waitcnt vmcnt(8)
s_barrier
s_add_u32 m0, s48, 32768
s_add_u32 s53, s54, 295808
buffer_load_dwordx4 v141, s[64:67], s53 offen offset:0 lds
buffer_load_dwordx4 v142, s[64:67], s53 offen offset:1024 lds
buffer_load_dwordx4 v143, s[64:67], s53 offen offset:2048 lds
buffer_load_dwordx4 v144, s[64:67], s53 offen offset:3072 lds
v_add_u32 v128, 147456, v146
ds_read_b64_tr_b16 v[124:125], v128 offset:0
ds_read_b64_tr_b16 v[126:127], v128 offset:1024
s_waitcnt lgkmcnt(8)
v_mfma_f32_32x32x16_bf16 a[80:95], v[152:155], v[64:67], a[80:95]
ds_read_b64_tr_b16 v[152:153], v128 offset:2048
ds_read_b64_tr_b16 v[154:155], v128 offset:3072
s_waitcnt lgkmcnt(8)
v_mfma_f32_32x32x16_bf16 a[80:95], v[112:115], v[68:71], a[80:95]
ds_read_b64_tr_b16 v[112:113], v128 offset:4096
ds_read_b64_tr_b16 v[114:115], v128 offset:5120
s_waitcnt lgkmcnt(8)
v_mfma_f32_32x32x16_bf16 a[80:95], v[116:119], v[72:75], a[80:95]
ds_read_b64_tr_b16 v[116:117], v128 offset:6144
ds_read_b64_tr_b16 v[118:119], v128 offset:7168
s_waitcnt lgkmcnt(8)
v_mfma_f32_32x32x16_bf16 a[80:95], v[120:123], v[76:79], a[80:95]
ds_read_b64_tr_b16 v[120:121], v128 offset:8192
ds_read_b64_tr_b16 v[122:123], v128 offset:9216
s_waitcnt lgkmcnt(8)
v_mfma_f32_32x32x16_bf16 v[0:15], v[124:127], v[48:51], v[0:15]
ds_read_b64_tr_b16 v[124:125], v128 offset:10240
ds_read_b64_tr_b16 v[126:127], v128 offset:11264
s_waitcnt lgkmcnt(8)
v_mfma_f32_32x32x16_bf16 v[0:15], v[152:155], v[52:55], v[0:15]
ds_read_b64_tr_b16 v[152:153], v128 offset:12288
ds_read_b64_tr_b16 v[154:155], v128 offset:13312
s_waitcnt lgkmcnt(8)
v_mfma_f32_32x32x16_bf16 v[0:15], v[112:115], v[56:59], v[0:15]
ds_read_b64_tr_b16 v[112:113], v128 offset:14336
ds_read_b64_tr_b16 v[114:115], v128 offset:15360
s_waitcnt lgkmcnt(8)
v_mfma_f32_32x32x16_bf16 v[0:15], v[116:119], v[60:63], v[0:15]
s_waitcnt vmcnt(8)
s_barrier
s_add_u32 m0, s48, 49152
s_add_u32 s53, s49, 491520
buffer_load_dwordx4 v136, s[24:27], s53 offen offset:0 nt lds
buffer_load_dwordx4 v136, s[24:27], s53 offen offset:1024 nt lds
buffer_load_dwordx4 v136, s[24:27], s53 offen offset:2048 nt lds
buffer_load_dwordx4 v136, s[24:27], s53 offen offset:3072 nt lds
s_waitcnt vmcnt(8)
s_barrier
s_add_u32 m0, s48, 65536
s_add_u32 s53, s49, 507904
buffer_load_dwordx4 v136, s[24:27], s53 offen offset:0 nt lds
buffer_load_dwordx4 v136, s[24:27], s53 offen offset:1024 nt lds
buffer_load_dwordx4 v136, s[24:27], s53 offen offset:2048 nt lds
buffer_load_dwordx4 v136, s[24:27], s53 offen offset:3072 nt lds
s_waitcnt vmcnt(8)
s_barrier
s_add_u32 m0, s48, 81920
s_add_u32 s53, s54, 295936
buffer_load_dwordx4 v141, s[64:67], s53 offen offset:0 lds
buffer_load_dwordx4 v142, s[64:67], s53 offen offset:1024 lds
buffer_load_dwordx4 v143, s[64:67], s53 offen offset:2048 lds
buffer_load_dwordx4 v144, s[64:67], s53 offen offset:3072 lds
v_add_u32 v128, 65536, v146
ds_read_b64_tr_b16 v[116:117], v128 offset:0
ds_read_b64_tr_b16 v[118:119], v128 offset:1024
s_waitcnt lgkmcnt(8)
v_mfma_f32_32x32x16_bf16 v[0:15], v[120:123], v[64:67], v[0:15]
ds_read_b64_tr_b16 v[120:121], v128 offset:2048
ds_read_b64_tr_b16 v[122:123], v128 offset:3072
s_waitcnt lgkmcnt(8)
v_mfma_f32_32x32x16_bf16 v[0:15], v[124:127], v[68:71], v[0:15]
ds_read_b64_tr_b16 v[124:125], v128 offset:4096
ds_read_b64_tr_b16 v[126:127], v128 offset:5120
s_waitcnt lgkmcnt(8)
v_mfma_f32_32x32x16_bf16 v[0:15], v[152:155], v[72:75], v[0:15]
ds_read_b64_tr_b16 v[152:153], v128 offset:6144
ds_read_b64_tr_b16 v[154:155], v128 offset:7168
s_waitcnt lgkmcnt(8)
v_mfma_f32_32x32x16_bf16 v[0:15], v[112:115], v[76:79], v[0:15]
ds_read_b64_tr_b16 v[112:113], v128 offset:8192
ds_read_b64_tr_b16 v[114:115], v128 offset:9216
s_waitcnt lgkmcnt(8)
v_mfma_f32_32x32x16_bf16 v[16:31], v[116:119], v[48:51], v[16:31]
ds_read_b64_tr_b16 v[116:117], v128 offset:10240
ds_read_b64_tr_b16 v[118:119], v128 offset:11264
s_waitcnt lgkmcnt(8)
v_mfma_f32_32x32x16_bf16 v[16:31], v[120:123], v[52:55], v[16:31]
ds_read_b64_tr_b16 v[120:121], v128 offset:12288
ds_read_b64_tr_b16 v[122:123], v128 offset:13312
s_waitcnt lgkmcnt(8)
v_mfma_f32_32x32x16_bf16 v[16:31], v[124:127], v[56:59], v[16:31]
ds_read_b64_tr_b16 v[124:125], v128 offset:14336
ds_read_b64_tr_b16 v[126:127], v128 offset:15360
s_waitcnt lgkmcnt(8)
v_mfma_f32_32x32x16_bf16 v[16:31], v[152:155], v[60:63], v[16:31]
s_waitcnt vmcnt(8)
s_barrier
s_waitcnt vmcnt(4)
s_barrier
s_add_u32 m0, s48, 0
s_add_u32 s53, s54, 442368
buffer_load_dwordx4 v141, s[64:67], s53 offen offset:0 lds
buffer_load_dwordx4 v142, s[64:67], s53 offen offset:1024 lds
buffer_load_dwordx4 v143, s[64:67], s53 offen offset:2048 lds
buffer_load_dwordx4 v144, s[64:67], s53 offen offset:3072 lds
s_waitcnt vmcnt(4)
s_barrier
s_add_u32 m0, s48, 16384
s_add_u32 s53, s54, 442496
buffer_load_dwordx4 v141, s[64:67], s53 offen offset:0 lds
buffer_load_dwordx4 v142, s[64:67], s53 offen offset:1024 lds
buffer_load_dwordx4 v143, s[64:67], s53 offen offset:2048 lds
buffer_load_dwordx4 v144, s[64:67], s53 offen offset:3072 lds
s_add_u32 s53, s54, 442368
buffer_load_dword v159, v157, s[64:67], s53 offen
v_add_u32 v128, 114688, v146
ds_read_b64_tr_b16 v[152:153], v128 offset:0
ds_read_b64_tr_b16 v[154:155], v128 offset:1024
s_waitcnt lgkmcnt(8)
v_mfma_f32_32x32x16_bf16 v[16:31], v[112:115], v[64:67], v[16:31]
ds_read_b64_tr_b16 v[112:113], v128 offset:2048
ds_read_b64_tr_b16 v[114:115], v128 offset:3072
s_waitcnt lgkmcnt(8)
v_mfma_f32_32x32x16_bf16 v[16:31], v[116:119], v[68:71], v[16:31]
ds_read_b64_tr_b16 v[116:117], v128 offset:4096
ds_read_b64_tr_b16 v[118:119], v128 offset:5120
s_waitcnt lgkmcnt(8)
v_mfma_f32_32x32x16_bf16 v[16:31], v[120:123], v[72:75], v[16:31]
ds_read_b64_tr_b16 v[120:121], v128 offset:6144
ds_read_b64_tr_b16 v[122:123], v128 offset:7168
s_waitcnt lgkmcnt(8)
v_mfma_f32_32x32x16_bf16 v[16:31], v[124:127], v[76:79], v[16:31]
ds_read_b64_tr_b16 v[124:125], v128 offset:8192
ds_read_b64_tr_b16 v[126:127], v128 offset:9216
s_waitcnt lgkmcnt(8)
v_mfma_f32_32x32x16_bf16 v[32:47], v[152:155], v[48:51], v[32:47]
ds_read_b64_tr_b16 v[152:153], v128 offset:10240
ds_read_b64_tr_b16 v[154:155], v128 offset:11264
s_waitcnt lgkmcnt(8)
v_mfma_f32_32x32x16_bf16 v[32:47], v[112:115], v[52:55], v[32:47]
ds_read_b64_tr_b16 v[112:113], v128 offset:12288
ds_read_b64_tr_b16 v[114:115], v128 offset:13312
s_waitcnt lgkmcnt(8)
v_mfma_f32_32x32x16_bf16 v[32:47], v[116:119], v[56:59], v[32:47]
ds_read_b64_tr_b16 v[116:117], v128 offset:14336
ds_read_b64_tr_b16 v[118:119], v128 offset:15360
s_waitcnt lgkmcnt(8)
v_mfma_f32_32x32x16_bf16 v[32:47], v[120:123], v[60:63], v[32:47]
s_waitcnt lgkmcnt(6)
v_mfma_f32_32x32x16_bf16 v[32:47], v[124:127], v[64:67], v[32:47]
s_waitcnt lgkmcnt(4)
v_mfma_f32_32x32x16_bf16 v[32:47], v[152:155], v[68:71], v[32:47]
s_waitcnt lgkmcnt(2)
v_mfma_f32_32x32x16_bf16 v[32:47], v[112:115], v[72:75], v[32:47]
s_waitcnt lgkmcnt(0)
v_mfma_f32_32x32x16_bf16 v[32:47], v[116:119], v[76:79], v[32:47]
s_barrier
s_barrier
s_waitcnt vmcnt(5)
s_barrier
v_add_u32 v148, s51, v147
ds_read_b128 v[48:51], v148 offset:16384
ds_read_b128 v[52:55], v148 offset:17408
ds_read_b128 v[56:59], v148 offset:18432
ds_read_b128 v[60:63], v148 offset:19456
ds_read_b128 v[64:67], v148 offset:20480
ds_read_b128 v[68:71], v148 offset:21504
ds_read_b128 v[72:75], v148 offset:22528
ds_read_b128 v[76:79], v148 offset:23552
s_waitcnt lgkmcnt(0)
v_add_u32 v128, 32768, v146
ds_read_b64_tr_b16 v[112:113], v128 offset:0
ds_read_b64_tr_b16 v[114:115], v128 offset:1024
ds_read_b64_tr_b16 v[116:117], v128 offset:2048
ds_read_b64_tr_b16 v[118:119], v128 offset:3072
ds_read_b64_tr_b16 v[120:121], v128 offset:4096
ds_read_b64_tr_b16 v[122:123], v128 offset:5120
ds_read_b64_tr_b16 v[124:125], v128 offset:6144
ds_read_b64_tr_b16 v[126:127], v128 offset:7168
ds_read_b64_tr_b16 v[152:153], v128 offset:8192
ds_read_b64_tr_b16 v[154:155], v128 offset:9216
s_waitcnt lgkmcnt(8)
v_mfma_f32_32x32x16_bf16 a[0:15], v[112:115], v[48:51], a[0:15]
ds_read_b64_tr_b16 v[112:113], v128 offset:10240
ds_read_b64_tr_b16 v[114:115], v128 offset:11264
s_waitcnt lgkmcnt(8)
v_mfma_f32_32x32x16_bf16 a[0:15], v[116:119], v[52:55], a[0:15]
ds_read_b64_tr_b16 v[116:117], v128 offset:12288
ds_read_b64_tr_b16 v[118:119], v128 offset:13312
s_waitcnt lgkmcnt(8)
v_mfma_f32_32x32x16_bf16 a[0:15], v[120:123], v[56:59], a[0:15]
ds_read_b64_tr_b16 v[120:121], v128 offset:14336
ds_read_b64_tr_b16 v[122:123], v128 offset:15360
s_waitcnt lgkmcnt(8)
v_mfma_f32_32x32x16_bf16 a[0:15], v[124:127], v[60:63], a[0:15]
s_waitcnt vmcnt(1)
s_barrier
v_add_u32 v128, 49152, v146
ds_read_b64_tr_b16 v[124:125], v128 offset:0
ds_read_b64_tr_b16 v[126:127], v128 offset:1024
s_waitcnt lgkmcnt(8)
v_mfma_f32_32x32x16_bf16 a[0:15], v[152:155], v[64:67], a[0:15]
ds_read_b64_tr_b16 v[152:153], v128 offset:2048
ds_read_b64_tr_b16 v[154:155], v128 offset:3072
s_waitcnt lgkmcnt(8)
v_mfma_f32_32x32x16_bf16 a[0:15], v[112:115], v[68:71], a[0:15]
ds_read_b64_tr_b16 v[112:113], v128 offset:4096
ds_read_b64_tr_b16 v[114:115], v128 offset:5120
s_waitcnt lgkmcnt(8)
v_mfma_f32_32x32x16_bf16 a[0:15], v[116:119], v[72:75], a[0:15]
ds_read_b64_tr_b16 v[116:117], v128 offset:6144
ds_read_b64_tr_b16 v[118:119], v128 offset:7168
s_waitcnt lgkmcnt(8)
v_mfma_f32_32x32x16_bf16 a[0:15], v[120:123], v[76:79], a[0:15]
ds_read_b64_tr_b16 v[120:121], v128 offset:8192
ds_read_b64_tr_b16 v[122:123], v128 offset:9216
s_waitcnt lgkmcnt(8)
v_mfma_f32_32x32x16_bf16 a[16:31], v[124:127], v[48:51], a[16:31]
ds_read_b64_tr_b16 v[124:125], v128 offset:10240
ds_read_b64_tr_b16 v[126:127], v128 offset:11264
s_waitcnt lgkmcnt(8)
v_mfma_f32_32x32x16_bf16 a[16:31], v[152:155], v[52:55], a[16:31]
ds_read_b64_tr_b16 v[152:153], v128 offset:12288
ds_read_b64_tr_b16 v[154:155], v128 offset:13312
s_waitcnt lgkmcnt(8)
v_mfma_f32_32x32x16_bf16 a[16:31], v[112:115], v[56:59], a[16:31]
v_accvgpr_read_b32 v96, a0
v_accvgpr_read_b32 v97, a1
v_accvgpr_read_b32 v98, a2
v_accvgpr_read_b32 v99, a3
ds_read_b64_tr_b16 v[112:113], v128 offset:14336
ds_read_b64_tr_b16 v[114:115], v128 offset:15360
s_waitcnt lgkmcnt(8)
v_mfma_f32_32x32x16_bf16 a[16:31], v[116:119], v[60:63], a[16:31]
v_accvgpr_read_b32 v100, a4
v_accvgpr_read_b32 v101, a5
v_accvgpr_read_b32 v102, a6
v_accvgpr_read_b32 v103, a7
v_accvgpr_read_b32 v104, a8
s_barrier
v_add_u32 v128, 65536, v146
ds_read_b64_tr_b16 v[116:117], v128 offset:0
ds_read_b64_tr_b16 v[118:119], v128 offset:1024
s_waitcnt lgkmcnt(8)
v_mfma_f32_32x32x16_bf16 a[16:31], v[120:123], v[64:67], a[16:31]
v_accvgpr_read_b32 v105, a9
v_accvgpr_read_b32 v106, a10
v_accvgpr_read_b32 v107, a11
v_accvgpr_read_b32 v108, a12
ds_read_b64_tr_b16 v[120:121], v128 offset:2048
ds_read_b64_tr_b16 v[122:123], v128 offset:3072
s_waitcnt lgkmcnt(8)
v_mfma_f32_32x32x16_bf16 a[16:31], v[124:127], v[68:71], a[16:31]
v_accvgpr_read_b32 v109, a13
v_accvgpr_read_b32 v110, a14
v_accvgpr_read_b32 v111, a15
v_cvt_pk_bf16_f32 v80, v96, v97
v_cvt_pk_bf16_f32 v81, v98, v99
ds_read_b64_tr_b16 v[124:125], v128 offset:4096
ds_read_b64_tr_b16 v[126:127], v128 offset:5120
s_waitcnt lgkmcnt(8)
v_mfma_f32_32x32x16_bf16 a[16:31], v[152:155], v[72:75], a[16:31]
v_cvt_pk_bf16_f32 v82, v100, v101
v_cvt_pk_bf16_f32 v83, v102, v103
v_cvt_pk_bf16_f32 v84, v104, v105
v_cvt_pk_bf16_f32 v85, v106, v107
ds_read_b64_tr_b16 v[152:153], v128 offset:6144
ds_read_b64_tr_b16 v[154:155], v128 offset:7168
s_waitcnt lgkmcnt(8)
v_mfma_f32_32x32x16_bf16 a[16:31], v[112:115], v[76:79], a[16:31]
v_cvt_pk_bf16_f32 v86, v108, v109
v_cvt_pk_bf16_f32 v87, v110, v111
s_add_u32 s58, s61, 0
buffer_store_dwordx4 v[80:83], v147, s[32:35], s58 offen sc1
buffer_store_dwordx4 v[84:87], v147, s[32:35], s58 offen offset:1024 sc1
ds_read_b64_tr_b16 v[112:113], v128 offset:8192
ds_read_b64_tr_b16 v[114:115], v128 offset:9216
s_waitcnt lgkmcnt(8)
v_mfma_f32_32x32x16_bf16 a[32:47], v[116:119], v[48:51], a[32:47]
ds_read_b64_tr_b16 v[116:117], v128 offset:10240
ds_read_b64_tr_b16 v[118:119], v128 offset:11264
s_waitcnt lgkmcnt(8)
v_mfma_f32_32x32x16_bf16 a[32:47], v[120:123], v[52:55], a[32:47]
ds_read_b64_tr_b16 v[120:121], v128 offset:12288
ds_read_b64_tr_b16 v[122:123], v128 offset:13312
s_waitcnt lgkmcnt(8)
v_mfma_f32_32x32x16_bf16 a[32:47], v[124:127], v[56:59], a[32:47]
v_accvgpr_read_b32 v96, a16
v_accvgpr_read_b32 v97, a17
v_accvgpr_read_b32 v98, a18
v_accvgpr_read_b32 v99, a19
ds_read_b64_tr_b16 v[124:125], v128 offset:14336
ds_read_b64_tr_b16 v[126:127], v128 offset:15360
s_waitcnt lgkmcnt(8)
v_mfma_f32_32x32x16_bf16 a[32:47], v[152:155], v[60:63], a[32:47]
v_accvgpr_read_b32 v100, a20
v_accvgpr_read_b32 v101, a21
v_accvgpr_read_b32 v102, a22
v_accvgpr_read_b32 v103, a23
v_accvgpr_read_b32 v104, a24
s_barrier
v_add_u32 v128, 81920, v146
ds_read_b64_tr_b16 v[152:153], v128 offset:0
ds_read_b64_tr_b16 v[154:155], v128 offset:1024
s_waitcnt lgkmcnt(8)
v_mfma_f32_32x32x16_bf16 a[32:47], v[112:115], v[64:67], a[32:47]
v_accvgpr_read_b32 v105, a25
v_accvgpr_read_b32 v106, a26
v_accvgpr_read_b32 v107, a27
v_accvgpr_read_b32 v108, a28
ds_read_b64_tr_b16 v[112:113], v128 offset:2048
ds_read_b64_tr_b16 v[114:115], v128 offset:3072
s_waitcnt lgkmcnt(8)
v_mfma_f32_32x32x16_bf16 a[32:47], v[116:119], v[68:71], a[32:47]
v_accvgpr_read_b32 v109, a29
v_accvgpr_read_b32 v110, a30
v_accvgpr_read_b32 v111, a31
v_cvt_pk_bf16_f32 v88, v96, v97
v_cvt_pk_bf16_f32 v89, v98, v99
ds_read_b64_tr_b16 v[116:117], v128 offset:4096
ds_read_b64_tr_b16 v[118:119], v128 offset:5120
s_waitcnt lgkmcnt(8)
v_mfma_f32_32x32x16_bf16 a[32:47], v[120:123], v[72:75], a[32:47]
v_cvt_pk_bf16_f32 v90, v100, v101
v_cvt_pk_bf16_f32 v91, v102, v103
v_cvt_pk_bf16_f32 v92, v104, v105
v_cvt_pk_bf16_f32 v93, v106, v107
ds_read_b64_tr_b16 v[120:121], v128 offset:6144
ds_read_b64_tr_b16 v[122:123], v128 offset:7168
s_waitcnt lgkmcnt(8)
v_mfma_f32_32x32x16_bf16 a[32:47], v[124:127], v[76:79], a[32:47]
v_cvt_pk_bf16_f32 v94, v108, v109
v_cvt_pk_bf16_f32 v95, v110, v111
s_add_u32 s58, s61, 2048
buffer_store_dwordx4 v[88:91], v147, s[32:35], s58 offen sc1
buffer_store_dwordx4 v[92:95], v147, s[32:35], s58 offen offset:1024 sc1
ds_read_b64_tr_b16 v[124:125], v128 offset:8192
ds_read_b64_tr_b16 v[126:127], v128 offset:9216
s_waitcnt lgkmcnt(8)
v_mfma_f32_32x32x16_bf16 a[48:63], v[152:155], v[48:51], a[48:63]
ds_read_b64_tr_b16 v[152:153], v128 offset:10240
ds_read_b64_tr_b16 v[154:155], v128 offset:11264
s_waitcnt lgkmcnt(8)
v_mfma_f32_32x32x16_bf16 a[48:63], v[112:115], v[52:55], a[48:63]
ds_read_b64_tr_b16 v[112:113], v128 offset:12288
ds_read_b64_tr_b16 v[114:115], v128 offset:13312
s_waitcnt lgkmcnt(8)
v_mfma_f32_32x32x16_bf16 a[48:63], v[116:119], v[56:59], a[48:63]
v_accvgpr_read_b32 v96, a32
v_accvgpr_read_b32 v97, a33
v_accvgpr_read_b32 v98, a34
v_accvgpr_read_b32 v99, a35
ds_read_b64_tr_b16 v[116:117], v128 offset:14336
ds_read_b64_tr_b16 v[118:119], v128 offset:15360
s_waitcnt lgkmcnt(8)
v_mfma_f32_32x32x16_bf16 a[48:63], v[120:123], v[60:63], a[48:63]
v_accvgpr_read_b32 v100, a36
v_accvgpr_read_b32 v101, a37
v_accvgpr_read_b32 v102, a38
v_accvgpr_read_b32 v103, a39
v_accvgpr_read_b32 v104, a40
s_barrier
v_add_u32 v128, 98304, v146
ds_read_b64_tr_b16 v[120:121], v128 offset:0
ds_read_b64_tr_b16 v[122:123], v128 offset:1024
s_waitcnt lgkmcnt(8)
v_mfma_f32_32x32x16_bf16 a[48:63], v[124:127], v[64:67], a[48:63]
v_accvgpr_read_b32 v105, a41
v_accvgpr_read_b32 v106, a42
v_accvgpr_read_b32 v107, a43
v_accvgpr_read_b32 v108, a44
ds_read_b64_tr_b16 v[124:125], v128 offset:2048
ds_read_b64_tr_b16 v[126:127], v128 offset:3072
s_waitcnt lgkmcnt(8)
v_mfma_f32_32x32x16_bf16 a[48:63], v[152:155], v[68:71], a[48:63]
v_accvgpr_read_b32 v109, a45
v_accvgpr_read_b32 v110, a46
v_accvgpr_read_b32 v111, a47
v_cvt_pk_bf16_f32 v80, v96, v97
v_cvt_pk_bf16_f32 v81, v98, v99
ds_read_b64_tr_b16 v[152:153], v128 offset:4096
ds_read_b64_tr_b16 v[154:155], v128 offset:5120
s_waitcnt lgkmcnt(8)
v_mfma_f32_32x32x16_bf16 a[48:63], v[112:115], v[72:75], a[48:63]
v_cvt_pk_bf16_f32 v82, v100, v101
v_cvt_pk_bf16_f32 v83, v102, v103
v_cvt_pk_bf16_f32 v84, v104, v105
v_cvt_pk_bf16_f32 v85, v106, v107
ds_read_b64_tr_b16 v[112:113], v128 offset:6144
ds_read_b64_tr_b16 v[114:115], v128 offset:7168
s_waitcnt lgkmcnt(8)
v_mfma_f32_32x32x16_bf16 a[48:63], v[116:119], v[76:79], a[48:63]
v_cvt_pk_bf16_f32 v86, v108, v109
v_cvt_pk_bf16_f32 v87, v110, v111
s_add_u32 s58, s61, 4096
buffer_store_dwordx4 v[80:83], v147, s[32:35], s58 offen sc1
buffer_store_dwordx4 v[84:87], v147, s[32:35], s58 offen offset:1024 sc1
ds_read_b64_tr_b16 v[116:117], v128 offset:8192
ds_read_b64_tr_b16 v[118:119], v128 offset:9216
s_waitcnt lgkmcnt(8)
v_mfma_f32_32x32x16_bf16 a[64:79], v[120:123], v[48:51], a[64:79]
ds_read_b64_tr_b16 v[120:121], v128 offset:10240
ds_read_b64_tr_b16 v[122:123], v128 offset:11264
s_waitcnt lgkmcnt(8)
v_mfma_f32_32x32x16_bf16 a[64:79], v[124:127], v[52:55], a[64:79]
ds_read_b64_tr_b16 v[124:125], v128 offset:12288
ds_read_b64_tr_b16 v[126:127], v128 offset:13312
s_waitcnt lgkmcnt(8)
v_mfma_f32_32x32x16_bf16 a[64:79], v[152:155], v[56:59], a[64:79]
v_accvgpr_read_b32 v96, a48
v_accvgpr_read_b32 v97, a49
v_accvgpr_read_b32 v98, a50
v_accvgpr_read_b32 v99, a51
ds_read_b64_tr_b16 v[152:153], v128 offset:14336
ds_read_b64_tr_b16 v[154:155], v128 offset:15360
s_waitcnt lgkmcnt(8)
v_mfma_f32_32x32x16_bf16 a[64:79], v[112:115], v[60:63], a[64:79]
v_accvgpr_read_b32 v100, a52
v_accvgpr_read_b32 v101, a53
v_accvgpr_read_b32 v102, a54
v_accvgpr_read_b32 v103, a55
v_accvgpr_read_b32 v104, a56
s_barrier
v_add_u32 v128, 114688, v146
ds_read_b64_tr_b16 v[112:113], v128 offset:0
ds_read_b64_tr_b16 v[114:115], v128 offset:1024
s_waitcnt lgkmcnt(8)
v_mfma_f32_32x32x16_bf16 a[64:79], v[116:119], v[64:67], a[64:79]
v_accvgpr_read_b32 v105, a57
v_accvgpr_read_b32 v106, a58
v_accvgpr_read_b32 v107, a59
v_accvgpr_read_b32 v108, a60
ds_read_b64_tr_b16 v[116:117], v128 offset:2048
ds_read_b64_tr_b16 v[118:119], v128 offset:3072
s_waitcnt lgkmcnt(8)
v_mfma_f32_32x32x16_bf16 a[64:79], v[120:123], v[68:71], a[64:79]
v_accvgpr_read_b32 v109, a61
v_accvgpr_read_b32 v110, a62
v_accvgpr_read_b32 v111, a63
v_cvt_pk_bf16_f32 v88, v96, v97
v_cvt_pk_bf16_f32 v89, v98, v99
ds_read_b64_tr_b16 v[120:121], v128 offset:4096
ds_read_b64_tr_b16 v[122:123], v128 offset:5120
s_waitcnt lgkmcnt(8)
v_mfma_f32_32x32x16_bf16 a[64:79], v[124:127], v[72:75], a[64:79]
v_cvt_pk_bf16_f32 v90, v100, v101
v_cvt_pk_bf16_f32 v91, v102, v103
v_cvt_pk_bf16_f32 v92, v104, v105
v_cvt_pk_bf16_f32 v93, v106, v107
ds_read_b64_tr_b16 v[124:125], v128 offset:6144
ds_read_b64_tr_b16 v[126:127], v128 offset:7168
s_waitcnt lgkmcnt(8)
v_mfma_f32_32x32x16_bf16 a[64:79], v[152:155], v[76:79], a[64:79]
v_cvt_pk_bf16_f32 v94, v108, v109
v_cvt_pk_bf16_f32 v95, v110, v111
s_add_u32 s58, s61, 6144
buffer_store_dwordx4 v[88:91], v147, s[32:35], s58 offen sc1
buffer_store_dwordx4 v[92:95], v147, s[32:35], s58 offen offset:1024 sc1
ds_read_b64_tr_b16 v[152:153], v128 offset:8192
ds_read_b64_tr_b16 v[154:155], v128 offset:9216
s_waitcnt lgkmcnt(8)
v_mfma_f32_32x32x16_bf16 a[80:95], v[112:115], v[48:51], a[80:95]
ds_read_b64_tr_b16 v[112:113], v128 offset:10240
ds_read_b64_tr_b16 v[114:115], v128 offset:11264
s_waitcnt lgkmcnt(8)
v_mfma_f32_32x32x16_bf16 a[80:95], v[116:119], v[52:55], a[80:95]
ds_read_b64_tr_b16 v[116:117], v128 offset:12288
ds_read_b64_tr_b16 v[118:119], v128 offset:13312
s_waitcnt lgkmcnt(8)
v_mfma_f32_32x32x16_bf16 a[80:95], v[120:123], v[56:59], a[80:95]
v_accvgpr_read_b32 v96, a64
v_accvgpr_read_b32 v97, a65
v_accvgpr_read_b32 v98, a66
v_accvgpr_read_b32 v99, a67
ds_read_b64_tr_b16 v[120:121], v128 offset:14336
ds_read_b64_tr_b16 v[122:123], v128 offset:15360
s_waitcnt lgkmcnt(8)
v_mfma_f32_32x32x16_bf16 a[80:95], v[124:127], v[60:63], a[80:95]
v_accvgpr_read_b32 v100, a68
v_accvgpr_read_b32 v101, a69
v_accvgpr_read_b32 v102, a70
v_accvgpr_read_b32 v103, a71
v_accvgpr_read_b32 v104, a72
s_barrier
v_add_u32 v128, 131072, v146
ds_read_b64_tr_b16 v[124:125], v128 offset:0
ds_read_b64_tr_b16 v[126:127], v128 offset:1024
s_waitcnt lgkmcnt(8)
v_mfma_f32_32x32x16_bf16 a[80:95], v[152:155], v[64:67], a[80:95]
v_accvgpr_read_b32 v105, a73
v_accvgpr_read_b32 v106, a74
v_accvgpr_read_b32 v107, a75
v_accvgpr_read_b32 v108, a76
ds_read_b64_tr_b16 v[152:153], v128 offset:2048
ds_read_b64_tr_b16 v[154:155], v128 offset:3072
s_waitcnt lgkmcnt(8)
v_mfma_f32_32x32x16_bf16 a[80:95], v[112:115], v[68:71], a[80:95]
v_accvgpr_read_b32 v109, a77
v_accvgpr_read_b32 v110, a78
v_accvgpr_read_b32 v111, a79
v_cvt_pk_bf16_f32 v80, v96, v97
v_cvt_pk_bf16_f32 v81, v98, v99
ds_read_b64_tr_b16 v[112:113], v128 offset:4096
ds_read_b64_tr_b16 v[114:115], v128 offset:5120
s_waitcnt lgkmcnt(8)
v_mfma_f32_32x32x16_bf16 a[80:95], v[116:119], v[72:75], a[80:95]
v_cvt_pk_bf16_f32 v82, v100, v101
v_cvt_pk_bf16_f32 v83, v102, v103
v_cvt_pk_bf16_f32 v84, v104, v105
v_cvt_pk_bf16_f32 v85, v106, v107
ds_read_b64_tr_b16 v[116:117], v128 offset:6144
ds_read_b64_tr_b16 v[118:119], v128 offset:7168
s_waitcnt lgkmcnt(8)
v_mfma_f32_32x32x16_bf16 a[80:95], v[120:123], v[76:79], a[80:95]
v_cvt_pk_bf16_f32 v86, v108, v109
v_cvt_pk_bf16_f32 v87, v110, v111
s_add_u32 s58, s61, 8192
buffer_store_dwordx4 v[80:83], v147, s[32:35], s58 offen sc1
buffer_store_dwordx4 v[84:87], v147, s[32:35], s58 offen offset:1024 sc1
ds_read_b64_tr_b16 v[120:121], v128 offset:8192
ds_read_b64_tr_b16 v[122:123], v128 offset:9216
s_waitcnt lgkmcnt(8)
v_mfma_f32_32x32x16_bf16 v[0:15], v[124:127], v[48:51], v[0:15]
ds_read_b64_tr_b16 v[124:125], v128 offset:10240
ds_read_b64_tr_b16 v[126:127], v128 offset:11264
s_waitcnt lgkmcnt(8)
v_mfma_f32_32x32x16_bf16 v[0:15], v[152:155], v[52:55], v[0:15]
ds_read_b64_tr_b16 v[152:153], v128 offset:12288
ds_read_b64_tr_b16 v[154:155], v128 offset:13312
s_waitcnt lgkmcnt(8)
v_mfma_f32_32x32x16_bf16 v[0:15], v[112:115], v[56:59], v[0:15]
v_accvgpr_read_b32 v96, a80
v_accvgpr_read_b32 v97, a81
v_accvgpr_read_b32 v98, a82
v_accvgpr_read_b32 v99, a83
ds_read_b64_tr_b16 v[112:113], v128 offset:14336
ds_read_b64_tr_b16 v[114:115], v128 offset:15360
s_waitcnt lgkmcnt(8)
v_mfma_f32_32x32x16_bf16 v[0:15], v[116:119], v[60:63], v[0:15]
v_accvgpr_read_b32 v100, a84
v_accvgpr_read_b32 v101, a85
v_accvgpr_read_b32 v102, a86
v_accvgpr_read_b32 v103, a87
v_accvgpr_read_b32 v104, a88
s_barrier
v_add_u32 v128, 147456, v146
ds_read_b64_tr_b16 v[116:117], v128 offset:0
ds_read_b64_tr_b16 v[118:119], v128 offset:1024
s_waitcnt lgkmcnt(8)
v_mfma_f32_32x32x16_bf16 v[0:15], v[120:123], v[64:67], v[0:15]
v_accvgpr_read_b32 v105, a89
v_accvgpr_read_b32 v106, a90
v_accvgpr_read_b32 v107, a91
v_accvgpr_read_b32 v108, a92
ds_read_b64_tr_b16 v[120:121], v128 offset:2048
ds_read_b64_tr_b16 v[122:123], v128 offset:3072
s_waitcnt lgkmcnt(8)
v_mfma_f32_32x32x16_bf16 v[0:15], v[124:127], v[68:71], v[0:15]
v_accvgpr_read_b32 v109, a93
v_accvgpr_read_b32 v110, a94
v_accvgpr_read_b32 v111, a95
v_cvt_pk_bf16_f32 v88, v96, v97
v_cvt_pk_bf16_f32 v89, v98, v99
ds_read_b64_tr_b16 v[124:125], v128 offset:4096
ds_read_b64_tr_b16 v[126:127], v128 offset:5120
s_waitcnt lgkmcnt(8)
v_mfma_f32_32x32x16_bf16 v[0:15], v[152:155], v[72:75], v[0:15]
v_cvt_pk_bf16_f32 v90, v100, v101
v_cvt_pk_bf16_f32 v91, v102, v103
v_cvt_pk_bf16_f32 v92, v104, v105
v_cvt_pk_bf16_f32 v93, v106, v107
ds_read_b64_tr_b16 v[152:153], v128 offset:6144
ds_read_b64_tr_b16 v[154:155], v128 offset:7168
s_waitcnt lgkmcnt(8)
v_mfma_f32_32x32x16_bf16 v[0:15], v[112:115], v[76:79], v[0:15]
v_cvt_pk_bf16_f32 v94, v108, v109
v_cvt_pk_bf16_f32 v95, v110, v111
s_add_u32 s58, s61, 10240
buffer_store_dwordx4 v[88:91], v147, s[32:35], s58 offen sc1
buffer_store_dwordx4 v[92:95], v147, s[32:35], s58 offen offset:1024 sc1
ds_read_b64_tr_b16 v[112:113], v128 offset:8192
ds_read_b64_tr_b16 v[114:115], v128 offset:9216
s_waitcnt lgkmcnt(8)
v_mfma_f32_32x32x16_bf16 v[16:31], v[116:119], v[48:51], v[16:31]
ds_read_b64_tr_b16 v[116:117], v128 offset:10240
ds_read_b64_tr_b16 v[118:119], v128 offset:11264
s_waitcnt lgkmcnt(8)
v_mfma_f32_32x32x16_bf16 v[16:31], v[120:123], v[52:55], v[16:31]
ds_read_b64_tr_b16 v[120:121], v128 offset:12288
ds_read_b64_tr_b16 v[122:123], v128 offset:13312
s_waitcnt lgkmcnt(8)
v_mfma_f32_32x32x16_bf16 v[16:31], v[124:127], v[56:59], v[16:31]
v_cvt_pk_bf16_f32 v80, v0, v1
ds_read_b64_tr_b16 v[124:125], v128 offset:14336
ds_read_b64_tr_b16 v[126:127], v128 offset:15360
s_waitcnt lgkmcnt(8)
v_mfma_f32_32x32x16_bf16 v[16:31], v[152:155], v[60:63], v[16:31]
v_cvt_pk_bf16_f32 v81, v2, v3
v_cvt_pk_bf16_f32 v82, v4, v5
s_barrier
v_add_u32 v128, 32768, v146
ds_read_b64_tr_b16 v[152:153], v128 offset:0
ds_read_b64_tr_b16 v[154:155], v128 offset:1024
s_waitcnt lgkmcnt(8)
v_mfma_f32_32x32x16_bf16 v[16:31], v[112:115], v[64:67], v[16:31]
v_cvt_pk_bf16_f32 v83, v6, v7
v_cvt_pk_bf16_f32 v84, v8, v9
ds_read_b64_tr_b16 v[112:113], v128 offset:2048
ds_read_b64_tr_b16 v[114:115], v128 offset:3072
s_waitcnt lgkmcnt(8)
v_mfma_f32_32x32x16_bf16 v[16:31], v[116:119], v[68:71], v[16:31]
v_cvt_pk_bf16_f32 v85, v10, v11
v_cvt_pk_bf16_f32 v86, v12, v13
ds_read_b64_tr_b16 v[116:117], v128 offset:4096
ds_read_b64_tr_b16 v[118:119], v128 offset:5120
s_waitcnt lgkmcnt(8)
v_mfma_f32_32x32x16_bf16 v[16:31], v[120:123], v[72:75], v[16:31]
v_cvt_pk_bf16_f32 v87, v14, v15
s_add_u32 s58, s61, 12288
ds_read_b64_tr_b16 v[120:121], v128 offset:6144
ds_read_b64_tr_b16 v[122:123], v128 offset:7168
s_waitcnt lgkmcnt(8)
v_mfma_f32_32x32x16_bf16 v[16:31], v[124:127], v[76:79], v[16:31]
buffer_store_dwordx4 v[80:83], v147, s[32:35], s58 offen sc1
buffer_store_dwordx4 v[84:87], v147, s[32:35], s58 offen offset:1024 sc1
ds_read_b64_tr_b16 v[124:125], v128 offset:8192
ds_read_b64_tr_b16 v[126:127], v128 offset:9216
s_waitcnt lgkmcnt(8)
v_mfma_f32_32x32x16_bf16 v[32:47], v[152:155], v[48:51], v[32:47]
ds_read_b64_tr_b16 v[152:153], v128 offset:10240
ds_read_b64_tr_b16 v[154:155], v128 offset:11264
s_waitcnt lgkmcnt(8)
v_mfma_f32_32x32x16_bf16 v[32:47], v[112:115], v[52:55], v[32:47]
ds_read_b64_tr_b16 v[112:113], v128 offset:12288
ds_read_b64_tr_b16 v[114:115], v128 offset:13312
s_waitcnt lgkmcnt(8)
v_mfma_f32_32x32x16_bf16 v[32:47], v[116:119], v[56:59], v[32:47]
v_cvt_pk_bf16_f32 v88, v16, v17
ds_read_b64_tr_b16 v[116:117], v128 offset:14336
ds_read_b64_tr_b16 v[118:119], v128 offset:15360
s_waitcnt lgkmcnt(8)
v_mfma_f32_32x32x16_bf16 v[32:47], v[120:123], v[60:63], v[32:47]
v_cvt_pk_bf16_f32 v89, v18, v19
v_cvt_pk_bf16_f32 v90, v20, v21
s_waitcnt lgkmcnt(6)
v_mfma_f32_32x32x16_bf16 v[32:47], v[124:127], v[64:67], v[32:47]
v_cvt_pk_bf16_f32 v91, v22, v23
v_cvt_pk_bf16_f32 v92, v24, v25
s_waitcnt lgkmcnt(4)
v_mfma_f32_32x32x16_bf16 v[32:47], v[152:155], v[68:71], v[32:47]
v_cvt_pk_bf16_f32 v93, v26, v27
v_cvt_pk_bf16_f32 v94, v28, v29
s_waitcnt lgkmcnt(2)
v_mfma_f32_32x32x16_bf16 v[32:47], v[112:115], v[72:75], v[32:47]
v_cvt_pk_bf16_f32 v95, v30, v31
s_add_u32 s58, s61, 14336
s_waitcnt lgkmcnt(0)
v_mfma_f32_32x32x16_bf16 v[32:47], v[116:119], v[76:79], v[32:47]
buffer_store_dwordx4 v[88:91], v147, s[32:35], s58 offen sc1
buffer_store_dwordx4 v[92:95], v147, s[32:35], s58 offen offset:1024 sc1
s_nop 11
v_cvt_pk_bf16_f32 v80, v32, v33
v_cvt_pk_bf16_f32 v81, v34, v35
v_cvt_pk_bf16_f32 v82, v36, v37
v_cvt_pk_bf16_f32 v83, v38, v39
v_cvt_pk_bf16_f32 v84, v40, v41
v_cvt_pk_bf16_f32 v85, v42, v43
v_cvt_pk_bf16_f32 v86, v44, v45
v_cvt_pk_bf16_f32 v87, v46, v47
s_add_u32 s58, s61, 16384
buffer_store_dwordx4 v[80:83], v147, s[32:35], s58 offen sc1
buffer_store_dwordx4 v[84:87], v147, s[32:35], s58 offen offset:1024 sc1
s_waitcnt vmcnt(0)
s_barrier
s_cmp_eq_u32 s69, 4
s_cbranch_scc0 FIN0
s_mov_b64 exec, 1
s_lshl_b32 s38, s36, 7
s_lshl_b32 s39, s37, 2
s_add_u32 s39, s38, s39
s_add_u32 s39, s39, 20971520
v_mov_b32 v1, s39
v_mov_b32 v2, 1
global_store_dword v1, v2, s[12:13] sc1
s_mov_b64 exec, -1
FIN0:
s_mov_b32 s76, s72
s_and_b32 s77, s73, 0xffff
s_mov_b32 s78, 2359296
s_mov_b32 s79, 0x20000
v_mbcnt_lo_u32_b32 v2, -1, 0
v_mbcnt_hi_u32_b32 v2, -1, v2
v_lshrrev_b32 v7, 5, v2
v_bfe_u32 v8, v2, 4, 1
v_bfe_u32 v9, v2, 3, 1
v_and_b32 v10, 7, v2
v_mul_u32_u24 v3, 36864, v7
v_lshlrev_b32 v11, 10, v8
v_add_u32 v3, v3, v11
v_lshlrev_b32 v11, 9, v9
v_add_u32 v3, v3, v11
v_lshlrev_b32 v11, 4, v10
v_add_u32 v3, v3, v11
v_lshlrev_b32 v5, 6, v7
v_lshlrev_b32 v11, 5, v8
v_add_u32 v5, v5, v11
v_lshlrev_b32 v11, 3, v9
v_add_u32 v5, v5, v11
s_mul_i32 s38, s37, 9
s_add_u32 s38, s38, s69
s_and_b32 s41, s38, 3
s_lshr_b32 s39, s38, 2
s_and_b32 s40, s39, 1
s_lshr_b32 s39, s39, 1
s_mul_i32 s52, s36, 589824
s_mul_i32 s46, s40, 18432
s_add_u32 s52, s52, s46
s_lshl_b32 s46, s39, 11
s_add_u32 s52, s52, s46
s_lshl_b32 s46, s41, 7
s_add_u32 s52, s52, s46
s_lshl_b32 s42, s36, 6
s_lshl_b32 s43, s40, 5
s_add_u32 s42, s42, s43
s_lshl_b32 s43, s41, 3
s_add_u32 s42, s42, s43
v_and_b32 v4, 7, v2
v_add_u32 v4, s42, v4
v_mul_u32_u24 v4, 1152, v4
v_add_u32 v4, v4, v5
s_lshl_b32 s53, s39, 7
s_mul_i32 s38, s37, 9
s_add_u32 s38, s38, 8
s_and_b32 s41, s38, 3
s_lshr_b32 s39, s38, 2
s_and_b32 s40, s39, 1
s_lshr_b32 s39, s39, 1
s_mul_i32 s54, s36, 589824
s_mul_i32 s46, s40, 18432
s_add_u32 s54, s54, s46
s_lshl_b32 s46, s39, 11
s_add_u32 s54, s54, s46
s_lshl_b32 s46, s41, 7
s_add_u32 s54, s54, s46
s_lshl_b32 s42, s36, 6
s_lshl_b32 s43, s40, 5
s_add_u32 s42, s42, s43
s_lshl_b32 s43, s41, 3
s_add_u32 s42, s42, s43
v_and_b32 v6, 7, v2
v_add_u32 v6, s42, v6
v_mul_u32_u24 v6, 1152, v6
v_add_u32 v6, v6, v5
s_lshl_b32 s55, s39, 7
s_mov_b32 s47, 0xffff0000
s_cmp_eq_u32 s69, 0
s_cbranch_scc0 FIN
s_mov_b64 exec, 0xff
s_lshl_b32 s38, s36, 7
s_add_u32 s38, s38, 20971520
v_lshlrev_b32 v60, 2, v2
v_add_u32 v60, s38, v60
s_mov_b32 s63, 0
FIN_poll:
global_load_dword v61, v60, s[12:13] sc1
s_waitcnt vmcnt(0)
v_cmp_ne_u32 vcc, 1, v61
s_cbranch_vccz FIN_go
s_sleep 2
s_add_u32 s63, s63, 1
s_cmp_lt_u32 s63, 0x100000
s_cbranch_scc1 FIN_poll
FIN_go:
s_mov_b64 exec, -1
FIN:
s_barrier
s_add_u32 s46, s52, 0
buffer_load_dwordx4 v[8:11], v3, s[32:35], s46 offen sc1
s_add_u32 s46, s52, 73728
buffer_load_dwordx4 v[12:15], v3, s[32:35], s46 offen sc1
s_add_u32 s46, s52, 147456
buffer_load_dwordx4 v[16:19], v3, s[32:35], s46 offen sc1
s_add_u32 s46, s52, 221184
buffer_load_dwordx4 v[20:23], v3, s[32:35], s46 offen sc1
s_add_u32 s46, s52, 294912
buffer_load_dwordx4 v[24:27], v3, s[32:35], s46 offen sc1
s_add_u32 s46, s52, 368640
buffer_load_dwordx4 v[28:31], v3, s[32:35], s46 offen sc1
s_add_u32 s46, s52, 442368
buffer_load_dwordx4 v[32:35], v3, s[32:35], s46 offen sc1
s_add_u32 s46, s52, 516096
buffer_load_dwordx4 v[36:39], v3, s[32:35], s46 offen sc1
s_cmp_eq_u32 s69, 1
s_cbranch_scc0 FF_one
s_add_u32 s46, s54, 0
buffer_load_dwordx4 v[64:67], v3, s[32:35], s46 offen sc1
s_add_u32 s46, s54, 73728
buffer_load_dwordx4 v[68:71], v3, s[32:35], s46 offen sc1
s_add_u32 s46, s54, 147456
buffer_load_dwordx4 v[72:75], v3, s[32:35], s46 offen sc1
s_add_u32 s46, s54, 221184
buffer_load_dwordx4 v[76:79], v3, s[32:35], s46 offen sc1
s_add_u32 s46, s54, 294912
buffer_load_dwordx4 v[80:83], v3, s[32:35], s46 offen sc1
s_add_u32 s46, s54, 368640
buffer_load_dwordx4 v[84:87], v3, s[32:35], s46 offen sc1
s_add_u32 s46, s54, 442368
buffer_load_dwordx4 v[88:91], v3, s[32:35], s46 offen sc1
s_add_u32 s46, s54, 516096
buffer_load_dwordx4 v[92:95], v3, s[32:35], s46 offen sc1
s_waitcnt vmcnt(8)
v_lshlrev_b32 v44, 16, v8
v_and_b32 v45, s47, v8
v_lshlrev_b32 v46, 16, v9
v_and_b32 v47, s47, v9
v_lshlrev_b32 v48, 16, v10
v_and_b32 v49, s47, v10
v_lshlrev_b32 v50, 16, v11
v_and_b32 v51, s47, v11
v_lshlrev_b32 v52, 16, v12
v_and_b32 v53, s47, v12
v_add_f32 v44, v44, v52
v_add_f32 v45, v45, v53
v_lshlrev_b32 v52, 16, v13
v_and_b32 v53, s47, v13
v_add_f32 v46, v46, v52
v_add_f32 v47, v47, v53
v_lshlrev_b32 v52, 16, v14
v_and_b32 v53, s47, v14
v_add_f32 v48, v48, v52
v_add_f32 v49, v49, v53
v_lshlrev_b32 v52, 16, v15
v_and_b32 v53, s47, v15
v_add_f32 v50, v50, v52
v_add_f32 v51, v51, v53
v_lshlrev_b32 v52, 16, v16
v_and_b32 v53, s47, v16
v_add_f32 v44, v44, v52
v_add_f32 v45, v45, v53
v_lshlrev_b32 v52, 16, v17
v_and_b32 v53, s47, v17
v_add_f32 v46, v46, v52
v_add_f32 v47, v47, v53
v_lshlrev_b32 v52, 16, v18
v_and_b32 v53, s47, v18
v_add_f32 v48, v48, v52
v_add_f32 v49, v49, v53
v_lshlrev_b32 v52, 16, v19
v_and_b32 v53, s47, v19
v_add_f32 v50, v50, v52
v_add_f32 v51, v51, v53
v_lshlrev_b32 v52, 16, v20
v_and_b32 v53, s47, v20
v_add_f32 v44, v44, v52
v_add_f32 v45, v45, v53
v_lshlrev_b32 v52, 16, v21
v_and_b32 v53, s47, v21
v_add_f32 v46, v46, v52
v_add_f32 v47, v47, v53
v_lshlrev_b32 v52, 16, v22
v_and_b32 v53, s47, v22
v_add_f32 v48, v48, v52
v_add_f32 v49, v49, v53
v_lshlrev_b32 v52, 16, v23
v_and_b32 v53, s47, v23
v_add_f32 v50, v50, v52
v_add_f32 v51, v51, v53
v_lshlrev_b32 v52, 16, v24
v_and_b32 v53, s47, v24
v_add_f32 v44, v44, v52
v_add_f32 v45, v45, v53
v_lshlrev_b32 v52, 16, v25
v_and_b32 v53, s47, v25
v_add_f32 v46, v46, v52
v_add_f32 v47, v47, v53
v_lshlrev_b32 v52, 16, v26
v_and_b32 v53, s47, v26
v_add_f32 v48, v48, v52
v_add_f32 v49, v49, v53
v_lshlrev_b32 v52, 16, v27
v_and_b32 v53, s47, v27
v_add_f32 v50, v50, v52
v_add_f32 v51, v51, v53
v_lshlrev_b32 v52, 16, v28
v_and_b32 v53, s47, v28
v_add_f32 v44, v44, v52
v_add_f32 v45, v45, v53
v_lshlrev_b32 v52, 16, v29
v_and_b32 v53, s47, v29
v_add_f32 v46, v46, v52
v_add_f32 v47, v47, v53
v_lshlrev_b32 v52, 16, v30
v_and_b32 v53, s47, v30
v_add_f32 v48, v48, v52
v_add_f32 v49, v49, v53
v_lshlrev_b32 v52, 16, v31
v_and_b32 v53, s47, v31
v_add_f32 v50, v50, v52
v_add_f32 v51, v51, v53
v_lshlrev_b32 v52, 16, v32
v_and_b32 v53, s47, v32
v_add_f32 v44, v44, v52
v_add_f32 v45, v45, v53
v_lshlrev_b32 v52, 16, v33
v_and_b32 v53, s47, v33
v_add_f32 v46, v46, v52
v_add_f32 v47, v47, v53
v_lshlrev_b32 v52, 16, v34
v_and_b32 v53, s47, v34
v_add_f32 v48, v48, v52
v_add_f32 v49, v49, v53
v_lshlrev_b32 v52, 16, v35
v_and_b32 v53, s47, v35
v_add_f32 v50, v50, v52
v_add_f32 v51, v51, v53
v_lshlrev_b32 v52, 16, v36
v_and_b32 v53, s47, v36
v_add_f32 v44, v44, v52
v_add_f32 v45, v45, v53
v_lshlrev_b32 v52, 16, v37
v_and_b32 v53, s47, v37
v_add_f32 v46, v46, v52
v_add_f32 v47, v47, v53
v_lshlrev_b32 v52, 16, v38
v_and_b32 v53, s47, v38
v_add_f32 v48, v48, v52
v_add_f32 v49, v49, v53
v_lshlrev_b32 v52, 16, v39
v_and_b32 v53, s47, v39
v_add_f32 v50, v50, v52
v_add_f32 v51, v51, v53
v_cvt_pk_bf16_f32 v56, v44, v45
v_cvt_pk_bf16_f32 v57, v46, v47
v_cvt_pk_bf16_f32 v58, v48, v49
v_cvt_pk_bf16_f32 v59, v50, v51
buffer_store_dwordx2 v[56:57], v4, s[76:79], s53 offen
buffer_store_dwordx2 v[58:59], v4, s[76:79], s53 offen offset:16
s_waitcnt vmcnt(0)
s_nop 1
v_lshlrev_b32 v44, 16, v64
v_and_b32 v45, s47, v64
v_lshlrev_b32 v46, 16, v65
v_and_b32 v47, s47, v65
v_lshlrev_b32 v48, 16, v66
v_and_b32 v49, s47, v66
v_lshlrev_b32 v50, 16, v67
v_and_b32 v51, s47, v67
v_lshlrev_b32 v52, 16, v68
v_and_b32 v53, s47, v68
v_add_f32 v44, v44, v52
v_add_f32 v45, v45, v53
v_lshlrev_b32 v52, 16, v69
v_and_b32 v53, s47, v69
v_add_f32 v46, v46, v52
v_add_f32 v47, v47, v53
v_lshlrev_b32 v52, 16, v70
v_and_b32 v53, s47, v70
v_add_f32 v48, v48, v52
v_add_f32 v49, v49, v53
v_lshlrev_b32 v52, 16, v71
v_and_b32 v53, s47, v71
v_add_f32 v50, v50, v52
v_add_f32 v51, v51, v53
v_lshlrev_b32 v52, 16, v72
v_and_b32 v53, s47, v72
v_add_f32 v44, v44, v52
v_add_f32 v45, v45, v53
v_lshlrev_b32 v52, 16, v73
v_and_b32 v53, s47, v73
v_add_f32 v46, v46, v52
v_add_f32 v47, v47, v53
v_lshlrev_b32 v52, 16, v74
v_and_b32 v53, s47, v74
v_add_f32 v48, v48, v52
v_add_f32 v49, v49, v53
v_lshlrev_b32 v52, 16, v75
v_and_b32 v53, s47, v75
v_add_f32 v50, v50, v52
v_add_f32 v51, v51, v53
v_lshlrev_b32 v52, 16, v76
v_and_b32 v53, s47, v76
v_add_f32 v44, v44, v52
v_add_f32 v45, v45, v53
v_lshlrev_b32 v52, 16, v77
v_and_b32 v53, s47, v77
v_add_f32 v46, v46, v52
v_add_f32 v47, v47, v53
v_lshlrev_b32 v52, 16, v78
v_and_b32 v53, s47, v78
v_add_f32 v48, v48, v52
v_add_f32 v49, v49, v53
v_lshlrev_b32 v52, 16, v79
v_and_b32 v53, s47, v79
v_add_f32 v50, v50, v52
v_add_f32 v51, v51, v53
v_lshlrev_b32 v52, 16, v80
v_and_b32 v53, s47, v80
v_add_f32 v44, v44, v52
v_add_f32 v45, v45, v53
v_lshlrev_b32 v52, 16, v81
v_and_b32 v53, s47, v81
v_add_f32 v46, v46, v52
v_add_f32 v47, v47, v53
v_lshlrev_b32 v52, 16, v82
v_and_b32 v53, s47, v82
v_add_f32 v48, v48, v52
v_add_f32 v49, v49, v53
v_lshlrev_b32 v52, 16, v83
v_and_b32 v53, s47, v83
v_add_f32 v50, v50, v52
v_add_f32 v51, v51, v53
v_lshlrev_b32 v52, 16, v84
v_and_b32 v53, s47, v84
v_add_f32 v44, v44, v52
v_add_f32 v45, v45, v53
v_lshlrev_b32 v52, 16, v85
v_and_b32 v53, s47, v85
v_add_f32 v46, v46, v52
v_add_f32 v47, v47, v53
v_lshlrev_b32 v52, 16, v86
v_and_b32 v53, s47, v86
v_add_f32 v48, v48, v52
v_add_f32 v49, v49, v53
v_lshlrev_b32 v52, 16, v87
v_and_b32 v53, s47, v87
v_add_f32 v50, v50, v52
v_add_f32 v51, v51, v53
v_lshlrev_b32 v52, 16, v88
v_and_b32 v53, s47, v88
v_add_f32 v44, v44, v52
v_add_f32 v45, v45, v53
v_lshlrev_b32 v52, 16, v89
v_and_b32 v53, s47, v89
v_add_f32 v46, v46, v52
v_add_f32 v47, v47, v53
v_lshlrev_b32 v52, 16, v90
v_and_b32 v53, s47, v90
v_add_f32 v48, v48, v52
v_add_f32 v49, v49, v53
v_lshlrev_b32 v52, 16, v91
v_and_b32 v53, s47, v91
v_add_f32 v50, v50, v52
v_add_f32 v51, v51, v53
v_lshlrev_b32 v52, 16, v92
v_and_b32 v53, s47, v92
v_add_f32 v44, v44, v52
v_add_f32 v45, v45, v53
v_lshlrev_b32 v52, 16, v93
v_and_b32 v53, s47, v93
v_add_f32 v46, v46, v52
v_add_f32 v47, v47, v53
v_lshlrev_b32 v52, 16, v94
v_and_b32 v53, s47, v94
v_add_f32 v48, v48, v52
v_add_f32 v49, v49, v53
v_lshlrev_b32 v52, 16, v95
v_and_b32 v53, s47, v95
v_add_f32 v50, v50, v52
v_add_f32 v51, v51, v53
v_cvt_pk_bf16_f32 v56, v44, v45
v_cvt_pk_bf16_f32 v57, v46, v47
v_cvt_pk_bf16_f32 v58, v48, v49
v_cvt_pk_bf16_f32 v59, v50, v51
buffer_store_dwordx2 v[56:57], v6, s[76:79], s55 offen
buffer_store_dwordx2 v[58:59], v6, s[76:79], s55 offen offset:16
s_branch FF_done
FF_one:
s_waitcnt vmcnt(0)
v_lshlrev_b32 v44, 16, v8
v_and_b32 v45, s47, v8
v_lshlrev_b32 v46, 16, v9
v_and_b32 v47, s47, v9
v_lshlrev_b32 v48, 16, v10
v_and_b32 v49, s47, v10
v_lshlrev_b32 v50, 16, v11
v_and_b32 v51, s47, v11
v_lshlrev_b32 v52, 16, v12
v_and_b32 v53, s47, v12
v_add_f32 v44, v44, v52
v_add_f32 v45, v45, v53
v_lshlrev_b32 v52, 16, v13
v_and_b32 v53, s47, v13
v_add_f32 v46, v46, v52
v_add_f32 v47, v47, v53
v_lshlrev_b32 v52, 16, v14
v_and_b32 v53, s47, v14
v_add_f32 v48, v48, v52
v_add_f32 v49, v49, v53
v_lshlrev_b32 v52, 16, v15
v_and_b32 v53, s47, v15
v_add_f32 v50, v50, v52
v_add_f32 v51, v51, v53
v_lshlrev_b32 v52, 16, v16
v_and_b32 v53, s47, v16
v_add_f32 v44, v44, v52
v_add_f32 v45, v45, v53
v_lshlrev_b32 v52, 16, v17
v_and_b32 v53, s47, v17
v_add_f32 v46, v46, v52
v_add_f32 v47, v47, v53
v_lshlrev_b32 v52, 16, v18
v_and_b32 v53, s47, v18
v_add_f32 v48, v48, v52
v_add_f32 v49, v49, v53
v_lshlrev_b32 v52, 16, v19
v_and_b32 v53, s47, v19
v_add_f32 v50, v50, v52
v_add_f32 v51, v51, v53
v_lshlrev_b32 v52, 16, v20
v_and_b32 v53, s47, v20
v_add_f32 v44, v44, v52
v_add_f32 v45, v45, v53
v_lshlrev_b32 v52, 16, v21
v_and_b32 v53, s47, v21
v_add_f32 v46, v46, v52
v_add_f32 v47, v47, v53
v_lshlrev_b32 v52, 16, v22
v_and_b32 v53, s47, v22
v_add_f32 v48, v48, v52
v_add_f32 v49, v49, v53
v_lshlrev_b32 v52, 16, v23
v_and_b32 v53, s47, v23
v_add_f32 v50, v50, v52
v_add_f32 v51, v51, v53
v_lshlrev_b32 v52, 16, v24
v_and_b32 v53, s47, v24
v_add_f32 v44, v44, v52
v_add_f32 v45, v45, v53
v_lshlrev_b32 v52, 16, v25
v_and_b32 v53, s47, v25
v_add_f32 v46, v46, v52
v_add_f32 v47, v47, v53
v_lshlrev_b32 v52, 16, v26
v_and_b32 v53, s47, v26
v_add_f32 v48, v48, v52
v_add_f32 v49, v49, v53
v_lshlrev_b32 v52, 16, v27
v_and_b32 v53, s47, v27
v_add_f32 v50, v50, v52
v_add_f32 v51, v51, v53
v_lshlrev_b32 v52, 16, v28
v_and_b32 v53, s47, v28
v_add_f32 v44, v44, v52
v_add_f32 v45, v45, v53
v_lshlrev_b32 v52, 16, v29
v_and_b32 v53, s47, v29
v_add_f32 v46, v46, v52
v_add_f32 v47, v47, v53
v_lshlrev_b32 v52, 16, v30
v_and_b32 v53, s47, v30
v_add_f32 v48, v48, v52
v_add_f32 v49, v49, v53
v_lshlrev_b32 v52, 16, v31
v_and_b32 v53, s47, v31
v_add_f32 v50, v50, v52
v_add_f32 v51, v51, v53
v_lshlrev_b32 v52, 16, v32
v_and_b32 v53, s47, v32
v_add_f32 v44, v44, v52
v_add_f32 v45, v45, v53
v_lshlrev_b32 v52, 16, v33
v_and_b32 v53, s47, v33
v_add_f32 v46, v46, v52
v_add_f32 v47, v47, v53
v_lshlrev_b32 v52, 16, v34
v_and_b32 v53, s47, v34
v_add_f32 v48, v48, v52
v_add_f32 v49, v49, v53
v_lshlrev_b32 v52, 16, v35
v_and_b32 v53, s47, v35
v_add_f32 v50, v50, v52
v_add_f32 v51, v51, v53
v_lshlrev_b32 v52, 16, v36
v_and_b32 v53, s47, v36
v_add_f32 v44, v44, v52
v_add_f32 v45, v45, v53
v_lshlrev_b32 v52, 16, v37
v_and_b32 v53, s47, v37
v_add_f32 v46, v46, v52
v_add_f32 v47, v47, v53
v_lshlrev_b32 v52, 16, v38
v_and_b32 v53, s47, v38
v_add_f32 v48, v48, v52
v_add_f32 v49, v49, v53
v_lshlrev_b32 v52, 16, v39
v_and_b32 v53, s47, v39
v_add_f32 v50, v50, v52
v_add_f32 v51, v51, v53
v_cvt_pk_bf16_f32 v56, v44, v45
v_cvt_pk_bf16_f32 v57, v46, v47
v_cvt_pk_bf16_f32 v58, v48, v49
v_cvt_pk_bf16_f32 v59, v50, v51
buffer_store_dwordx2 v[56:57], v4, s[76:79], s53 offen
buffer_store_dwordx2 v[58:59], v4, s[76:79], s53 offen offset:16
FF_done:
A_end:
s_endpgm
.section .rodata,"a"
.p2align 6
.amdhsa_kernel standalone__mha_block_cached__near_ridge_kernel
  .amdhsa_next_free_vgpr 256
  .amdhsa_next_free_sgpr 96
  .amdhsa_accum_offset 160
  .amdhsa_group_segment_fixed_size 0
  .amdhsa_kernarg_size 64
  .amdhsa_user_sgpr_count 2
  .amdhsa_user_sgpr_kernarg_segment_ptr 1
  .amdhsa_system_sgpr_workgroup_id_x 1
.end_amdhsa_kernel
.text
```
